```python
import torch

def _softmax(x, axis=-1):
    return torch.softmax(x, dim=axis)
def _gelu(x):
    return torch.nn.functional.gelu(x, approximate="tanh")
def _silu(x):
    return torch.nn.functional.silu(x)
def _sigmoid(x):
    return torch.sigmoid(x)
def _layernorm(x, axis=-1, eps=1e-5):
    m = x.mean(dim=axis, keepdim=True)
    v = x.var(dim=axis, keepdim=True, unbiased=False)
    return (x - m) / torch.sqrt(v + eps)
def _scatter_add(tgt, idx, src, axis=0):
    return tgt.clone().index_add_(axis, idx, src)
def _segment_sum(src, seg, n):
    out = torch.zeros((n,) + src.shape[1:], dtype=src.dtype)
    return out.index_add_(0, seg, src)
def _pad(x, pw):
    flat = tuple(v for pair in reversed(pw) for v in pair)
    return torch.nn.functional.pad(x, flat)

kernel_name = 'parallel_sum__spectral_gfnet__glu_gated_swiglu__prompt'

def setup_inputs():

    _w = (lambda a: (lambda t: t.to(torch.bfloat16) if t.is_floating_point() else t)(torch.as_tensor(a)))
    def _A_setup():
        B, S, D = 1, 2048, 512
        Df = D // 2 + 1
        return {
            "x": _w((lambda *s: torch.randn(*s, dtype=torch.bfloat16) * 0.05)(B, S, D)),
            "w_r": _w((lambda *s: torch.randn(*s, dtype=torch.bfloat16) * 0.4)(S, Df) * 0.02),
            "w_i": _w((lambda *s: torch.randn(*s, dtype=torch.bfloat16) * 0.4)(S, Df) * 0.02),
        }
    _A_in = _A_setup()

    def _B_setup():
        B, S, D, F = 1, 2048, 512, 1792
        return {
            "x": _w((lambda *s: torch.randn(*s, dtype=torch.bfloat16) * 0.05)(B, S, D)),
            "w1": _w((lambda *s: torch.randn(*s, dtype=torch.bfloat16) * 0.2)(D, F) * (2.0 / D) ** 0.5),
            "w3": _w((lambda *s: torch.randn(*s, dtype=torch.bfloat16) * 0.2)(D, F) * (2.0 / D) ** 0.5),
            "w2": _w((lambda *s: torch.randn(*s, dtype=torch.bfloat16) * 0.2)(F, D) * (2.0 / F) ** 0.5),
        }
    _B_in = _B_setup()

    return {
        "A_x": _A_in["x"],
        "A_w_r": _A_in["w_r"],
        "A_w_i": _A_in["w_i"],
        "B_x": _B_in["x"],
        "B_w1": _B_in["w1"],
        "B_w3": _B_in["w3"],
        "B_w2": _B_in["w2"],
    }

def reference(A_x, A_w_r, A_w_i, B_x, B_w1, B_w3, B_w2):
    def _A_ref(x, w_r, w_i):
        B, S, D = x.shape
        X = (lambda x, axes=(-2,-1): torch.fft.rfft2(x.float(), dim=axes))(x, axes=(-2, -1))
        W = w_r + 1j * w_i
        X = X * W
        y = (lambda x, s, axes=(-2,-1): torch.fft.irfft2(x, s=s, dim=axes).to(torch.bfloat16))(X, (S, D), axes=(-2, -1))
        return y

    def _B_ref(x, w1, w3, w2):
        gate = torch.einsum("bsd,df->bsf", x, w1)
        up = torch.einsum("bsd,df->bsf", x, w3)
        h = _silu(gate) * up
        out = torch.einsum("bsf,fd->bsd", h, w2)
        return out

    x = A_x
    xn = _layernorm(x, axis=-1)
    return x + _A_ref(xn, A_w_r, A_w_i) + _B_ref(xn, B_w1, B_w3, B_w2)
```

```asm
; @launch grid=(256,1,1) block=(256,1,1) lds=163840
.amdgcn_target "amdgcn-amd-amdhsa--gfx950"
.text
.globl parallel_sum__spectral_gfnet__glu_gated_swiglu__prompt_kernel
.p2align 8
.type parallel_sum__spectral_gfnet__glu_gated_swiglu__prompt_kernel,@function
parallel_sum__spectral_gfnet__glu_gated_swiglu__prompt_kernel:
    s_cmp_ge_u32 s2, 256
    s_cbranch_scc1 L_end
    s_load_dwordx2 s[4:5], s[0:1], 0
    s_load_dwordx2 s[8:9], s[0:1], 32
    s_load_dwordx2 s[12:13], s[0:1], 40
    s_load_dwordx4 s[88:91], s[0:1], 8
    s_load_dwordx4 s[92:95], s[0:1], 48
    s_load_dwordx4 s[96:99], s[0:1], 64
    s_memrealtime s[100:101]
    s_getpc_b64 s[28:29]
    s_add_u32 s28, s28, gf_tables@rel32@lo+4
    s_addc_u32 s29, s29, gf_tables@rel32@hi+12
    v_lshrrev_b32 v2, 6, v0
    v_and_b32 v1, 63, v0
    s_and_b32 s52, s2, 7
    s_lshr_b32 s53, s2, 3
    v_readfirstlane_b32 s44, v2
    s_mov_b32 s6, 2097152
    s_mov_b32 s7, 0x20000
    s_mov_b32 s10, 1835008
    s_mov_b32 s11, 0x20000
    s_mov_b32 s14, 1835008
    s_mov_b32 s15, 0x20000
    s_mov_b32 s30, 524288
    s_mov_b32 s31, 0x20000
    s_and_b32 s29, s29, 0xffff
    s_and_b32 s54, s52, 3
    s_lshl_b32 s54, s54, 2
    s_and_b32 s55, s53, 3
    s_add_u32 s45, s54, s55
    s_lshr_b32 s54, s53, 2
    s_add_u32 s58, s54, 8
    s_cmp_lt_u32 s54, 4
    s_cselect_b32 s58, s54, s58
    s_add_u32 s59, s54, 4
    s_cmp_lt_u32 s52, 4
    s_cselect_b32 s46, s58, s59
    s_lshr_b32 s55, s52, 1
    s_and_b32 s54, s52, 1
    s_lshl_b32 s54, s54, 4
    s_lshr_b32 s58, s53, 1
    s_add_u32 s47, s54, s58
    s_lshl_b32 s55, s55, 1
    s_and_b32 s58, s53, 1
    s_add_u32 s48, s55, s58
    s_nop 0
    s_lshl_b32 s54, s52, 2
    s_and_b32 s58, s53, 3
    s_add_u32 s49, s54, s58
    s_lshr_b32 s50, s53, 2
    v_and_b32 v2, 31, v1
    v_lshrrev_b32 v3, 5, v1
    v_and_b32 v4, 15, v1
    v_lshrrev_b32 v5, 4, v1
    v_and_b32 v6, 7, v1
    v_lshrrev_b32 v7, 3, v1
    v_xor_b32 v8, v6, v5
    v_lshlrev_b32 v8, 4, v8
    v_lshl_add_u32 v38, v7, 15, v8
    v_xor_b32 v39, 64, v38
    v_lshlrev_b32 v42, 4, v1
    s_and_b32 s60, s44, 1
    s_lshr_b32 s61, s44, 1
    s_lshl_b32 s52, s44, 12
    s_lshl_b32 s68, s44, 11
    s_lshl_b32 s55, s45, 1
    s_add_u32 s55, s55, s61
    s_lshl_b32 s55, s55, 10
    s_lshl_b32 s56, s60, 20
    s_add_u32 s53, s55, s56
    s_cmp_ge_u32 s46, 12
    s_cbranch_scc1 L_mixed
    s_lshl_b32 s62, s46, 7
    s_mul_i32 s54, s44, 57344
    s_lshl_b32 s55, s62, 1
    s_add_u32 s54, s54, s55
    s_movk_i32 s55, 3584
    v_mul_lo_u32 v9, v5, s55
    v_lshrrev_b32 v8, 1, v4
    v_xor_b32 v8, v8, v5
    v_and_b32 v44, 1, v1
    v_lshl_or_b32 v8, v8, 1, v44
    v_lshl_add_u32 v40, v8, 4, v9
    v_xor_b32 v8, 8, v8
    v_lshl_add_u32 v41, v8, 4, v9
    s_lshr_b32 s55, s2, 5
    s_mov_b32 s66, 0
    s_waitcnt lgkmcnt(0)
    s_and_b32 s5, s5, 0xffff
    s_and_b32 s9, s9, 0xffff
    s_and_b32 s13, s13, 0xffff
    s_or_b32 s74, s100, 1
    s_or_b32 s55, s2, s44
    s_cmp_eq_u32 s55, 0
    s_cbranch_scc0 L_ldr_1
    s_mov_b32 s40, s96
    s_and_b32 s41, s97, 0xffff
    s_mov_b32 s42, 256
    s_mov_b32 s43, 0x20000
    v_mov_b32 v9, 2147483632
    v_cmp_eq_u32 vcc, 0, v0
    v_mov_b32 v8, s74
    s_nop 0
    v_cndmask_b32_e64 v9, v9, 0, vcc
    buffer_store_dword v8, v9, s[40:43], 0 offen sc1
L_ldr_1:
    s_cmp_lt_u32 s46, 4
    s_cbranch_scc0 L_stl_2
    s_lshl_b32 s70, s46, 2
    s_add_u32 s70, s70, s44
    s_lshl_b32 s70, s70, 3
    s_add_u32 s70, s70, 0
    v_add_u32 v122, s70, v5
    v_lshrrev_b32 v8, 6, v122
    v_and_b32 v9, 63, v122
    v_lshl_add_u32 v8, v9, 5, v8
    v_lshlrev_b32 v8, 10, v8
    v_lshl_add_u32 v8, v4, 4, v8
    s_lshl_b32 s71, s45, 11
    buffer_load_dwordx4 v[48:51], v8, s[4:7], s71 offen offset:0
    buffer_load_dwordx4 v[52:55], v8, s[4:7], s71 offen offset:256
    buffer_load_dwordx4 v[56:59], v8, s[4:7], s71 offen offset:512
    buffer_load_dwordx4 v[60:63], v8, s[4:7], s71 offen offset:768
    s_lshl_b32 s70, s46, 2
    s_add_u32 s70, s70, s44
    s_lshl_b32 s70, s70, 3
    s_add_u32 s70, s70, 4
    v_add_u32 v123, s70, v5
    v_lshrrev_b32 v8, 6, v123
    v_and_b32 v9, 63, v123
    v_lshl_add_u32 v8, v9, 5, v8
    v_lshlrev_b32 v8, 10, v8
    v_lshl_add_u32 v8, v4, 4, v8
    s_lshl_b32 s71, s45, 11
    buffer_load_dwordx4 v[64:67], v8, s[4:7], s71 offen offset:0
    buffer_load_dwordx4 v[68:71], v8, s[4:7], s71 offen offset:256
    buffer_load_dwordx4 v[72:75], v8, s[4:7], s71 offen offset:512
    buffer_load_dwordx4 v[76:79], v8, s[4:7], s71 offen offset:768
L_stl_2:
    s_mov_b32 s59, 0
    s_lshl_b32 s64, s59, 7
    s_add_u32 s64, s64, s53
    s_mul_i32 s65, s59, 229376
    s_add_u32 s65, s65, s54
    s_add_u32 m0, s52, 0
    s_add_u32 s59, s64, 0
    buffer_load_dwordx4 v38, s[4:7], s59 offen lds
    s_add_u32 m0, s52, 1024
    s_add_u32 s59, s64, 262144
    buffer_load_dwordx4 v39, s[4:7], s59 offen lds
    s_add_u32 m0, s52, 2048
    s_add_u32 s59, s64, 524288
    buffer_load_dwordx4 v38, s[4:7], s59 offen lds
    s_add_u32 m0, s52, 3072
    s_add_u32 s59, s64, 786432
    buffer_load_dwordx4 v39, s[4:7], s59 offen lds
    s_add_u32 m0, s52, 16384
    s_add_u32 s59, s65, 0
    buffer_load_dwordx4 v40, s[8:11], s59 offen lds
    s_add_u32 m0, s52, 17408
    s_add_u32 s59, s65, 14336
    buffer_load_dwordx4 v40, s[8:11], s59 offen lds
    s_add_u32 m0, s52, 18432
    s_add_u32 s59, s65, 28672
    buffer_load_dwordx4 v40, s[8:11], s59 offen lds
    s_add_u32 m0, s52, 19456
    s_add_u32 s59, s65, 43008
    buffer_load_dwordx4 v40, s[8:11], s59 offen lds
    s_add_u32 m0, s52, 32768
    s_add_u32 s59, s65, 0
    buffer_load_dwordx4 v41, s[12:15], s59 offen lds
    s_add_u32 m0, s52, 33792
    s_add_u32 s59, s65, 14336
    buffer_load_dwordx4 v41, s[12:15], s59 offen lds
    s_add_u32 m0, s52, 34816
    s_add_u32 s59, s65, 28672
    buffer_load_dwordx4 v41, s[12:15], s59 offen lds
    s_add_u32 m0, s52, 35840
    s_add_u32 s59, s65, 43008
    buffer_load_dwordx4 v41, s[12:15], s59 offen lds
    s_getpc_b64 s[70:71]
L_cpf_3:
    s_sub_u32 s70, s70, L_cpf_3-parallel_sum__spectral_gfnet__glu_gated_swiglu__prompt_kernel
    s_subb_u32 s71, s71, 0
    s_lshr_b32 s72, s2, 3
    s_lshl_b32 s72, s72, 2
    s_add_u32 s72, s72, s44
    s_lshl_b32 s72, s72, 9
    s_add_u32 s73, s72, 0
    s_min_u32 s73, s73, L_end-parallel_sum__spectral_gfnet__glu_gated_swiglu__prompt_kernel
    s_load_dword s69, s[70:71], s73
    s_add_u32 s73, s72, 128
    s_min_u32 s73, s73, L_end-parallel_sum__spectral_gfnet__glu_gated_swiglu__prompt_kernel
    s_load_dword s69, s[70:71], s73
    s_add_u32 s73, s72, 256
    s_min_u32 s73, s73, L_end-parallel_sum__spectral_gfnet__glu_gated_swiglu__prompt_kernel
    s_load_dword s69, s[70:71], s73
    s_add_u32 s73, s72, 384
    s_min_u32 s73, s73, L_end-parallel_sum__spectral_gfnet__glu_gated_swiglu__prompt_kernel
    s_load_dword s69, s[70:71], s73
    s_mov_b32 s40, s96
    s_and_b32 s41, s97, 0xffff
    s_mov_b32 s42, 256
    s_mov_b32 s43, 0x20000
    s_mov_b32 s20, s98
    s_and_b32 s21, s99, 0xffff
    s_mov_b32 s22, 33554432
    s_mov_b32 s23, 0x20000
    s_mov_b32 s32, s88
    s_and_b32 s33, s89, 0xffff
    s_mov_b32 s34, 1052672
    s_mov_b32 s35, 0x20000
    s_mov_b32 s36, s90
    s_and_b32 s37, s91, 0xffff
    s_mov_b32 s38, 1052672
    s_mov_b32 s39, 0x20000
    s_mov_b32 s16, s92
    s_and_b32 s17, s93, 0xffff
    s_mov_b32 s18, 1835008
    s_mov_b32 s19, 0x20000
    s_mov_b32 s24, s94
    s_and_b32 s25, s95, 0xffff
    s_mov_b32 s26, 2097152
    s_mov_b32 s27, 0x20000
    v_lshrrev_b32 v8, 1, v2
    v_and_b32 v8, 7, v8
    v_xor_b32 v8, v8, v3
    v_lshlrev_b32 v9, 7, v2
    s_lshl_b32 s55, s61, 13
    v_add_u32 v9, s55, v9
    v_xor_b32 v44, 0, v8
    v_lshl_add_u32 v10, v44, 4, v9
    v_add_u32 v14, 49152, v10
    v_add_u32 v18, 98304, v10
    v_xor_b32 v44, 2, v8
    v_lshl_add_u32 v11, v44, 4, v9
    v_add_u32 v15, 49152, v11
    v_add_u32 v19, 98304, v11
    v_xor_b32 v44, 4, v8
    v_lshl_add_u32 v12, v44, 4, v9
    v_add_u32 v16, 49152, v12
    v_add_u32 v20, 98304, v12
    v_xor_b32 v44, 6, v8
    v_lshl_add_u32 v13, v44, 4, v9
    v_add_u32 v17, 49152, v13
    v_add_u32 v21, 98304, v13
    v_lshrrev_b32 v8, 2, v4
    v_and_b32 v9, 1, v5
    v_lshl_add_u32 v44, v3, 3, v8
    v_lshlrev_b32 v44, 8, v44
    v_lshl_add_u32 v44, v9, 14, v44
    v_and_b32 v45, 3, v4
    v_lshl_add_u32 v44, v45, 3, v44
    v_add_u32 v44, 16384, v44
    v_lshl_or_b32 v8, v9, 2, v8
    s_lshl_b32 s55, s60, 2
    v_xor_b32 v8, s55, v8
    v_xor_b32 v45, 0, v8
    v_lshl_add_u32 v22, v45, 5, v44
    v_add_u32 v26, 49152, v22
    v_add_u32 v30, 98304, v22
    v_xor_b32 v45, 1, v8
    v_lshl_add_u32 v23, v45, 5, v44
    v_add_u32 v27, 49152, v23
    v_add_u32 v31, 98304, v23
    v_xor_b32 v45, 2, v8
    v_lshl_add_u32 v24, v45, 5, v44
    v_add_u32 v28, 49152, v24
    v_add_u32 v32, 98304, v24
    v_xor_b32 v45, 3, v8
    v_lshl_add_u32 v25, v45, 5, v44
    v_add_u32 v29, 49152, v25
    v_add_u32 v33, 98304, v25
    s_lshl_b32 s55, s60, 4
    v_add_u32 v96, s55, v4
    v_cvt_f32_u32 v96, v96
    v_mul_f32 v96, 0x3d000000, v96
    v_lshlrev_b32 v100, 2, v3
    v_cvt_f32_u32 v101, v100
    v_mul_f32 v98, v96, v101
    v_cmp_lt_u32 vcc, 15, v2
    v_mov_b32 v99, 0
    v_mov_b32 v100, 0x3e800000
    v_cndmask_b32 v99, v99, v100, vcc
    v_add_f32 v98, v98, v99
    v_mov_b32 v102, v98
    v_fmamk_f32 v104, v96, 0x3f800000, v98
    v_cos_f32 v103, v102
    v_sin_f32 v102, v102
    v_cos_f32 v105, v104
    v_sin_f32 v104, v104
    v_cvt_pk_bf16_f32 v102, v103, v102
    v_cvt_pk_bf16_f32 v104, v105, v104
    v_accvgpr_write_b32 a80, v102
    v_accvgpr_write_b32 a81, v104
    v_fmamk_f32 v102, v96, 0x40000000, v98
    v_fmamk_f32 v104, v96, 0x40400000, v98
    v_cos_f32 v103, v102
    v_sin_f32 v102, v102
    v_cos_f32 v105, v104
    v_sin_f32 v104, v104
    v_cvt_pk_bf16_f32 v102, v103, v102
    v_cvt_pk_bf16_f32 v104, v105, v104
    v_accvgpr_write_b32 a82, v102
    v_accvgpr_write_b32 a83, v104
    v_fmamk_f32 v102, v96, 0x41000000, v98
    v_fmamk_f32 v104, v96, 0x41100000, v98
    v_cos_f32 v103, v102
    v_sin_f32 v102, v102
    v_cos_f32 v105, v104
    v_sin_f32 v104, v104
    v_cvt_pk_bf16_f32 v102, v103, v102
    v_cvt_pk_bf16_f32 v104, v105, v104
    v_accvgpr_write_b32 a84, v102
    v_accvgpr_write_b32 a85, v104
    v_fmamk_f32 v102, v96, 0x41200000, v98
    v_fmamk_f32 v104, v96, 0x41300000, v98
    v_cos_f32 v103, v102
    v_sin_f32 v102, v102
    v_cos_f32 v105, v104
    v_sin_f32 v104, v104
    v_cvt_pk_bf16_f32 v102, v103, v102
    v_cvt_pk_bf16_f32 v104, v105, v104
    v_accvgpr_write_b32 a86, v102
    v_accvgpr_write_b32 a87, v104
    v_fmamk_f32 v102, v96, 0x41800000, v98
    v_fmamk_f32 v104, v96, 0x41880000, v98
    v_cos_f32 v103, v102
    v_sin_f32 v102, v102
    v_cos_f32 v105, v104
    v_sin_f32 v104, v104
    v_cvt_pk_bf16_f32 v102, v103, v102
    v_cvt_pk_bf16_f32 v104, v105, v104
    v_accvgpr_write_b32 a88, v102
    v_accvgpr_write_b32 a89, v104
    v_fmamk_f32 v102, v96, 0x41900000, v98
    v_fmamk_f32 v104, v96, 0x41980000, v98
    v_cos_f32 v103, v102
    v_sin_f32 v102, v102
    v_cos_f32 v105, v104
    v_sin_f32 v104, v104
    v_cvt_pk_bf16_f32 v102, v103, v102
    v_cvt_pk_bf16_f32 v104, v105, v104
    v_accvgpr_write_b32 a90, v102
    v_accvgpr_write_b32 a91, v104
    v_fmamk_f32 v102, v96, 0x41c00000, v98
    v_fmamk_f32 v104, v96, 0x41c80000, v98
    v_cos_f32 v103, v102
    v_sin_f32 v102, v102
    v_cos_f32 v105, v104
    v_sin_f32 v104, v104
    v_cvt_pk_bf16_f32 v102, v103, v102
    v_cvt_pk_bf16_f32 v104, v105, v104
    v_accvgpr_write_b32 a92, v102
    v_accvgpr_write_b32 a93, v104
    v_fmamk_f32 v102, v96, 0x41d00000, v98
    v_fmamk_f32 v104, v96, 0x41d80000, v98
    v_cos_f32 v103, v102
    v_sin_f32 v102, v102
    v_cos_f32 v105, v104
    v_sin_f32 v104, v104
    v_cvt_pk_bf16_f32 v102, v103, v102
    v_cvt_pk_bf16_f32 v104, v105, v104
    v_accvgpr_write_b32 a94, v102
    v_accvgpr_write_b32 a95, v104
    s_cmp_lt_u32 s46, 4
    s_cbranch_scc0 L_stc_4
    v_mov_b32 v124, 0x3f803f80
    s_waitcnt vmcnt(12)
    v_dot2_f32_bf16 v108, v48, v124, 0
    v_dot2_f32_bf16 v109, v48, v48, 0
    v_dot2_f32_bf16 v110, v64, v124, 0
    v_dot2_f32_bf16 v111, v64, v64, 0
    v_dot2_f32_bf16 v108, v49, v124, v108
    v_dot2_f32_bf16 v109, v49, v49, v109
    v_dot2_f32_bf16 v110, v65, v124, v110
    v_dot2_f32_bf16 v111, v65, v65, v111
    v_dot2_f32_bf16 v108, v50, v124, v108
    v_dot2_f32_bf16 v109, v50, v50, v109
    v_dot2_f32_bf16 v110, v66, v124, v110
    v_dot2_f32_bf16 v111, v66, v66, v111
    v_dot2_f32_bf16 v108, v51, v124, v108
    v_dot2_f32_bf16 v109, v51, v51, v109
    v_dot2_f32_bf16 v110, v67, v124, v110
    v_dot2_f32_bf16 v111, v67, v67, v111
    v_dot2_f32_bf16 v108, v52, v124, v108
    v_dot2_f32_bf16 v109, v52, v52, v109
    v_dot2_f32_bf16 v110, v68, v124, v110
    v_dot2_f32_bf16 v111, v68, v68, v111
    v_dot2_f32_bf16 v108, v53, v124, v108
    v_dot2_f32_bf16 v109, v53, v53, v109
    v_dot2_f32_bf16 v110, v69, v124, v110
    v_dot2_f32_bf16 v111, v69, v69, v111
    v_dot2_f32_bf16 v108, v54, v124, v108
    v_dot2_f32_bf16 v109, v54, v54, v109
    v_dot2_f32_bf16 v110, v70, v124, v110
    v_dot2_f32_bf16 v111, v70, v70, v111
    v_dot2_f32_bf16 v108, v55, v124, v108
    v_dot2_f32_bf16 v109, v55, v55, v109
    v_dot2_f32_bf16 v110, v71, v124, v110
    v_dot2_f32_bf16 v111, v71, v71, v111
    v_dot2_f32_bf16 v108, v56, v124, v108
    v_dot2_f32_bf16 v109, v56, v56, v109
    v_dot2_f32_bf16 v110, v72, v124, v110
    v_dot2_f32_bf16 v111, v72, v72, v111
    v_dot2_f32_bf16 v108, v57, v124, v108
    v_dot2_f32_bf16 v109, v57, v57, v109
    v_dot2_f32_bf16 v110, v73, v124, v110
    v_dot2_f32_bf16 v111, v73, v73, v111
    v_dot2_f32_bf16 v108, v58, v124, v108
    v_dot2_f32_bf16 v109, v58, v58, v109
    v_dot2_f32_bf16 v110, v74, v124, v110
    v_dot2_f32_bf16 v111, v74, v74, v111
    v_dot2_f32_bf16 v108, v59, v124, v108
    v_dot2_f32_bf16 v109, v59, v59, v109
    v_dot2_f32_bf16 v110, v75, v124, v110
    v_dot2_f32_bf16 v111, v75, v75, v111
    v_dot2_f32_bf16 v108, v60, v124, v108
    v_dot2_f32_bf16 v109, v60, v60, v109
    v_dot2_f32_bf16 v110, v76, v124, v110
    v_dot2_f32_bf16 v111, v76, v76, v111
    v_dot2_f32_bf16 v108, v61, v124, v108
    v_dot2_f32_bf16 v109, v61, v61, v109
    v_dot2_f32_bf16 v110, v77, v124, v110
    v_dot2_f32_bf16 v111, v77, v77, v111
    v_dot2_f32_bf16 v108, v62, v124, v108
    v_dot2_f32_bf16 v109, v62, v62, v109
    v_dot2_f32_bf16 v110, v78, v124, v110
    v_dot2_f32_bf16 v111, v78, v78, v111
    v_dot2_f32_bf16 v108, v63, v124, v108
    v_dot2_f32_bf16 v109, v63, v63, v109
    v_dot2_f32_bf16 v110, v79, v124, v110
    v_dot2_f32_bf16 v111, v79, v79, v111
    v_add_f32_dpp v108, v108, v108 row_shr:1 row_mask:0xf bank_mask:0xf bound_ctrl:0
    v_add_f32_dpp v109, v109, v109 row_shr:1 row_mask:0xf bank_mask:0xf bound_ctrl:0
    v_add_f32_dpp v110, v110, v110 row_shr:1 row_mask:0xf bank_mask:0xf bound_ctrl:0
    v_add_f32_dpp v111, v111, v111 row_shr:1 row_mask:0xf bank_mask:0xf bound_ctrl:0
    v_add_f32_dpp v108, v108, v108 row_shr:2 row_mask:0xf bank_mask:0xf bound_ctrl:0
    v_add_f32_dpp v109, v109, v109 row_shr:2 row_mask:0xf bank_mask:0xf bound_ctrl:0
    v_add_f32_dpp v110, v110, v110 row_shr:2 row_mask:0xf bank_mask:0xf bound_ctrl:0
    v_add_f32_dpp v111, v111, v111 row_shr:2 row_mask:0xf bank_mask:0xf bound_ctrl:0
    v_add_f32_dpp v108, v108, v108 row_shr:4 row_mask:0xf bank_mask:0xf bound_ctrl:0
    v_add_f32_dpp v109, v109, v109 row_shr:4 row_mask:0xf bank_mask:0xf bound_ctrl:0
    v_add_f32_dpp v110, v110, v110 row_shr:4 row_mask:0xf bank_mask:0xf bound_ctrl:0
    v_add_f32_dpp v111, v111, v111 row_shr:4 row_mask:0xf bank_mask:0xf bound_ctrl:0
    v_add_f32_dpp v108, v108, v108 row_shr:8 row_mask:0xf bank_mask:0xf bound_ctrl:0
    v_add_f32_dpp v109, v109, v109 row_shr:8 row_mask:0xf bank_mask:0xf bound_ctrl:0
    v_add_f32_dpp v110, v110, v110 row_shr:8 row_mask:0xf bank_mask:0xf bound_ctrl:0
    v_add_f32_dpp v111, v111, v111 row_shr:8 row_mask:0xf bank_mask:0xf bound_ctrl:0
    v_mul_f32 v116, 0x3b000000, v108
    v_mul_f32 v118, 0x3b000000, v109
    v_fma_f32 v118, -v116, v116, v118
    v_max_f32 v118, 0, v118
    v_add_f32 v118, 0x3727c5ac, v118
    v_rsq_f32 v117, v118
    v_mul_f32 v112, 0x3b000000, v110
    v_mul_f32 v114, 0x3b000000, v111
    v_fma_f32 v114, -v112, v112, v114
    v_max_f32 v114, 0, v114
    v_add_f32 v114, 0x3727c5ac, v114
    v_rsq_f32 v113, v114
L_stc_4:
    s_mov_b32 s59, 1
    s_lshl_b32 s64, s59, 7
    s_add_u32 s64, s64, s53
    s_mul_i32 s65, s59, 229376
    s_add_u32 s65, s65, s54
    s_add_u32 m0, s52, 49152
    s_add_u32 s59, s64, 0
    buffer_load_dwordx4 v38, s[4:7], s59 offen lds
    s_add_u32 m0, s52, 50176
    s_add_u32 s59, s64, 262144
    buffer_load_dwordx4 v39, s[4:7], s59 offen lds
    s_add_u32 m0, s52, 51200
    s_add_u32 s59, s64, 524288
    buffer_load_dwordx4 v38, s[4:7], s59 offen lds
    s_add_u32 m0, s52, 52224
    s_add_u32 s59, s64, 786432
    buffer_load_dwordx4 v39, s[4:7], s59 offen lds
    s_add_u32 m0, s52, 65536
    s_add_u32 s59, s65, 0
    buffer_load_dwordx4 v40, s[8:11], s59 offen lds
    s_add_u32 m0, s52, 66560
    s_add_u32 s59, s65, 14336
    buffer_load_dwordx4 v40, s[8:11], s59 offen lds
    s_add_u32 m0, s52, 67584
    s_add_u32 s59, s65, 28672
    buffer_load_dwordx4 v40, s[8:11], s59 offen lds
    s_add_u32 m0, s52, 68608
    s_add_u32 s59, s65, 43008
    buffer_load_dwordx4 v40, s[8:11], s59 offen lds
    s_add_u32 m0, s52, 81920
    s_add_u32 s59, s65, 0
    buffer_load_dwordx4 v41, s[12:15], s59 offen lds
    s_add_u32 m0, s52, 82944
    s_add_u32 s59, s65, 14336
    buffer_load_dwordx4 v41, s[12:15], s59 offen lds
    s_add_u32 m0, s52, 83968
    s_add_u32 s59, s65, 28672
    buffer_load_dwordx4 v41, s[12:15], s59 offen lds
    s_add_u32 m0, s52, 84992
    s_add_u32 s59, s65, 43008
    buffer_load_dwordx4 v41, s[12:15], s59 offen lds
    s_waitcnt vmcnt(12)
    s_barrier
    ds_read_b128 v[64:67], v10
    ds_read_b64_tr_b16 v[48:49], v22 offset:0
    ds_read_b64_tr_b16 v[50:51], v22 offset:1024
    ds_read_b128 v[68:71], v10 offset:4096
    ds_read_b64_tr_b16 v[52:53], v23 offset:0
    ds_read_b64_tr_b16 v[54:55], v23 offset:1024
    ds_read_b64_tr_b16 v[56:57], v24 offset:0
    ds_read_b64_tr_b16 v[58:59], v24 offset:1024
    ds_read_b64_tr_b16 v[60:61], v25 offset:0
    ds_read_b64_tr_b16 v[62:63], v25 offset:1024
    s_waitcnt lgkmcnt(0)
    v_mfma_f32_32x32x16_bf16 v[128:143], v[48:51], v[64:67], 0
    ds_read_b128 v[88:91], v11
    ds_read_b64_tr_b16 v[72:73], v22 offset:4096
    ds_read_b64_tr_b16 v[74:75], v22 offset:5120
    s_mov_b32 s59, 2
    s_lshl_b32 s64, s59, 7
    s_add_u32 s64, s64, s53
    v_mfma_f32_32x32x16_bf16 v[144:159], v[48:51], v[68:71], 0
    ds_read_b128 v[92:95], v11 offset:4096
    ds_read_b64_tr_b16 v[76:77], v23 offset:4096
    ds_read_b64_tr_b16 v[78:79], v23 offset:5120
    s_mul_i32 s65, s59, 229376
    s_add_u32 s65, s65, s54
    v_mov_b32 v44, 0
    v_mfma_f32_32x32x16_bf16 v[160:175], v[52:55], v[64:67], 0
    ds_read_b64_tr_b16 v[80:81], v24 offset:4096
    ds_read_b64_tr_b16 v[82:83], v24 offset:5120
    ds_read_b64_tr_b16 v[84:85], v25 offset:4096
    v_cmp_gt_u32 vcc, 1, v0
    v_mov_b32 v47, 2147483632
    s_nop 0
    v_cndmask_b32 v43, v47, v44, vcc
    v_mfma_f32_32x32x16_bf16 v[176:191], v[52:55], v[68:71], 0
    ds_read_b64_tr_b16 v[86:87], v25 offset:5120
    buffer_load_dword v46, v43, s[40:43], 0 offen sc1
    v_mfma_f32_32x32x16_bf16 v[192:207], v[56:59], v[64:67], 0
    s_add_u32 m0, s52, 98304
    s_add_u32 s59, s64, 0
    buffer_load_dwordx4 v38, s[4:7], s59 offen lds
    v_mfma_f32_32x32x16_bf16 v[208:223], v[56:59], v[68:71], 0
    s_add_u32 m0, s52, 99328
    s_add_u32 s59, s64, 262144
    buffer_load_dwordx4 v39, s[4:7], s59 offen lds
    v_mfma_f32_32x32x16_bf16 v[224:239], v[60:63], v[64:67], 0
    s_add_u32 m0, s52, 100352
    s_add_u32 s59, s64, 524288
    buffer_load_dwordx4 v38, s[4:7], s59 offen lds
    v_mfma_f32_32x32x16_bf16 v[240:255], v[60:63], v[68:71], 0
    s_add_u32 m0, s52, 101376
    s_add_u32 s59, s64, 786432
    buffer_load_dwordx4 v39, s[4:7], s59 offen lds
    s_waitcnt lgkmcnt(0)
    v_mfma_f32_32x32x16_bf16 v[128:143], v[72:75], v[88:91], v[128:143]
    ds_read_b128 v[64:67], v12
    ds_read_b64_tr_b16 v[48:49], v22 offset:8192
    ds_read_b64_tr_b16 v[50:51], v22 offset:9216
    v_mfma_f32_32x32x16_bf16 v[144:159], v[72:75], v[92:95], v[144:159]
    ds_read_b128 v[68:71], v12 offset:4096
    ds_read_b64_tr_b16 v[52:53], v23 offset:8192
    ds_read_b64_tr_b16 v[54:55], v23 offset:9216
    v_mfma_f32_32x32x16_bf16 v[160:175], v[76:79], v[88:91], v[160:175]
    ds_read_b64_tr_b16 v[56:57], v24 offset:8192
    ds_read_b64_tr_b16 v[58:59], v24 offset:9216
    ds_read_b64_tr_b16 v[60:61], v25 offset:8192
    v_mfma_f32_32x32x16_bf16 v[176:191], v[76:79], v[92:95], v[176:191]
    ds_read_b64_tr_b16 v[62:63], v25 offset:9216
    v_mfma_f32_32x32x16_bf16 v[192:207], v[80:83], v[88:91], v[192:207]
    s_add_u32 m0, s52, 114688
    s_add_u32 s59, s65, 0
    buffer_load_dwordx4 v40, s[8:11], s59 offen lds
    v_mfma_f32_32x32x16_bf16 v[208:223], v[80:83], v[92:95], v[208:223]
    s_add_u32 m0, s52, 115712
    s_add_u32 s59, s65, 14336
    buffer_load_dwordx4 v40, s[8:11], s59 offen lds
    v_mfma_f32_32x32x16_bf16 v[224:239], v[84:87], v[88:91], v[224:239]
    s_add_u32 m0, s52, 116736
    s_add_u32 s59, s65, 28672
    buffer_load_dwordx4 v40, s[8:11], s59 offen lds
    v_mfma_f32_32x32x16_bf16 v[240:255], v[84:87], v[92:95], v[240:255]
    s_add_u32 m0, s52, 117760
    s_add_u32 s59, s65, 43008
    buffer_load_dwordx4 v40, s[8:11], s59 offen lds
    s_waitcnt lgkmcnt(0)
    v_mfma_f32_32x32x16_bf16 v[128:143], v[48:51], v[64:67], v[128:143]
    ds_read_b128 v[88:91], v13
    ds_read_b64_tr_b16 v[72:73], v22 offset:12288
    ds_read_b64_tr_b16 v[74:75], v22 offset:13312
    v_mfma_f32_32x32x16_bf16 v[144:159], v[48:51], v[68:71], v[144:159]
    ds_read_b128 v[92:95], v13 offset:4096
    ds_read_b64_tr_b16 v[76:77], v23 offset:12288
    ds_read_b64_tr_b16 v[78:79], v23 offset:13312
    v_mfma_f32_32x32x16_bf16 v[160:175], v[52:55], v[64:67], v[160:175]
    ds_read_b64_tr_b16 v[80:81], v24 offset:12288
    ds_read_b64_tr_b16 v[82:83], v24 offset:13312
    ds_read_b64_tr_b16 v[84:85], v25 offset:12288
    v_mfma_f32_32x32x16_bf16 v[176:191], v[52:55], v[68:71], v[176:191]
    ds_read_b64_tr_b16 v[86:87], v25 offset:13312
    v_mfma_f32_32x32x16_bf16 v[192:207], v[56:59], v[64:67], v[192:207]
    s_add_u32 m0, s52, 131072
    s_add_u32 s59, s65, 0
    buffer_load_dwordx4 v41, s[12:15], s59 offen lds
    v_mfma_f32_32x32x16_bf16 v[208:223], v[56:59], v[68:71], v[208:223]
    s_add_u32 m0, s52, 132096
    s_add_u32 s59, s65, 14336
    buffer_load_dwordx4 v41, s[12:15], s59 offen lds
    v_mfma_f32_32x32x16_bf16 v[224:239], v[60:63], v[64:67], v[224:239]
    s_add_u32 m0, s52, 133120
    s_add_u32 s59, s65, 28672
    buffer_load_dwordx4 v41, s[12:15], s59 offen lds
    v_mfma_f32_32x32x16_bf16 v[240:255], v[60:63], v[68:71], v[240:255]
    s_add_u32 m0, s52, 134144
    s_add_u32 s59, s65, 43008
    buffer_load_dwordx4 v41, s[12:15], s59 offen lds
    s_waitcnt lgkmcnt(0)
    s_waitcnt vmcnt(13)
    s_waitcnt vmcnt(12)
    v_readfirstlane_b32 s51, v46
    s_cmp_eq_u32 s2, 0
    s_cselect_b32 s51, s74, s51
    s_or_b32 s70, s51, s44
    s_cmp_eq_u32 s70, 0
    s_cbranch_scc1 L_nslow_5
L_nback_6:
    s_lshl_b32 s70, s44, 2
    s_add_u32 s70, s70, 149504
    v_mov_b32 v44, s70
    v_mov_b32 v45, s51
    ds_write_b32 v44, v45
    s_waitcnt lgkmcnt(0)
    s_barrier
    v_mov_b32 v44, 149504
    ds_read_b32 v46, v44
    v_mfma_f32_32x32x16_bf16 v[128:143], v[72:75], v[88:91], v[128:143]
    ds_read_b128 v[64:67], v14
    ds_read_b64_tr_b16 v[48:49], v26 offset:0
    ds_read_b64_tr_b16 v[50:51], v26 offset:1024
    s_mov_b32 s59, 3
    s_lshl_b32 s64, s59, 7
    s_add_u32 s64, s64, s53
    v_mfma_f32_32x32x16_bf16 v[144:159], v[72:75], v[92:95], v[144:159]
    ds_read_b128 v[68:71], v14 offset:4096
    ds_read_b64_tr_b16 v[52:53], v27 offset:0
    ds_read_b64_tr_b16 v[54:55], v27 offset:1024
    s_mul_i32 s65, s59, 229376
    s_add_u32 s65, s65, s54
    v_mfma_f32_32x32x16_bf16 v[160:175], v[76:79], v[88:91], v[160:175]
    ds_read_b64_tr_b16 v[56:57], v28 offset:0
    ds_read_b64_tr_b16 v[58:59], v28 offset:1024
    ds_read_b64_tr_b16 v[60:61], v29 offset:0
    v_mfma_f32_32x32x16_bf16 v[176:191], v[76:79], v[92:95], v[176:191]
    ds_read_b64_tr_b16 v[62:63], v29 offset:1024
    v_mfma_f32_32x32x16_bf16 v[192:207], v[80:83], v[88:91], v[192:207]
    s_add_u32 m0, s52, 0
    s_add_u32 s59, s64, 0
    buffer_load_dwordx4 v38, s[4:7], s59 offen lds
    v_mfma_f32_32x32x16_bf16 v[208:223], v[80:83], v[92:95], v[208:223]
    s_add_u32 m0, s52, 1024
    s_add_u32 s59, s64, 262144
    buffer_load_dwordx4 v39, s[4:7], s59 offen lds
    v_mfma_f32_32x32x16_bf16 v[224:239], v[84:87], v[88:91], v[224:239]
    s_add_u32 m0, s52, 2048
    s_add_u32 s59, s64, 524288
    buffer_load_dwordx4 v38, s[4:7], s59 offen lds
    v_mfma_f32_32x32x16_bf16 v[240:255], v[84:87], v[92:95], v[240:255]
    s_add_u32 m0, s52, 3072
    s_add_u32 s59, s64, 786432
    buffer_load_dwordx4 v39, s[4:7], s59 offen lds
    s_waitcnt lgkmcnt(0)
    v_mfma_f32_32x32x16_bf16 v[128:143], v[48:51], v[64:67], v[128:143]
    ds_read_b128 v[88:91], v15
    ds_read_b64_tr_b16 v[72:73], v26 offset:4096
    ds_read_b64_tr_b16 v[74:75], v26 offset:5120
    s_cmp_lt_u32 s46, 4
    s_cbranch_scc0 L_gd_8
    v_mov_b32 v119, v46
    s_lshl_b32 s70, s45, 11
    s_add_u32 s70, s70, 0
    v_lshlrev_b32 v122, 4, v122
    v_cmp_eq_u32 vcc, 15, v4
    v_mov_b32 v124, 2147483632
    s_nop 0
    v_cndmask_b32 v124, v124, v122, vcc
    buffer_store_dwordx4 v[116:119], v124, s[20:23], s70 offen sc1
L_gd_8:
    v_mfma_f32_32x32x16_bf16 v[144:159], v[48:51], v[68:71], v[144:159]
    ds_read_b128 v[92:95], v15 offset:4096
    ds_read_b64_tr_b16 v[76:77], v27 offset:4096
    ds_read_b64_tr_b16 v[78:79], v27 offset:5120
    s_cmp_lt_u32 s46, 4
    s_cbranch_scc0 L_gd_9
    v_mov_b32 v115, v46
    s_lshl_b32 s70, s45, 11
    s_add_u32 s70, s70, 0
    v_lshlrev_b32 v123, 4, v123
    v_cmp_eq_u32 vcc, 15, v4
    v_mov_b32 v124, 2147483632
    s_nop 0
    v_cndmask_b32 v124, v124, v123, vcc
    buffer_store_dwordx4 v[112:115], v124, s[20:23], s70 offen sc1
L_gd_9:
    v_mfma_f32_32x32x16_bf16 v[160:175], v[52:55], v[64:67], v[160:175]
    ds_read_b64_tr_b16 v[80:81], v28 offset:4096
    ds_read_b64_tr_b16 v[82:83], v28 offset:5120
    ds_read_b64_tr_b16 v[84:85], v29 offset:4096
    v_mfma_f32_32x32x16_bf16 v[176:191], v[52:55], v[68:71], v[176:191]
    ds_read_b64_tr_b16 v[86:87], v29 offset:5120
    v_mfma_f32_32x32x16_bf16 v[192:207], v[56:59], v[64:67], v[192:207]
    s_add_u32 m0, s52, 16384
    s_add_u32 s59, s65, 0
    buffer_load_dwordx4 v40, s[8:11], s59 offen lds
    v_mfma_f32_32x32x16_bf16 v[208:223], v[56:59], v[68:71], v[208:223]
    s_add_u32 m0, s52, 17408
    s_add_u32 s59, s65, 14336
    buffer_load_dwordx4 v40, s[8:11], s59 offen lds
    v_mfma_f32_32x32x16_bf16 v[224:239], v[60:63], v[64:67], v[224:239]
    s_add_u32 m0, s52, 18432
    s_add_u32 s59, s65, 28672
    buffer_load_dwordx4 v40, s[8:11], s59 offen lds
    v_mfma_f32_32x32x16_bf16 v[240:255], v[60:63], v[68:71], v[240:255]
    s_add_u32 m0, s52, 19456
    s_add_u32 s59, s65, 43008
    buffer_load_dwordx4 v40, s[8:11], s59 offen lds
    s_waitcnt lgkmcnt(0)
    v_mfma_f32_32x32x16_bf16 v[128:143], v[72:75], v[88:91], v[128:143]
    ds_read_b128 v[64:67], v16
    ds_read_b64_tr_b16 v[48:49], v26 offset:8192
    ds_read_b64_tr_b16 v[50:51], v26 offset:9216
    v_mfma_f32_32x32x16_bf16 v[144:159], v[72:75], v[92:95], v[144:159]
    ds_read_b128 v[68:71], v16 offset:4096
    ds_read_b64_tr_b16 v[52:53], v27 offset:8192
    ds_read_b64_tr_b16 v[54:55], v27 offset:9216
    v_mfma_f32_32x32x16_bf16 v[160:175], v[76:79], v[88:91], v[160:175]
    ds_read_b64_tr_b16 v[56:57], v28 offset:8192
    ds_read_b64_tr_b16 v[58:59], v28 offset:9216
    ds_read_b64_tr_b16 v[60:61], v29 offset:8192
    v_mfma_f32_32x32x16_bf16 v[176:191], v[76:79], v[92:95], v[176:191]
    ds_read_b64_tr_b16 v[62:63], v29 offset:9216
    v_mfma_f32_32x32x16_bf16 v[192:207], v[80:83], v[88:91], v[192:207]
    s_add_u32 m0, s52, 32768
    s_add_u32 s59, s65, 0
    buffer_load_dwordx4 v41, s[12:15], s59 offen lds
    v_mfma_f32_32x32x16_bf16 v[208:223], v[80:83], v[92:95], v[208:223]
    s_add_u32 m0, s52, 33792
    s_add_u32 s59, s65, 14336
    buffer_load_dwordx4 v41, s[12:15], s59 offen lds
    v_mfma_f32_32x32x16_bf16 v[224:239], v[84:87], v[88:91], v[224:239]
    s_add_u32 m0, s52, 34816
    s_add_u32 s59, s65, 28672
    buffer_load_dwordx4 v41, s[12:15], s59 offen lds
    v_mfma_f32_32x32x16_bf16 v[240:255], v[84:87], v[92:95], v[240:255]
    s_add_u32 m0, s52, 35840
    s_add_u32 s59, s65, 43008
    buffer_load_dwordx4 v41, s[12:15], s59 offen lds
    s_waitcnt lgkmcnt(0)
    v_mfma_f32_32x32x16_bf16 v[128:143], v[48:51], v[64:67], v[128:143]
    ds_read_b128 v[88:91], v17
    ds_read_b64_tr_b16 v[72:73], v26 offset:12288
    ds_read_b64_tr_b16 v[74:75], v26 offset:13312
    v_mfma_f32_32x32x16_bf16 v[144:159], v[48:51], v[68:71], v[144:159]
    ds_read_b128 v[92:95], v17 offset:4096
    ds_read_b64_tr_b16 v[76:77], v27 offset:12288
    ds_read_b64_tr_b16 v[78:79], v27 offset:13312
    v_mfma_f32_32x32x16_bf16 v[160:175], v[52:55], v[64:67], v[160:175]
    ds_read_b64_tr_b16 v[80:81], v28 offset:12288
    ds_read_b64_tr_b16 v[82:83], v28 offset:13312
    ds_read_b64_tr_b16 v[84:85], v29 offset:12288
    v_mfma_f32_32x32x16_bf16 v[176:191], v[52:55], v[68:71], v[176:191]
    ds_read_b64_tr_b16 v[86:87], v29 offset:13312
    v_mfma_f32_32x32x16_bf16 v[192:207], v[56:59], v[64:67], v[192:207]
    s_mul_i32 s70, s45, 114688
    s_lshl_b32 s71, s62, 1
    s_add_u32 s70, s70, s71
    s_lshl_b32 s71, s61, 7
    s_add_u32 s70, s70, s71
    s_movk_i32 s71, 3584
    v_mul_lo_u32 v45, v7, s71
    v_lshl_add_u32 v45, v6, 4, v45
    s_cmp_eq_u32 s60, 0
    s_cbranch_scc0 L_cl1_10
    s_add_u32 s71, s70, 0
    buffer_load_dwordx4 a[0:3], v45, s[8:11], s71 offen
    s_add_u32 s71, s70, 28672
    buffer_load_dwordx4 a[4:7], v45, s[8:11], s71 offen
    s_add_u32 s71, s70, 57344
    buffer_load_dwordx4 a[8:11], v45, s[8:11], s71 offen
    s_add_u32 s71, s70, 86016
    buffer_load_dwordx4 a[12:15], v45, s[8:11], s71 offen
    s_branch L_cl2_11
L_cl1_10:
    s_add_u32 s71, s70, 0
    buffer_load_dwordx4 a[0:3], v45, s[12:15], s71 offen
    s_add_u32 s71, s70, 28672
    buffer_load_dwordx4 a[4:7], v45, s[12:15], s71 offen
    s_add_u32 s71, s70, 57344
    buffer_load_dwordx4 a[8:11], v45, s[12:15], s71 offen
    s_add_u32 s71, s70, 86016
    buffer_load_dwordx4 a[12:15], v45, s[12:15], s71 offen
L_cl2_11:
    v_mfma_f32_32x32x16_bf16 v[208:223], v[56:59], v[68:71], v[208:223]
    v_mfma_f32_32x32x16_bf16 v[224:239], v[60:63], v[64:67], v[224:239]
    v_mfma_f32_32x32x16_bf16 v[240:255], v[60:63], v[68:71], v[240:255]
    s_waitcnt lgkmcnt(0)
    s_waitcnt vmcnt(16)
    s_barrier
    v_mfma_f32_32x32x16_bf16 v[128:143], v[72:75], v[88:91], v[128:143]
    ds_read_b128 v[64:67], v18
    ds_read_b64_tr_b16 v[48:49], v30 offset:0
    ds_read_b64_tr_b16 v[50:51], v30 offset:1024
    s_mov_b32 s59, 4
    s_lshl_b32 s64, s59, 7
    s_add_u32 s64, s64, s53
    v_mfma_f32_32x32x16_bf16 v[144:159], v[72:75], v[92:95], v[144:159]
    ds_read_b128 v[68:71], v18 offset:4096
    ds_read_b64_tr_b16 v[52:53], v31 offset:0
    ds_read_b64_tr_b16 v[54:55], v31 offset:1024
    s_mul_i32 s65, s59, 229376
    s_add_u32 s65, s65, s54
    v_mfma_f32_32x32x16_bf16 v[160:175], v[76:79], v[88:91], v[160:175]
    ds_read_b64_tr_b16 v[56:57], v32 offset:0
    ds_read_b64_tr_b16 v[58:59], v32 offset:1024
    ds_read_b64_tr_b16 v[60:61], v33 offset:0
    v_mfma_f32_32x32x16_bf16 v[176:191], v[76:79], v[92:95], v[176:191]
    ds_read_b64_tr_b16 v[62:63], v33 offset:1024
    v_mfma_f32_32x32x16_bf16 v[192:207], v[80:83], v[88:91], v[192:207]
    s_add_u32 m0, s52, 49152
    s_add_u32 s59, s64, 0
    buffer_load_dwordx4 v38, s[4:7], s59 offen lds
    v_mfma_f32_32x32x16_bf16 v[208:223], v[80:83], v[92:95], v[208:223]
    s_add_u32 m0, s52, 50176
    s_add_u32 s59, s64, 262144
    buffer_load_dwordx4 v39, s[4:7], s59 offen lds
    v_mfma_f32_32x32x16_bf16 v[224:239], v[84:87], v[88:91], v[224:239]
    s_add_u32 m0, s52, 51200
    s_add_u32 s59, s64, 524288
    buffer_load_dwordx4 v38, s[4:7], s59 offen lds
    v_mfma_f32_32x32x16_bf16 v[240:255], v[84:87], v[92:95], v[240:255]
    s_add_u32 m0, s52, 52224
    s_add_u32 s59, s64, 786432
    buffer_load_dwordx4 v39, s[4:7], s59 offen lds
    s_waitcnt lgkmcnt(0)
    v_mfma_f32_32x32x16_bf16 v[128:143], v[48:51], v[64:67], v[128:143]
    ds_read_b128 v[88:91], v19
    ds_read_b64_tr_b16 v[72:73], v30 offset:4096
    ds_read_b64_tr_b16 v[74:75], v30 offset:5120
    v_mfma_f32_32x32x16_bf16 v[144:159], v[48:51], v[68:71], v[144:159]
    ds_read_b128 v[92:95], v19 offset:4096
    ds_read_b64_tr_b16 v[76:77], v31 offset:4096
    ds_read_b64_tr_b16 v[78:79], v31 offset:5120
    v_mfma_f32_32x32x16_bf16 v[160:175], v[52:55], v[64:67], v[160:175]
    ds_read_b64_tr_b16 v[80:81], v32 offset:4096
    ds_read_b64_tr_b16 v[82:83], v32 offset:5120
    ds_read_b64_tr_b16 v[84:85], v33 offset:4096
    v_mfma_f32_32x32x16_bf16 v[176:191], v[52:55], v[68:71], v[176:191]
    ds_read_b64_tr_b16 v[86:87], v33 offset:5120
    v_mfma_f32_32x32x16_bf16 v[192:207], v[56:59], v[64:67], v[192:207]
    s_add_u32 m0, s52, 65536
    s_add_u32 s59, s65, 0
    buffer_load_dwordx4 v40, s[8:11], s59 offen lds
    v_mfma_f32_32x32x16_bf16 v[208:223], v[56:59], v[68:71], v[208:223]
    s_add_u32 m0, s52, 66560
    s_add_u32 s59, s65, 14336
    buffer_load_dwordx4 v40, s[8:11], s59 offen lds
    v_mfma_f32_32x32x16_bf16 v[224:239], v[60:63], v[64:67], v[224:239]
    s_add_u32 m0, s52, 67584
    s_add_u32 s59, s65, 28672
    buffer_load_dwordx4 v40, s[8:11], s59 offen lds
    v_mfma_f32_32x32x16_bf16 v[240:255], v[60:63], v[68:71], v[240:255]
    s_add_u32 m0, s52, 68608
    s_add_u32 s59, s65, 43008
    buffer_load_dwordx4 v40, s[8:11], s59 offen lds
    s_waitcnt lgkmcnt(0)
    v_mfma_f32_32x32x16_bf16 v[128:143], v[72:75], v[88:91], v[128:143]
    ds_read_b128 v[64:67], v20
    ds_read_b64_tr_b16 v[48:49], v30 offset:8192
    ds_read_b64_tr_b16 v[50:51], v30 offset:9216
    v_mfma_f32_32x32x16_bf16 v[144:159], v[72:75], v[92:95], v[144:159]
    ds_read_b128 v[68:71], v20 offset:4096
    ds_read_b64_tr_b16 v[52:53], v31 offset:8192
    ds_read_b64_tr_b16 v[54:55], v31 offset:9216
    v_mfma_f32_32x32x16_bf16 v[160:175], v[76:79], v[88:91], v[160:175]
    ds_read_b64_tr_b16 v[56:57], v32 offset:8192
    ds_read_b64_tr_b16 v[58:59], v32 offset:9216
    ds_read_b64_tr_b16 v[60:61], v33 offset:8192
    v_mfma_f32_32x32x16_bf16 v[176:191], v[76:79], v[92:95], v[176:191]
    ds_read_b64_tr_b16 v[62:63], v33 offset:9216
    v_mfma_f32_32x32x16_bf16 v[192:207], v[80:83], v[88:91], v[192:207]
    s_add_u32 m0, s52, 81920
    s_add_u32 s59, s65, 0
    buffer_load_dwordx4 v41, s[12:15], s59 offen lds
    v_mfma_f32_32x32x16_bf16 v[208:223], v[80:83], v[92:95], v[208:223]
    s_add_u32 m0, s52, 82944
    s_add_u32 s59, s65, 14336
    buffer_load_dwordx4 v41, s[12:15], s59 offen lds
    v_mfma_f32_32x32x16_bf16 v[224:239], v[84:87], v[88:91], v[224:239]
    s_add_u32 m0, s52, 83968
    s_add_u32 s59, s65, 28672
    buffer_load_dwordx4 v41, s[12:15], s59 offen lds
    v_mfma_f32_32x32x16_bf16 v[240:255], v[84:87], v[92:95], v[240:255]
    s_add_u32 m0, s52, 84992
    s_add_u32 s59, s65, 43008
    buffer_load_dwordx4 v41, s[12:15], s59 offen lds
    s_waitcnt lgkmcnt(0)
    v_mfma_f32_32x32x16_bf16 v[128:143], v[48:51], v[64:67], v[128:143]
    ds_read_b128 v[88:91], v21
    ds_read_b64_tr_b16 v[72:73], v30 offset:12288
    ds_read_b64_tr_b16 v[74:75], v30 offset:13312
    s_waitcnt vmcnt(12)
    v_accvgpr_read_b32 v123, a0
    v_lshlrev_b32 v96, 16, v123
    v_mfma_f32_32x32x16_bf16 v[144:159], v[48:51], v[68:71], v[144:159]
    ds_read_b128 v[92:95], v21 offset:4096
    ds_read_b64_tr_b16 v[76:77], v31 offset:12288
    ds_read_b64_tr_b16 v[78:79], v31 offset:13312
    v_and_b32 v97, 0xffff0000, v123
    v_accvgpr_read_b32 v123, a1
    v_lshlrev_b32 v98, 16, v123
    v_mfma_f32_32x32x16_bf16 v[160:175], v[52:55], v[64:67], v[160:175]
    ds_read_b64_tr_b16 v[80:81], v32 offset:12288
    ds_read_b64_tr_b16 v[82:83], v32 offset:13312
    ds_read_b64_tr_b16 v[84:85], v33 offset:12288
    v_and_b32 v99, 0xffff0000, v123
    v_accvgpr_read_b32 v123, a2
    v_lshlrev_b32 v100, 16, v123
    v_mfma_f32_32x32x16_bf16 v[176:191], v[52:55], v[68:71], v[176:191]
    ds_read_b64_tr_b16 v[86:87], v33 offset:13312
    v_and_b32 v101, 0xffff0000, v123
    v_accvgpr_read_b32 v123, a3
    v_lshlrev_b32 v102, 16, v123
    v_and_b32 v103, 0xffff0000, v123
    v_accvgpr_read_b32 v123, a4
    v_mfma_f32_32x32x16_bf16 v[192:207], v[56:59], v[64:67], v[192:207]
    v_lshlrev_b32 v124, 16, v123
    v_and_b32 v125, 0xffff0000, v123
    v_add_f32 v96, v96, v124
    v_add_f32 v97, v97, v125
    v_accvgpr_read_b32 v123, a5
    v_lshlrev_b32 v124, 16, v123
    v_mfma_f32_32x32x16_bf16 v[208:223], v[56:59], v[68:71], v[208:223]
    v_and_b32 v125, 0xffff0000, v123
    v_add_f32 v98, v98, v124
    v_add_f32 v99, v99, v125
    v_accvgpr_read_b32 v123, a6
    v_lshlrev_b32 v124, 16, v123
    v_and_b32 v125, 0xffff0000, v123
    v_mfma_f32_32x32x16_bf16 v[224:239], v[60:63], v[64:67], v[224:239]
    v_add_f32 v100, v100, v124
    v_add_f32 v101, v101, v125
    v_accvgpr_read_b32 v123, a7
    v_lshlrev_b32 v124, 16, v123
    v_and_b32 v125, 0xffff0000, v123
    v_add_f32 v102, v102, v124
    v_mfma_f32_32x32x16_bf16 v[240:255], v[60:63], v[68:71], v[240:255]
    v_add_f32 v103, v103, v125
    v_accvgpr_read_b32 v123, a8
    v_lshlrev_b32 v124, 16, v123
    v_and_b32 v125, 0xffff0000, v123
    v_add_f32 v96, v96, v124
    v_add_f32 v97, v97, v125
    s_waitcnt lgkmcnt(0)
    s_barrier
    v_mfma_f32_32x32x16_bf16 v[128:143], v[72:75], v[88:91], v[128:143]
    ds_read_b128 v[64:67], v10
    ds_read_b64_tr_b16 v[48:49], v22 offset:0
    ds_read_b64_tr_b16 v[50:51], v22 offset:1024
    s_mov_b32 s59, 5
    s_lshl_b32 s64, s59, 7
    s_add_u32 s64, s64, s53
    v_mfma_f32_32x32x16_bf16 v[144:159], v[72:75], v[92:95], v[144:159]
    ds_read_b128 v[68:71], v10 offset:4096
    ds_read_b64_tr_b16 v[52:53], v23 offset:0
    ds_read_b64_tr_b16 v[54:55], v23 offset:1024
    s_mul_i32 s65, s59, 229376
    s_add_u32 s65, s65, s54
    v_accvgpr_read_b32 v123, a9
    v_mfma_f32_32x32x16_bf16 v[160:175], v[76:79], v[88:91], v[160:175]
    ds_read_b64_tr_b16 v[56:57], v24 offset:0
    ds_read_b64_tr_b16 v[58:59], v24 offset:1024
    ds_read_b64_tr_b16 v[60:61], v25 offset:0
    v_lshlrev_b32 v124, 16, v123
    v_and_b32 v125, 0xffff0000, v123
    v_add_f32 v98, v98, v124
    v_mfma_f32_32x32x16_bf16 v[176:191], v[76:79], v[92:95], v[176:191]
    ds_read_b64_tr_b16 v[62:63], v25 offset:1024
    v_add_f32 v99, v99, v125
    v_accvgpr_read_b32 v123, a10
    v_lshlrev_b32 v124, 16, v123
    v_and_b32 v125, 0xffff0000, v123
    v_add_f32 v100, v100, v124
    v_mfma_f32_32x32x16_bf16 v[192:207], v[80:83], v[88:91], v[192:207]
    s_add_u32 m0, s52, 98304
    s_add_u32 s59, s64, 0
    buffer_load_dwordx4 v38, s[4:7], s59 offen lds
    v_add_f32 v101, v101, v125
    v_accvgpr_read_b32 v123, a11
    v_lshlrev_b32 v124, 16, v123
    v_mfma_f32_32x32x16_bf16 v[208:223], v[80:83], v[92:95], v[208:223]
    s_add_u32 m0, s52, 99328
    s_add_u32 s59, s64, 262144
    buffer_load_dwordx4 v39, s[4:7], s59 offen lds
    v_and_b32 v125, 0xffff0000, v123
    v_add_f32 v102, v102, v124
    v_add_f32 v103, v103, v125
    v_mfma_f32_32x32x16_bf16 v[224:239], v[84:87], v[88:91], v[224:239]
    s_add_u32 m0, s52, 100352
    s_add_u32 s59, s64, 524288
    buffer_load_dwordx4 v38, s[4:7], s59 offen lds
    v_accvgpr_read_b32 v123, a12
    v_lshlrev_b32 v124, 16, v123
    v_and_b32 v125, 0xffff0000, v123
    v_mfma_f32_32x32x16_bf16 v[240:255], v[84:87], v[92:95], v[240:255]
    s_add_u32 m0, s52, 101376
    s_add_u32 s59, s64, 786432
    buffer_load_dwordx4 v39, s[4:7], s59 offen lds
    v_add_f32 v96, v96, v124
    v_add_f32 v97, v97, v125
    v_accvgpr_read_b32 v123, a13
    s_waitcnt lgkmcnt(0)
    v_mfma_f32_32x32x16_bf16 v[128:143], v[48:51], v[64:67], v[128:143]
    ds_read_b128 v[88:91], v11
    ds_read_b64_tr_b16 v[72:73], v22 offset:4096
    ds_read_b64_tr_b16 v[74:75], v22 offset:5120
    v_lshlrev_b32 v124, 16, v123
    v_and_b32 v125, 0xffff0000, v123
    v_add_f32 v98, v98, v124
    v_mfma_f32_32x32x16_bf16 v[144:159], v[48:51], v[68:71], v[144:159]
    ds_read_b128 v[92:95], v11 offset:4096
    ds_read_b64_tr_b16 v[76:77], v23 offset:4096
    ds_read_b64_tr_b16 v[78:79], v23 offset:5120
    v_add_f32 v99, v99, v125
    v_accvgpr_read_b32 v123, a14
    v_lshlrev_b32 v124, 16, v123
    v_mfma_f32_32x32x16_bf16 v[160:175], v[52:55], v[64:67], v[160:175]
    ds_read_b64_tr_b16 v[80:81], v24 offset:4096
    ds_read_b64_tr_b16 v[82:83], v24 offset:5120
    ds_read_b64_tr_b16 v[84:85], v25 offset:4096
    v_and_b32 v125, 0xffff0000, v123
    v_add_f32 v100, v100, v124
    v_add_f32 v101, v101, v125
    v_mfma_f32_32x32x16_bf16 v[176:191], v[52:55], v[68:71], v[176:191]
    ds_read_b64_tr_b16 v[86:87], v25 offset:5120
    v_accvgpr_read_b32 v123, a15
    v_lshlrev_b32 v124, 16, v123
    v_and_b32 v125, 0xffff0000, v123
    v_add_f32 v102, v102, v124
    v_add_f32 v103, v103, v125
    v_mfma_f32_32x32x16_bf16 v[192:207], v[56:59], v[64:67], v[192:207]
    s_add_u32 m0, s52, 114688
    s_add_u32 s59, s65, 0
    buffer_load_dwordx4 v40, s[8:11], s59 offen lds
    v_permlane32_swap_b32 v96, v100
    v_permlane32_swap_b32 v97, v101
    v_permlane32_swap_b32 v98, v102
    v_mfma_f32_32x32x16_bf16 v[208:223], v[56:59], v[68:71], v[208:223]
    s_add_u32 m0, s52, 115712
    s_add_u32 s59, s65, 14336
    buffer_load_dwordx4 v40, s[8:11], s59 offen lds
    v_permlane32_swap_b32 v99, v103
    v_add_f32 v96, v96, v100
    v_add_f32 v97, v97, v101
    v_mfma_f32_32x32x16_bf16 v[224:239], v[60:63], v[64:67], v[224:239]
    s_add_u32 m0, s52, 116736
    s_add_u32 s59, s65, 28672
    buffer_load_dwordx4 v40, s[8:11], s59 offen lds
    v_add_f32 v98, v98, v102
    v_add_f32 v99, v99, v103
    s_nop 0
    v_permlane16_swap_b32 v96, v98
    v_mfma_f32_32x32x16_bf16 v[240:255], v[60:63], v[68:71], v[240:255]
    s_add_u32 m0, s52, 117760
    s_add_u32 s59, s65, 43008
    buffer_load_dwordx4 v40, s[8:11], s59 offen lds
    v_permlane16_swap_b32 v97, v99
    v_add_f32 v96, v96, v98
    v_add_f32 v97, v97, v99
    s_waitcnt lgkmcnt(0)
    v_mfma_f32_32x32x16_bf16 v[128:143], v[72:75], v[88:91], v[128:143]
    ds_read_b128 v[64:67], v12
    ds_read_b64_tr_b16 v[48:49], v22 offset:8192
    ds_read_b64_tr_b16 v[50:51], v22 offset:9216
    v_add_f32_dpp v96, v96, v96 row_ror:8 row_mask:0xf bank_mask:0xf
    v_add_f32_dpp v97, v97, v97 row_ror:8 row_mask:0xf bank_mask:0xf
    v_and_b32 v8, 1, v5
    v_mfma_f32_32x32x16_bf16 v[144:159], v[72:75], v[92:95], v[144:159]
    ds_read_b128 v[68:71], v12 offset:4096
    ds_read_b64_tr_b16 v[52:53], v23 offset:8192
    ds_read_b64_tr_b16 v[54:55], v23 offset:9216
    v_lshlrev_b32 v8, 1, v8
    v_lshl_add_u32 v8, v3, 2, v8
    v_lshl_add_u32 v8, v6, 3, v8
    v_mfma_f32_32x32x16_bf16 v[160:175], v[76:79], v[88:91], v[160:175]
    ds_read_b64_tr_b16 v[56:57], v24 offset:8192
    ds_read_b64_tr_b16 v[58:59], v24 offset:9216
    ds_read_b64_tr_b16 v[60:61], v25 offset:8192
    v_lshrrev_b32 v9, 4, v8
    v_and_b32 v8, 15, v8
    v_lshl_add_u32 v8, v9, 5, v8
    v_mfma_f32_32x32x16_bf16 v[176:191], v[76:79], v[92:95], v[176:191]
    ds_read_b64_tr_b16 v[62:63], v25 offset:9216
    s_lshl_b32 s55, s60, 4
    s_lshl_b32 s56, s61, 7
    s_add_u32 s55, s55, s56
    v_add_u32 v8, s55, v8
    v_lshlrev_b32 v8, 2, v8
    v_mfma_f32_32x32x16_bf16 v[192:207], v[80:83], v[88:91], v[192:207]
    s_add_u32 m0, s52, 131072
    s_add_u32 s59, s65, 0
    buffer_load_dwordx4 v41, s[12:15], s59 offen lds
    s_lshl_b32 s55, s46, 14
    s_lshl_b32 s56, s45, 10
    s_add_u32 s55, s55, s56
    v_mfma_f32_32x32x16_bf16 v[208:223], v[80:83], v[92:95], v[208:223]
    s_add_u32 m0, s52, 132096
    s_add_u32 s59, s65, 14336
    buffer_load_dwordx4 v41, s[12:15], s59 offen lds
    s_add_u32 s55, s55, 65536
    v_and_b32 v9, 8, v1
    v_cmp_eq_u32 vcc, 0, v9
    v_mfma_f32_32x32x16_bf16 v[224:239], v[84:87], v[88:91], v[224:239]
    s_add_u32 m0, s52, 133120
    s_add_u32 s59, s65, 28672
    buffer_load_dwordx4 v41, s[12:15], s59 offen lds
    v_mov_b32 v124, 2147483632
    v_cndmask_b32 v8, v124, v8, vcc
    v_cvt_pk_bf16_f32 v96, v96, v97
    v_mfma_f32_32x32x16_bf16 v[240:255], v[84:87], v[92:95], v[240:255]
    s_add_u32 m0, s52, 134144
    s_add_u32 s59, s65, 43008
    buffer_load_dwordx4 v41, s[12:15], s59 offen lds
    v_mov_b32 v97, v46
    buffer_store_dwordx2 v[96:97], v8, s[20:23], s55 offen sc1
    s_waitcnt lgkmcnt(0)
    v_mfma_f32_32x32x16_bf16 v[128:143], v[48:51], v[64:67], v[128:143]
    ds_read_b128 v[88:91], v13
    ds_read_b64_tr_b16 v[72:73], v22 offset:12288
    ds_read_b64_tr_b16 v[74:75], v22 offset:13312
    v_mfma_f32_32x32x16_bf16 v[144:159], v[48:51], v[68:71], v[144:159]
    ds_read_b128 v[92:95], v13 offset:4096
    ds_read_b64_tr_b16 v[76:77], v23 offset:12288
    ds_read_b64_tr_b16 v[78:79], v23 offset:13312
    v_mfma_f32_32x32x16_bf16 v[160:175], v[52:55], v[64:67], v[160:175]
    ds_read_b64_tr_b16 v[80:81], v24 offset:12288
    ds_read_b64_tr_b16 v[82:83], v24 offset:13312
    ds_read_b64_tr_b16 v[84:85], v25 offset:12288
    v_mfma_f32_32x32x16_bf16 v[176:191], v[52:55], v[68:71], v[176:191]
    ds_read_b64_tr_b16 v[86:87], v25 offset:13312
    v_mfma_f32_32x32x16_bf16 v[192:207], v[56:59], v[64:67], v[192:207]
    v_mfma_f32_32x32x16_bf16 v[208:223], v[56:59], v[68:71], v[208:223]
    v_mfma_f32_32x32x16_bf16 v[224:239], v[60:63], v[64:67], v[224:239]
    v_mfma_f32_32x32x16_bf16 v[240:255], v[60:63], v[68:71], v[240:255]
    s_waitcnt lgkmcnt(0)
    s_waitcnt vmcnt(13)
    s_barrier
    v_mfma_f32_32x32x16_bf16 v[128:143], v[72:75], v[88:91], v[128:143]
    ds_read_b128 v[64:67], v14
    ds_read_b64_tr_b16 v[48:49], v26 offset:0
    ds_read_b64_tr_b16 v[50:51], v26 offset:1024
    s_mov_b32 s59, 6
    s_lshl_b32 s64, s59, 7
    s_add_u32 s64, s64, s53
    v_mfma_f32_32x32x16_bf16 v[144:159], v[72:75], v[92:95], v[144:159]
    ds_read_b128 v[68:71], v14 offset:4096
    ds_read_b64_tr_b16 v[52:53], v27 offset:0
    ds_read_b64_tr_b16 v[54:55], v27 offset:1024
    s_mul_i32 s65, s59, 229376
    s_add_u32 s65, s65, s54
    v_mfma_f32_32x32x16_bf16 v[160:175], v[76:79], v[88:91], v[160:175]
    ds_read_b64_tr_b16 v[56:57], v28 offset:0
    ds_read_b64_tr_b16 v[58:59], v28 offset:1024
    ds_read_b64_tr_b16 v[60:61], v29 offset:0
    v_mfma_f32_32x32x16_bf16 v[176:191], v[76:79], v[92:95], v[176:191]
    ds_read_b64_tr_b16 v[62:63], v29 offset:1024
    v_mfma_f32_32x32x16_bf16 v[192:207], v[80:83], v[88:91], v[192:207]
    s_add_u32 m0, s52, 0
    s_add_u32 s59, s64, 0
    buffer_load_dwordx4 v38, s[4:7], s59 offen lds
    v_mfma_f32_32x32x16_bf16 v[208:223], v[80:83], v[92:95], v[208:223]
    s_add_u32 m0, s52, 1024
    s_add_u32 s59, s64, 262144
    buffer_load_dwordx4 v39, s[4:7], s59 offen lds
    v_mfma_f32_32x32x16_bf16 v[224:239], v[84:87], v[88:91], v[224:239]
    s_add_u32 m0, s52, 2048
    s_add_u32 s59, s64, 524288
    buffer_load_dwordx4 v38, s[4:7], s59 offen lds
    v_mfma_f32_32x32x16_bf16 v[240:255], v[84:87], v[92:95], v[240:255]
    s_add_u32 m0, s52, 3072
    s_add_u32 s59, s64, 786432
    buffer_load_dwordx4 v39, s[4:7], s59 offen lds
    s_waitcnt lgkmcnt(0)
    v_mfma_f32_32x32x16_bf16 v[128:143], v[48:51], v[64:67], v[128:143]
    ds_read_b128 v[88:91], v15
    ds_read_b64_tr_b16 v[72:73], v26 offset:4096
    ds_read_b64_tr_b16 v[74:75], v26 offset:5120
    v_mfma_f32_32x32x16_bf16 v[144:159], v[48:51], v[68:71], v[144:159]
    ds_read_b128 v[92:95], v15 offset:4096
    ds_read_b64_tr_b16 v[76:77], v27 offset:4096
    ds_read_b64_tr_b16 v[78:79], v27 offset:5120
    v_mfma_f32_32x32x16_bf16 v[160:175], v[52:55], v[64:67], v[160:175]
    ds_read_b64_tr_b16 v[80:81], v28 offset:4096
    ds_read_b64_tr_b16 v[82:83], v28 offset:5120
    ds_read_b64_tr_b16 v[84:85], v29 offset:4096
    v_mfma_f32_32x32x16_bf16 v[176:191], v[52:55], v[68:71], v[176:191]
    ds_read_b64_tr_b16 v[86:87], v29 offset:5120
    v_mfma_f32_32x32x16_bf16 v[192:207], v[56:59], v[64:67], v[192:207]
    s_add_u32 m0, s52, 16384
    s_add_u32 s59, s65, 0
    buffer_load_dwordx4 v40, s[8:11], s59 offen lds
    v_mfma_f32_32x32x16_bf16 v[208:223], v[56:59], v[68:71], v[208:223]
    s_add_u32 m0, s52, 17408
    s_add_u32 s59, s65, 14336
    buffer_load_dwordx4 v40, s[8:11], s59 offen lds
    v_mfma_f32_32x32x16_bf16 v[224:239], v[60:63], v[64:67], v[224:239]
    s_add_u32 m0, s52, 18432
    s_add_u32 s59, s65, 28672
    buffer_load_dwordx4 v40, s[8:11], s59 offen lds
    v_mfma_f32_32x32x16_bf16 v[240:255], v[60:63], v[68:71], v[240:255]
    s_add_u32 m0, s52, 19456
    s_add_u32 s59, s65, 43008
    buffer_load_dwordx4 v40, s[8:11], s59 offen lds
    s_waitcnt lgkmcnt(0)
    v_mfma_f32_32x32x16_bf16 v[128:143], v[72:75], v[88:91], v[128:143]
    ds_read_b128 v[64:67], v16
    ds_read_b64_tr_b16 v[48:49], v26 offset:8192
    ds_read_b64_tr_b16 v[50:51], v26 offset:9216
    v_mfma_f32_32x32x16_bf16 v[144:159], v[72:75], v[92:95], v[144:159]
    ds_read_b128 v[68:71], v16 offset:4096
    ds_read_b64_tr_b16 v[52:53], v27 offset:8192
    ds_read_b64_tr_b16 v[54:55], v27 offset:9216
    v_mfma_f32_32x32x16_bf16 v[160:175], v[76:79], v[88:91], v[160:175]
    ds_read_b64_tr_b16 v[56:57], v28 offset:8192
    ds_read_b64_tr_b16 v[58:59], v28 offset:9216
    ds_read_b64_tr_b16 v[60:61], v29 offset:8192
    v_mfma_f32_32x32x16_bf16 v[176:191], v[76:79], v[92:95], v[176:191]
    ds_read_b64_tr_b16 v[62:63], v29 offset:9216
    v_mfma_f32_32x32x16_bf16 v[192:207], v[80:83], v[88:91], v[192:207]
    s_add_u32 m0, s52, 32768
    s_add_u32 s59, s65, 0
    buffer_load_dwordx4 v41, s[12:15], s59 offen lds
    v_mfma_f32_32x32x16_bf16 v[208:223], v[80:83], v[92:95], v[208:223]
    s_add_u32 m0, s52, 33792
    s_add_u32 s59, s65, 14336
    buffer_load_dwordx4 v41, s[12:15], s59 offen lds
    v_mfma_f32_32x32x16_bf16 v[224:239], v[84:87], v[88:91], v[224:239]
    s_add_u32 m0, s52, 34816
    s_add_u32 s59, s65, 28672
    buffer_load_dwordx4 v41, s[12:15], s59 offen lds
    v_mfma_f32_32x32x16_bf16 v[240:255], v[84:87], v[92:95], v[240:255]
    s_add_u32 m0, s52, 35840
    s_add_u32 s59, s65, 43008
    buffer_load_dwordx4 v41, s[12:15], s59 offen lds
    s_waitcnt lgkmcnt(0)
    v_mfma_f32_32x32x16_bf16 v[128:143], v[48:51], v[64:67], v[128:143]
    ds_read_b128 v[88:91], v17
    ds_read_b64_tr_b16 v[72:73], v26 offset:12288
    ds_read_b64_tr_b16 v[74:75], v26 offset:13312
    v_mfma_f32_32x32x16_bf16 v[144:159], v[48:51], v[68:71], v[144:159]
    ds_read_b128 v[92:95], v17 offset:4096
    ds_read_b64_tr_b16 v[76:77], v27 offset:12288
    ds_read_b64_tr_b16 v[78:79], v27 offset:13312
    v_mfma_f32_32x32x16_bf16 v[160:175], v[52:55], v[64:67], v[160:175]
    ds_read_b64_tr_b16 v[80:81], v28 offset:12288
    ds_read_b64_tr_b16 v[82:83], v28 offset:13312
    ds_read_b64_tr_b16 v[84:85], v29 offset:12288
    v_mfma_f32_32x32x16_bf16 v[176:191], v[52:55], v[68:71], v[176:191]
    ds_read_b64_tr_b16 v[86:87], v29 offset:13312
    v_mfma_f32_32x32x16_bf16 v[192:207], v[56:59], v[64:67], v[192:207]
    v_mfma_f32_32x32x16_bf16 v[208:223], v[56:59], v[68:71], v[208:223]
    v_mfma_f32_32x32x16_bf16 v[224:239], v[60:63], v[64:67], v[224:239]
    v_mfma_f32_32x32x16_bf16 v[240:255], v[60:63], v[68:71], v[240:255]
    s_waitcnt lgkmcnt(0)
    s_waitcnt vmcnt(13)
    s_barrier
    v_mfma_f32_32x32x16_bf16 v[128:143], v[72:75], v[88:91], v[128:143]
    ds_read_b128 v[64:67], v18
    ds_read_b64_tr_b16 v[48:49], v30 offset:0
    ds_read_b64_tr_b16 v[50:51], v30 offset:1024
    s_mov_b32 s59, 7
    s_lshl_b32 s64, s59, 7
    s_add_u32 s64, s64, s53
    v_mfma_f32_32x32x16_bf16 v[144:159], v[72:75], v[92:95], v[144:159]
    ds_read_b128 v[68:71], v18 offset:4096
    ds_read_b64_tr_b16 v[52:53], v31 offset:0
    ds_read_b64_tr_b16 v[54:55], v31 offset:1024
    s_mul_i32 s65, s59, 229376
    s_add_u32 s65, s65, s54
    v_mfma_f32_32x32x16_bf16 v[160:175], v[76:79], v[88:91], v[160:175]
    ds_read_b64_tr_b16 v[56:57], v32 offset:0
    ds_read_b64_tr_b16 v[58:59], v32 offset:1024
    ds_read_b64_tr_b16 v[60:61], v33 offset:0
    v_mfma_f32_32x32x16_bf16 v[176:191], v[76:79], v[92:95], v[176:191]
    ds_read_b64_tr_b16 v[62:63], v33 offset:1024
    v_mfma_f32_32x32x16_bf16 v[192:207], v[80:83], v[88:91], v[192:207]
    s_add_u32 m0, s52, 49152
    s_add_u32 s59, s64, 0
    buffer_load_dwordx4 v38, s[4:7], s59 offen lds
    v_mfma_f32_32x32x16_bf16 v[208:223], v[80:83], v[92:95], v[208:223]
    s_add_u32 m0, s52, 50176
    s_add_u32 s59, s64, 262144
    buffer_load_dwordx4 v39, s[4:7], s59 offen lds
    v_mfma_f32_32x32x16_bf16 v[224:239], v[84:87], v[88:91], v[224:239]
    s_add_u32 m0, s52, 51200
    s_add_u32 s59, s64, 524288
    buffer_load_dwordx4 v38, s[4:7], s59 offen lds
    v_mfma_f32_32x32x16_bf16 v[240:255], v[84:87], v[92:95], v[240:255]
    s_add_u32 m0, s52, 52224
    s_add_u32 s59, s64, 786432
    buffer_load_dwordx4 v39, s[4:7], s59 offen lds
    s_waitcnt lgkmcnt(0)
    v_mfma_f32_32x32x16_bf16 v[128:143], v[48:51], v[64:67], v[128:143]
    ds_read_b128 v[88:91], v19
    ds_read_b64_tr_b16 v[72:73], v30 offset:4096
    ds_read_b64_tr_b16 v[74:75], v30 offset:5120
    v_mfma_f32_32x32x16_bf16 v[144:159], v[48:51], v[68:71], v[144:159]
    ds_read_b128 v[92:95], v19 offset:4096
    ds_read_b64_tr_b16 v[76:77], v31 offset:4096
    ds_read_b64_tr_b16 v[78:79], v31 offset:5120
    v_mfma_f32_32x32x16_bf16 v[160:175], v[52:55], v[64:67], v[160:175]
    ds_read_b64_tr_b16 v[80:81], v32 offset:4096
    ds_read_b64_tr_b16 v[82:83], v32 offset:5120
    ds_read_b64_tr_b16 v[84:85], v33 offset:4096
    v_mfma_f32_32x32x16_bf16 v[176:191], v[52:55], v[68:71], v[176:191]
    ds_read_b64_tr_b16 v[86:87], v33 offset:5120
    v_mfma_f32_32x32x16_bf16 v[192:207], v[56:59], v[64:67], v[192:207]
    s_add_u32 m0, s52, 65536
    s_add_u32 s59, s65, 0
    buffer_load_dwordx4 v40, s[8:11], s59 offen lds
    v_mfma_f32_32x32x16_bf16 v[208:223], v[56:59], v[68:71], v[208:223]
    s_add_u32 m0, s52, 66560
    s_add_u32 s59, s65, 14336
    buffer_load_dwordx4 v40, s[8:11], s59 offen lds
    v_mfma_f32_32x32x16_bf16 v[224:239], v[60:63], v[64:67], v[224:239]
    s_add_u32 m0, s52, 67584
    s_add_u32 s59, s65, 28672
    buffer_load_dwordx4 v40, s[8:11], s59 offen lds
    v_mfma_f32_32x32x16_bf16 v[240:255], v[60:63], v[68:71], v[240:255]
    s_add_u32 m0, s52, 68608
    s_add_u32 s59, s65, 43008
    buffer_load_dwordx4 v40, s[8:11], s59 offen lds
    s_waitcnt lgkmcnt(0)
    v_mfma_f32_32x32x16_bf16 v[128:143], v[72:75], v[88:91], v[128:143]
    ds_read_b128 v[64:67], v20
    ds_read_b64_tr_b16 v[48:49], v30 offset:8192
    ds_read_b64_tr_b16 v[50:51], v30 offset:9216
    v_mfma_f32_32x32x16_bf16 v[144:159], v[72:75], v[92:95], v[144:159]
    ds_read_b128 v[68:71], v20 offset:4096
    ds_read_b64_tr_b16 v[52:53], v31 offset:8192
    ds_read_b64_tr_b16 v[54:55], v31 offset:9216
    v_mfma_f32_32x32x16_bf16 v[160:175], v[76:79], v[88:91], v[160:175]
    ds_read_b64_tr_b16 v[56:57], v32 offset:8192
    ds_read_b64_tr_b16 v[58:59], v32 offset:9216
    ds_read_b64_tr_b16 v[60:61], v33 offset:8192
    v_mfma_f32_32x32x16_bf16 v[176:191], v[76:79], v[92:95], v[176:191]
    ds_read_b64_tr_b16 v[62:63], v33 offset:9216
    v_mfma_f32_32x32x16_bf16 v[192:207], v[80:83], v[88:91], v[192:207]
    s_add_u32 m0, s52, 81920
    s_add_u32 s59, s65, 0
    buffer_load_dwordx4 v41, s[12:15], s59 offen lds
    v_mfma_f32_32x32x16_bf16 v[208:223], v[80:83], v[92:95], v[208:223]
    s_add_u32 m0, s52, 82944
    s_add_u32 s59, s65, 14336
    buffer_load_dwordx4 v41, s[12:15], s59 offen lds
    v_mfma_f32_32x32x16_bf16 v[224:239], v[84:87], v[88:91], v[224:239]
    s_add_u32 m0, s52, 83968
    s_add_u32 s59, s65, 28672
    buffer_load_dwordx4 v41, s[12:15], s59 offen lds
    v_mfma_f32_32x32x16_bf16 v[240:255], v[84:87], v[92:95], v[240:255]
    s_add_u32 m0, s52, 84992
    s_add_u32 s59, s65, 43008
    buffer_load_dwordx4 v41, s[12:15], s59 offen lds
    s_waitcnt lgkmcnt(0)
    s_mul_i32 s77, s44, 458752
    s_lshl_b32 s70, s50, 7
    s_add_u32 s77, s77, s70
    s_mul_i32 s78, s44, 12288
    s_lshl_b32 s74, s44, 13
    v_and_b32 v43, 1, v5
    v_lshlrev_b32 v43, 2, v43
    v_xor_b32 v43, v43, v6
    v_lshlrev_b32 v43, 4, v43
    v_lshl_add_u32 v37, v7, 10, v43
    s_mov_b32 s66, 0
    v_mfma_f32_32x32x16_bf16 v[128:143], v[48:51], v[64:67], v[128:143]
    ds_read_b128 v[88:91], v21
    ds_read_b64_tr_b16 v[72:73], v30 offset:12288
    ds_read_b64_tr_b16 v[74:75], v30 offset:13312
    v_and_b32 v8, 63, v1
    v_lshlrev_b32 v126, 4, v8
    s_lshl_b32 s55, s46, 14
    v_mfma_f32_32x32x16_bf16 v[144:159], v[48:51], v[68:71], v[144:159]
    ds_read_b128 v[92:95], v21 offset:4096
    ds_read_b64_tr_b16 v[76:77], v31 offset:12288
    ds_read_b64_tr_b16 v[78:79], v31 offset:13312
    s_add_u32 s55, s55, s52
    s_add_u32 s79, s55, 65536
    buffer_load_dwordx4 v[96:99], v126, s[20:23], s79 offen offset:0 sc1
    v_mfma_f32_32x32x16_bf16 v[160:175], v[52:55], v[64:67], v[160:175]
    ds_read_b64_tr_b16 v[80:81], v32 offset:12288
    ds_read_b64_tr_b16 v[82:83], v32 offset:13312
    ds_read_b64_tr_b16 v[84:85], v33 offset:12288
    buffer_load_dwordx4 v[100:103], v126, s[20:23], s79 offen offset:1024 sc1
    buffer_load_dwordx4 v[104:107], v126, s[20:23], s79 offen offset:2048 sc1
    buffer_load_dwordx4 v[108:111], v126, s[20:23], s79 offen offset:3072 sc1
    v_mfma_f32_32x32x16_bf16 v[176:191], v[52:55], v[68:71], v[176:191]
    ds_read_b64_tr_b16 v[86:87], v33 offset:13312
    s_lshl_b32 s55, s45, 7
    s_lshl_b32 s56, s61, 6
    s_add_u32 s55, s55, s56
    s_lshl_b32 s55, s55, 4
    s_add_u32 s75, s55, 0
    v_mfma_f32_32x32x16_bf16 v[192:207], v[56:59], v[64:67], v[192:207]
    v_lshlrev_b32 v8, 4, v2
    buffer_load_dwordx4 v[112:115], v8, s[20:23], s75 offen sc1
    buffer_load_dwordx4 v[116:119], v8, s[20:23], s75 offen offset:512 sc1
    s_mul_i32 s55, s2, 7168
    s_mul_i32 s56, s44, 1792
    s_add_u32 s55, s55, s56
    v_mfma_f32_32x32x16_bf16 v[208:223], v[56:59], v[68:71], v[208:223]
    v_lshlrev_b32 v8, 7, v1
    v_cmp_gt_u32 vcc, 14, v1
    v_mov_b32 v9, 2147483632
    s_nop 0
    v_cndmask_b32 v9, v9, v8, vcc
    s_lshl_b32 s56, s44, 8
    v_mfma_f32_32x32x16_bf16 v[224:239], v[60:63], v[64:67], v[224:239]
    s_add_u32 m0, s56, 162816
    s_nop 0
    buffer_load_dword v9, s[16:19], s55 offen lds
    v_mfma_f32_32x32x16_bf16 v[240:255], v[60:63], v[68:71], v[240:255]
    s_waitcnt lgkmcnt(0)
    s_waitcnt vmcnt(19)
    s_barrier
    v_mfma_f32_32x32x16_bf16 v[128:143], v[72:75], v[88:91], v[128:143]
    ds_read_b128 v[64:67], v10
    ds_read_b64_tr_b16 v[48:49], v22 offset:0
    ds_read_b64_tr_b16 v[50:51], v22 offset:1024
    v_mfma_f32_32x32x16_bf16 v[144:159], v[72:75], v[92:95], v[144:159]
    ds_read_b128 v[68:71], v10 offset:4096
    ds_read_b64_tr_b16 v[52:53], v23 offset:0
    ds_read_b64_tr_b16 v[54:55], v23 offset:1024
    v_mfma_f32_32x32x16_bf16 v[160:175], v[76:79], v[88:91], v[160:175]
    ds_read_b64_tr_b16 v[56:57], v24 offset:0
    ds_read_b64_tr_b16 v[58:59], v24 offset:1024
    ds_read_b64_tr_b16 v[60:61], v25 offset:0
    v_mfma_f32_32x32x16_bf16 v[176:191], v[76:79], v[92:95], v[176:191]
    ds_read_b64_tr_b16 v[62:63], v25 offset:1024
    v_mfma_f32_32x32x16_bf16 v[192:207], v[80:83], v[88:91], v[192:207]
    v_mfma_f32_32x32x16_bf16 v[208:223], v[80:83], v[92:95], v[208:223]
    v_mfma_f32_32x32x16_bf16 v[224:239], v[84:87], v[88:91], v[224:239]
    v_mfma_f32_32x32x16_bf16 v[240:255], v[84:87], v[92:95], v[240:255]
    s_waitcnt lgkmcnt(0)
    v_mfma_f32_32x32x16_bf16 v[128:143], v[48:51], v[64:67], v[128:143]
    ds_read_b128 v[88:91], v11
    ds_read_b64_tr_b16 v[72:73], v22 offset:4096
    ds_read_b64_tr_b16 v[74:75], v22 offset:5120
    v_mfma_f32_32x32x16_bf16 v[144:159], v[48:51], v[68:71], v[144:159]
    ds_read_b128 v[92:95], v11 offset:4096
    ds_read_b64_tr_b16 v[76:77], v23 offset:4096
    ds_read_b64_tr_b16 v[78:79], v23 offset:5120
    v_mfma_f32_32x32x16_bf16 v[160:175], v[52:55], v[64:67], v[160:175]
    ds_read_b64_tr_b16 v[80:81], v24 offset:4096
    ds_read_b64_tr_b16 v[82:83], v24 offset:5120
    ds_read_b64_tr_b16 v[84:85], v25 offset:4096
    v_mfma_f32_32x32x16_bf16 v[176:191], v[52:55], v[68:71], v[176:191]
    ds_read_b64_tr_b16 v[86:87], v25 offset:5120
    v_mfma_f32_32x32x16_bf16 v[192:207], v[56:59], v[64:67], v[192:207]
    s_add_u32 s67, s66, 0
    s_cmp_ge_u32 s67, 14
    s_cselect_b32 s59, 14, 0
    s_sub_u32 s67, s67, s59
    s_lshl_b32 s67, s67, 15
    s_add_u32 s67, s77, s67
    v_mfma_f32_32x32x16_bf16 v[208:223], v[56:59], v[68:71], v[208:223]
    s_add_u32 m0, s78, 98304
    s_add_u32 s59, s67, 0
    buffer_load_dwordx4 v37, s[16:19], s59 offen lds
    v_mfma_f32_32x32x16_bf16 v[224:239], v[60:63], v[64:67], v[224:239]
    s_add_u32 m0, s78, 99328
    s_add_u32 s59, s67, 8192
    buffer_load_dwordx4 v37, s[16:19], s59 offen lds
    v_mfma_f32_32x32x16_bf16 v[240:255], v[60:63], v[68:71], v[240:255]
    s_add_u32 m0, s78, 100352
    s_add_u32 s59, s67, 16384
    buffer_load_dwordx4 v37, s[16:19], s59 offen lds
    s_waitcnt lgkmcnt(0)
    v_mfma_f32_32x32x16_bf16 v[128:143], v[72:75], v[88:91], v[128:143]
    ds_read_b128 v[64:67], v12
    ds_read_b64_tr_b16 v[48:49], v22 offset:8192
    ds_read_b64_tr_b16 v[50:51], v22 offset:9216
    v_mfma_f32_32x32x16_bf16 v[144:159], v[72:75], v[92:95], v[144:159]
    ds_read_b128 v[68:71], v12 offset:4096
    ds_read_b64_tr_b16 v[52:53], v23 offset:8192
    ds_read_b64_tr_b16 v[54:55], v23 offset:9216
    v_mfma_f32_32x32x16_bf16 v[160:175], v[76:79], v[88:91], v[160:175]
    ds_read_b64_tr_b16 v[56:57], v24 offset:8192
    ds_read_b64_tr_b16 v[58:59], v24 offset:9216
    ds_read_b64_tr_b16 v[60:61], v25 offset:8192
    v_mfma_f32_32x32x16_bf16 v[176:191], v[76:79], v[92:95], v[176:191]
    ds_read_b64_tr_b16 v[62:63], v25 offset:9216
    v_mfma_f32_32x32x16_bf16 v[192:207], v[80:83], v[88:91], v[192:207]
    s_add_u32 m0, s78, 101376
    s_add_u32 s59, s67, 24576
    buffer_load_dwordx4 v37, s[16:19], s59 offen lds
    v_mfma_f32_32x32x16_bf16 v[208:223], v[80:83], v[92:95], v[208:223]
    s_add_u32 s67, s66, 1
    s_cmp_ge_u32 s67, 14
    s_cselect_b32 s59, 14, 0
    s_sub_u32 s67, s67, s59
    s_lshl_b32 s67, s67, 15
    s_add_u32 s67, s77, s67
    v_mfma_f32_32x32x16_bf16 v[224:239], v[84:87], v[88:91], v[224:239]
    s_add_u32 m0, s78, 102400
    s_add_u32 s59, s67, 0
    buffer_load_dwordx4 v37, s[16:19], s59 offen lds
    v_mfma_f32_32x32x16_bf16 v[240:255], v[84:87], v[92:95], v[240:255]
    s_add_u32 m0, s78, 103424
    s_add_u32 s59, s67, 8192
    buffer_load_dwordx4 v37, s[16:19], s59 offen lds
    s_waitcnt lgkmcnt(0)
    v_mfma_f32_32x32x16_bf16 v[128:143], v[48:51], v[64:67], v[128:143]
    ds_read_b128 v[88:91], v13
    ds_read_b64_tr_b16 v[72:73], v22 offset:12288
    ds_read_b64_tr_b16 v[74:75], v22 offset:13312
    v_mfma_f32_32x32x16_bf16 v[144:159], v[48:51], v[68:71], v[144:159]
    ds_read_b128 v[92:95], v13 offset:4096
    ds_read_b64_tr_b16 v[76:77], v23 offset:12288
    ds_read_b64_tr_b16 v[78:79], v23 offset:13312
    v_mfma_f32_32x32x16_bf16 v[160:175], v[52:55], v[64:67], v[160:175]
    ds_read_b64_tr_b16 v[80:81], v24 offset:12288
    ds_read_b64_tr_b16 v[82:83], v24 offset:13312
    ds_read_b64_tr_b16 v[84:85], v25 offset:12288
    v_mfma_f32_32x32x16_bf16 v[176:191], v[52:55], v[68:71], v[176:191]
    ds_read_b64_tr_b16 v[86:87], v25 offset:13312
    v_mfma_f32_32x32x16_bf16 v[192:207], v[56:59], v[64:67], v[192:207]
    s_add_u32 m0, s78, 104448
    s_add_u32 s59, s67, 16384
    buffer_load_dwordx4 v37, s[16:19], s59 offen lds
    v_mfma_f32_32x32x16_bf16 v[208:223], v[56:59], v[68:71], v[208:223]
    s_add_u32 m0, s78, 105472
    s_add_u32 s59, s67, 24576
    buffer_load_dwordx4 v37, s[16:19], s59 offen lds
    v_mfma_f32_32x32x16_bf16 v[224:239], v[60:63], v[64:67], v[224:239]
    s_add_u32 s67, s66, 2
    s_cmp_ge_u32 s67, 14
    s_cselect_b32 s59, 14, 0
    s_sub_u32 s67, s67, s59
    s_lshl_b32 s67, s67, 15
    s_add_u32 s67, s77, s67
    v_mfma_f32_32x32x16_bf16 v[240:255], v[60:63], v[68:71], v[240:255]
    s_add_u32 m0, s78, 106496
    s_add_u32 s59, s67, 0
    buffer_load_dwordx4 v37, s[16:19], s59 offen lds
    s_waitcnt lgkmcnt(0)
    s_waitcnt vmcnt(16)
    s_waitcnt vmcnt(12)
    v_xor_b32 v43, v46, v97
    v_xor_b32 v44, v46, v99
    v_or_b32 v43, v43, v44
    v_xor_b32 v44, v46, v101
    v_or_b32 v43, v43, v44
    v_xor_b32 v44, v46, v103
    v_or_b32 v43, v43, v44
    v_xor_b32 v44, v46, v105
    v_or_b32 v43, v43, v44
    v_xor_b32 v44, v46, v107
    v_or_b32 v43, v43, v44
    v_xor_b32 v44, v46, v109
    v_or_b32 v43, v43, v44
    v_xor_b32 v44, v46, v111
    v_or_b32 v43, v43, v44
    v_cmp_ne_u32 vcc, 0, v43
    s_cbranch_vccnz L_cslow_12
L_cback_13:
    v_and_b32 v97, 0xffff0000, v96
    v_lshlrev_b32 v96, 16, v96
    v_and_b32 v99, 0xffff0000, v98
    v_lshlrev_b32 v98, 16, v98
    v_and_b32 v101, 0xffff0000, v100
    v_lshlrev_b32 v100, 16, v100
    v_and_b32 v103, 0xffff0000, v102
    v_lshlrev_b32 v102, 16, v102
    v_and_b32 v105, 0xffff0000, v104
    v_lshlrev_b32 v104, 16, v104
    v_and_b32 v107, 0xffff0000, v106
    v_lshlrev_b32 v106, 16, v106
    v_and_b32 v109, 0xffff0000, v108
    v_lshlrev_b32 v108, 16, v108
    v_and_b32 v111, 0xffff0000, v110
    v_lshlrev_b32 v110, 16, v110
    v_add_f32 v96, v96, v104
    v_add_f32 v97, v97, v105
    v_add_f32 v98, v98, v106
    v_add_f32 v99, v99, v107
    v_add_f32 v100, v100, v108
    v_add_f32 v101, v101, v109
    v_add_f32 v102, v102, v110
    v_add_f32 v103, v103, v111
    v_add_f32 v96, v96, v100
    v_add_f32 v97, v97, v101
    v_add_f32 v98, v98, v102
    v_add_f32 v99, v99, v103
    s_lshl_b32 s70, s44, 10
    s_add_u32 s70, s70, 150528
    v_add_u32 v8, s70, v126
    ds_write_b128 v8, v[96:99]
    s_waitcnt lgkmcnt(0)
    s_barrier
    v_mfma_f32_32x32x16_bf16 v[128:143], v[72:75], v[88:91], v[128:143]
    ds_read_b128 v[64:67], v14
    ds_read_b64_tr_b16 v[48:49], v26 offset:0
    ds_read_b64_tr_b16 v[50:51], v26 offset:1024
    v_and_b32 v8, 255, v0
    v_lshlrev_b32 v8, 2, v8
    v_add_u32 v9, 150528, v8
    v_mfma_f32_32x32x16_bf16 v[144:159], v[72:75], v[92:95], v[144:159]
    ds_read_b128 v[68:71], v14 offset:4096
    ds_read_b64_tr_b16 v[52:53], v27 offset:0
    ds_read_b64_tr_b16 v[54:55], v27 offset:1024
    ds_read_b32 v122, v9 offset:0
    ds_read_b32 v123, v9 offset:1024
    ds_read_b32 v124, v9 offset:2048
    v_mfma_f32_32x32x16_bf16 v[160:175], v[76:79], v[88:91], v[160:175]
    ds_read_b64_tr_b16 v[56:57], v28 offset:0
    ds_read_b64_tr_b16 v[58:59], v28 offset:1024
    ds_read_b64_tr_b16 v[60:61], v29 offset:0
    ds_read_b32 v125, v9 offset:3072
    v_add_u32 v8, 147456, v8
    s_waitcnt lgkmcnt(0)
    v_mfma_f32_32x32x16_bf16 v[176:191], v[76:79], v[92:95], v[176:191]
    ds_read_b64_tr_b16 v[62:63], v29 offset:1024
    v_add_f32 v122, v122, v123
    v_add_f32 v124, v124, v125
    v_add_f32 v124, v124, v122
    ds_write_b32 v8, v124
    s_sub_u32 s55, 64, s47
    v_mfma_f32_32x32x16_bf16 v[192:207], v[80:83], v[88:91], v[192:207]
    s_add_u32 m0, s78, 107520
    s_add_u32 s59, s67, 8192
    buffer_load_dwordx4 v37, s[16:19], s59 offen lds
    s_cmp_eq_u32 s47, 0
    s_cselect_b32 s55, 32, s55
    v_mfma_f32_32x32x16_bf16 v[208:223], v[80:83], v[92:95], v[208:223]
    s_add_u32 m0, s78, 108544
    s_add_u32 s59, s67, 16384
    buffer_load_dwordx4 v37, s[16:19], s59 offen lds
    s_cmp_eq_u32 s61, 0
    s_cselect_b32 s76, s47, s55
    v_lshrrev_b32 v8, 2, v1
    v_mfma_f32_32x32x16_bf16 v[224:239], v[84:87], v[88:91], v[224:239]
    s_add_u32 m0, s78, 109568
    s_add_u32 s59, s67, 24576
    buffer_load_dwordx4 v37, s[16:19], s59 offen lds
    s_mov_b32 s55, 32896
    v_mul_lo_u32 v8, v8, s55
    v_and_b32 v9, 3, v1
    v_mfma_f32_32x32x16_bf16 v[240:255], v[84:87], v[92:95], v[240:255]
    v_lshl_add_u32 v8, v9, 4, v8
    s_lshl_b32 s55, s60, 10
    s_add_u32 s55, s55, s76
    s_mul_i32 s55, s55, 514
    s_lshl_b32 s56, s48, 6
    s_add_u32 s55, s55, s56
    s_waitcnt lgkmcnt(0)
    v_mfma_f32_32x32x16_bf16 v[128:143], v[48:51], v[64:67], v[128:143]
    ds_read_b128 v[88:91], v15
    ds_read_b64_tr_b16 v[72:73], v26 offset:4096
    ds_read_b64_tr_b16 v[74:75], v26 offset:5120
    s_lshl_b32 s56, s44, 10
    s_add_u32 m0, s56, 154624
    s_nop 0
    buffer_load_dwordx4 v8, s[32:35], s55 offen lds
    v_mfma_f32_32x32x16_bf16 v[144:159], v[48:51], v[68:71], v[144:159]
    ds_read_b128 v[92:95], v15 offset:4096
    ds_read_b64_tr_b16 v[76:77], v27 offset:4096
    ds_read_b64_tr_b16 v[78:79], v27 offset:5120
    s_add_u32 m0, s56, 158720
    s_nop 0
    buffer_load_dwordx4 v8, s[36:39], s55 offen lds
    s_mov_b32 s56, 32896
    v_mfma_f32_32x32x16_bf16 v[160:175], v[52:55], v[64:67], v[160:175]
    ds_read_b64_tr_b16 v[80:81], v28 offset:4096
    ds_read_b64_tr_b16 v[82:83], v28 offset:5120
    ds_read_b64_tr_b16 v[84:85], v29 offset:4096
    v_mul_lo_u32 v9, v4, s56
    v_add_u32 v9, 510, v9
    s_lshl_b32 s56, s48, 6
    v_mfma_f32_32x32x16_bf16 v[176:191], v[52:55], v[68:71], v[176:191]
    ds_read_b64_tr_b16 v[86:87], v29 offset:5120
    s_sub_u32 s58, s55, s56
    s_cmp_eq_u32 s48, 0
    s_cselect_b32 s56, 16, 0
    v_cmp_gt_u32 vcc, s56, v1
    v_mov_b32 v8, 2147483632
    v_mfma_f32_32x32x16_bf16 v[192:207], v[56:59], v[64:67], v[192:207]
    s_add_u32 s67, s66, 3
    s_cmp_ge_u32 s67, 14
    s_cselect_b32 s59, 14, 0
    s_sub_u32 s67, s67, s59
    s_lshl_b32 s67, s67, 15
    s_add_u32 s67, s77, s67
    v_cndmask_b32 v125, v8, v9, vcc
    s_lshl_b32 s56, s44, 9
    s_add_u32 m0, s56, 148480
    s_nop 0
    buffer_load_dword v125, s[32:35], s58 offen lds
    v_mfma_f32_32x32x16_bf16 v[208:223], v[56:59], v[68:71], v[208:223]
    s_add_u32 m0, s78, 0
    s_add_u32 s59, s67, 0
    buffer_load_dwordx4 v37, s[16:19], s59 offen lds
    s_add_u32 m0, s56, 148736
    s_nop 0
    buffer_load_dword v125, s[36:39], s58 offen lds
    v_mfma_f32_32x32x16_bf16 v[224:239], v[60:63], v[64:67], v[224:239]
    s_add_u32 m0, s78, 1024
    s_add_u32 s59, s67, 8192
    buffer_load_dwordx4 v37, s[16:19], s59 offen lds
    v_mfma_f32_32x32x16_bf16 v[240:255], v[60:63], v[68:71], v[240:255]
    s_add_u32 m0, s78, 2048
    s_add_u32 s59, s67, 16384
    buffer_load_dwordx4 v37, s[16:19], s59 offen lds
    s_waitcnt lgkmcnt(0)
    v_mfma_f32_32x32x16_bf16 v[128:143], v[72:75], v[88:91], v[128:143]
    ds_read_b128 v[64:67], v16
    ds_read_b64_tr_b16 v[48:49], v26 offset:8192
    ds_read_b64_tr_b16 v[50:51], v26 offset:9216
    v_mfma_f32_32x32x16_bf16 v[144:159], v[72:75], v[92:95], v[144:159]
    ds_read_b128 v[68:71], v16 offset:4096
    ds_read_b64_tr_b16 v[52:53], v27 offset:8192
    ds_read_b64_tr_b16 v[54:55], v27 offset:9216
    v_mfma_f32_32x32x16_bf16 v[160:175], v[76:79], v[88:91], v[160:175]
    ds_read_b64_tr_b16 v[56:57], v28 offset:8192
    ds_read_b64_tr_b16 v[58:59], v28 offset:9216
    ds_read_b64_tr_b16 v[60:61], v29 offset:8192
    v_mfma_f32_32x32x16_bf16 v[176:191], v[76:79], v[92:95], v[176:191]
    ds_read_b64_tr_b16 v[62:63], v29 offset:9216
    v_mfma_f32_32x32x16_bf16 v[192:207], v[80:83], v[88:91], v[192:207]
    s_add_u32 m0, s78, 3072
    s_add_u32 s59, s67, 24576
    buffer_load_dwordx4 v37, s[16:19], s59 offen lds
    v_mfma_f32_32x32x16_bf16 v[208:223], v[80:83], v[92:95], v[208:223]
    s_add_u32 s67, s66, 4
    s_cmp_ge_u32 s67, 14
    s_cselect_b32 s59, 14, 0
    s_sub_u32 s67, s67, s59
    s_lshl_b32 s67, s67, 15
    s_add_u32 s67, s77, s67
    v_mfma_f32_32x32x16_bf16 v[224:239], v[84:87], v[88:91], v[224:239]
    s_add_u32 m0, s78, 4096
    s_add_u32 s59, s67, 0
    buffer_load_dwordx4 v37, s[16:19], s59 offen lds
    v_mfma_f32_32x32x16_bf16 v[240:255], v[84:87], v[92:95], v[240:255]
    s_add_u32 m0, s78, 5120
    s_add_u32 s59, s67, 8192
    buffer_load_dwordx4 v37, s[16:19], s59 offen lds
    s_waitcnt lgkmcnt(0)
    v_mfma_f32_32x32x16_bf16 v[128:143], v[48:51], v[64:67], v[128:143]
    ds_read_b128 v[88:91], v17
    ds_read_b64_tr_b16 v[72:73], v26 offset:12288
    ds_read_b64_tr_b16 v[74:75], v26 offset:13312
    v_mfma_f32_32x32x16_bf16 v[144:159], v[48:51], v[68:71], v[144:159]
    ds_read_b128 v[92:95], v17 offset:4096
    ds_read_b64_tr_b16 v[76:77], v27 offset:12288
    ds_read_b64_tr_b16 v[78:79], v27 offset:13312
    v_mfma_f32_32x32x16_bf16 v[160:175], v[52:55], v[64:67], v[160:175]
    ds_read_b64_tr_b16 v[80:81], v28 offset:12288
    ds_read_b64_tr_b16 v[82:83], v28 offset:13312
    ds_read_b64_tr_b16 v[84:85], v29 offset:12288
    v_mfma_f32_32x32x16_bf16 v[176:191], v[52:55], v[68:71], v[176:191]
    ds_read_b64_tr_b16 v[86:87], v29 offset:13312
    v_mfma_f32_32x32x16_bf16 v[192:207], v[56:59], v[64:67], v[192:207]
    s_add_u32 m0, s78, 6144
    s_add_u32 s59, s67, 16384
    buffer_load_dwordx4 v37, s[16:19], s59 offen lds
    v_mfma_f32_32x32x16_bf16 v[208:223], v[56:59], v[68:71], v[208:223]
    s_add_u32 m0, s78, 7168
    s_add_u32 s59, s67, 24576
    buffer_load_dwordx4 v37, s[16:19], s59 offen lds
    v_mfma_f32_32x32x16_bf16 v[224:239], v[60:63], v[64:67], v[224:239]
    s_add_u32 s67, s66, 5
    s_cmp_ge_u32 s67, 14
    s_cselect_b32 s59, 14, 0
    s_sub_u32 s67, s67, s59
    s_lshl_b32 s67, s67, 15
    s_add_u32 s67, s77, s67
    v_mfma_f32_32x32x16_bf16 v[240:255], v[60:63], v[68:71], v[240:255]
    s_add_u32 m0, s78, 8192
    s_add_u32 s59, s67, 0
    buffer_load_dwordx4 v37, s[16:19], s59 offen lds
    s_waitcnt lgkmcnt(0)
    s_barrier
    v_mfma_f32_32x32x16_bf16 v[128:143], v[72:75], v[88:91], v[128:143]
    s_add_u32 m0, s78, 9216
    s_add_u32 s59, s67, 8192
    buffer_load_dwordx4 v37, s[16:19], s59 offen lds
    v_mfma_f32_32x32x16_bf16 v[144:159], v[72:75], v[92:95], v[144:159]
    s_add_u32 m0, s78, 10240
    s_add_u32 s59, s67, 16384
    buffer_load_dwordx4 v37, s[16:19], s59 offen lds
    v_mfma_f32_32x32x16_bf16 v[160:175], v[76:79], v[88:91], v[160:175]
    s_add_u32 m0, s78, 11264
    s_add_u32 s59, s67, 24576
    buffer_load_dwordx4 v37, s[16:19], s59 offen lds
    v_mfma_f32_32x32x16_bf16 v[176:191], v[76:79], v[92:95], v[176:191]
    v_mfma_f32_32x32x16_bf16 v[192:207], v[80:83], v[88:91], v[192:207]
    v_mfma_f32_32x32x16_bf16 v[208:223], v[80:83], v[92:95], v[208:223]
    v_mfma_f32_32x32x16_bf16 v[224:239], v[84:87], v[88:91], v[224:239]
    v_mfma_f32_32x32x16_bf16 v[240:255], v[84:87], v[92:95], v[240:255]
    s_waitcnt lgkmcnt(0)
    s_barrier
    s_lshr_b32 s70, s48, 1
    s_lshl_b32 s70, s70, 10
    s_lshr_b32 s71, s2, 3
    s_and_b32 s71, s71, 7
    s_lshl_b32 s71, s71, 7
    s_add_u32 s70, s70, s71
    s_add_u32 s70, s70, 333824
    v_lshlrev_b32 v44, 2, v0
    v_add_u32 v44, s70, v44
    v_cmp_gt_u32 vcc, 16, v0
    v_mov_b32 v47, 2147483632
    s_nop 0
    v_cndmask_b32 v126, v47, v44, vcc
    buffer_load_dword v127, v126, s[20:23], 0 offen sc1
    v_lshrrev_b32 v8, 2, v4
    v_lshl_add_u32 v9, v3, 2, v8
    v_lshlrev_b32 v9, 7, v9
    v_lshrrev_b32 v8, 1, v8
    v_lshl_add_u32 v9, v8, 6, v9
    v_and_b32 v8, 1, v5
    v_lshl_add_u32 v9, v8, 5, v9
    v_and_b32 v8, 3, v4
    v_lshl_add_u32 v9, v8, 3, v9
    s_add_u32 s55, s78, 98304
    v_add_u32 v10, s55, v9
    v_xor_b32 v11, 64, v10
    s_add_u32 s55, s78, 0
    v_add_u32 v12, s55, v9
    v_xor_b32 v13, 64, v12
    s_add_u32 s55, s74, 49152
    v_add_u32 v38, s55, v9
    v_xor_b32 v39, 64, v38
    s_waitcnt vmcnt(30)
    v_xor_b32 v43, v46, v115
    v_xor_b32 v44, v46, v119
    v_or_b32 v43, v43, v44
    v_cmp_ne_u32 vcc, 0, v43
    s_cbranch_vccnz L_sslow_15
L_sback_16:
    s_mov_b32 s55, 0xbfb8aa3b
    v_sub_f32 v48, 0, v112
    v_mul_f32 v52, s55, v113
    v_mov_b32 v56, v114
    v_sub_f32 v50, 0, v116
    s_add_u32 s67, s66, 6
    s_cmp_ge_u32 s67, 14
    s_cselect_b32 s59, 14, 0
    s_sub_u32 s67, s67, s59
    s_lshl_b32 s67, s67, 15
    s_add_u32 s67, s77, s67
    v_mul_f32 v54, s55, v117
    v_mov_b32 v58, v118
    s_mul_i32 s56, s60, 512
    s_add_u32 s56, s56, 147456
    v_lshlrev_b32 v9, 4, v3
    v_add_u32 v9, s56, v9
    s_lshl_b32 s56, s45, 1
    s_add_u32 s56, s56, s61
    s_mul_i32 s56, s56, 229376
    s_lshr_b32 s57, s62, 4
    s_add_u32 m0, s74, 49152
    s_add_u32 s59, s67, 0
    buffer_load_dwordx4 v37, s[16:19], s59 offen lds
    s_mul_i32 s58, s60, 4
    s_add_u32 s57, s57, s58
    s_lshl_b32 s57, s57, 11
    s_add_u32 s56, s56, s57
    s_add_u32 s56, s56, 5242880
    ds_read_b128 v[60:63], v9 offset:0
    ds_read_b128 v[64:67], v9 offset:32
    ds_read_b128 v[68:71], v9 offset:64
    ds_read_b128 v[72:75], v9 offset:96
    ds_read_b128 v[96:99], v9 offset:128
    s_add_u32 m0, s74, 50176
    s_add_u32 s59, s67, 8192
    buffer_load_dwordx4 v37, s[16:19], s59 offen lds
    ds_read_b128 v[100:103], v9 offset:160
    ds_read_b128 v[104:107], v9 offset:192
    ds_read_b128 v[108:111], v9 offset:224
    s_waitcnt lgkmcnt(4)
    v_pk_fma_f32 v[76:77], v[60:61], v[48:49], v[128:129] op_sel_hi:[1,0,1]
    v_pk_fma_f32 v[78:79], v[62:63], v[48:49], v[130:131] op_sel_hi:[1,0,1]
    v_pk_fma_f32 v[80:81], v[64:65], v[48:49], v[132:133] op_sel_hi:[1,0,1]
    v_pk_fma_f32 v[82:83], v[66:67], v[48:49], v[134:135] op_sel_hi:[1,0,1]
    v_pk_mul_f32 v[128:129], v[76:77], v[52:53] op_sel_hi:[1,0]
    v_pk_mul_f32 v[130:131], v[78:79], v[52:53] op_sel_hi:[1,0]
    v_pk_mul_f32 v[132:133], v[80:81], v[52:53] op_sel_hi:[1,0]
    s_add_u32 m0, s74, 51200
    s_add_u32 s59, s67, 16384
    buffer_load_dwordx4 v37, s[16:19], s59 offen lds
    v_pk_mul_f32 v[134:135], v[82:83], v[52:53] op_sel_hi:[1,0]
    v_exp_f32 v128, v128
    v_exp_f32 v129, v129
    v_pk_fma_f32 v[84:85], v[68:69], v[48:49], v[136:137] op_sel_hi:[1,0,1]
    v_exp_f32 v130, v130
    v_exp_f32 v131, v131
    v_pk_fma_f32 v[86:87], v[70:71], v[48:49], v[138:139] op_sel_hi:[1,0,1]
    v_exp_f32 v132, v132
    v_exp_f32 v133, v133
    v_pk_fma_f32 v[88:89], v[72:73], v[48:49], v[140:141] op_sel_hi:[1,0,1]
    s_add_u32 m0, s74, 52224
    s_add_u32 s59, s67, 24576
    buffer_load_dwordx4 v37, s[16:19], s59 offen lds
    v_exp_f32 v134, v134
    v_exp_f32 v135, v135
    v_pk_fma_f32 v[90:91], v[74:75], v[48:49], v[142:143] op_sel_hi:[1,0,1]
    v_pk_fma_f32 v[128:129], v[128:129], v[56:57], v[56:57] op_sel_hi:[1,0,0]
    v_pk_fma_f32 v[130:131], v[130:131], v[56:57], v[56:57] op_sel_hi:[1,0,0]
    v_pk_fma_f32 v[132:133], v[132:133], v[56:57], v[56:57] op_sel_hi:[1,0,0]
    v_pk_fma_f32 v[134:135], v[134:135], v[56:57], v[56:57] op_sel_hi:[1,0,0]
    v_rcp_f32 v128, v128
    v_rcp_f32 v129, v129
    v_pk_mul_f32 v[76:77], v[76:77], v[84:85]
    s_add_u32 s67, s66, 7
    s_cmp_ge_u32 s67, 14
    s_cselect_b32 s59, 14, 0
    s_sub_u32 s67, s67, s59
    s_lshl_b32 s67, s67, 15
    s_add_u32 s67, s77, s67
    v_rcp_f32 v130, v130
    v_rcp_f32 v131, v131
    v_pk_mul_f32 v[78:79], v[78:79], v[86:87]
    v_rcp_f32 v132, v132
    v_rcp_f32 v133, v133
    v_pk_mul_f32 v[80:81], v[80:81], v[88:89]
    v_rcp_f32 v134, v134
    v_rcp_f32 v135, v135
    v_pk_mul_f32 v[82:83], v[82:83], v[90:91]
    v_pk_mul_f32 v[76:77], v[76:77], v[128:129]
    s_add_u32 m0, s74, 53248
    s_add_u32 s59, s67, 0
    buffer_load_dwordx4 v37, s[16:19], s59 offen lds
    v_pk_mul_f32 v[78:79], v[78:79], v[130:131]
    v_pk_mul_f32 v[80:81], v[80:81], v[132:133]
    v_pk_mul_f32 v[82:83], v[82:83], v[134:135]
    v_cvt_pk_bf16_f32 v92, v76, v77
    v_cvt_pk_bf16_f32 v93, v78, v79
    v_cvt_pk_bf16_f32 v94, v80, v81
    v_cvt_pk_bf16_f32 v95, v82, v83
    s_add_u32 s57, s56, 0
    buffer_store_dwordx4 v[92:95], v42, s[20:23], s57 offen sc1
    v_pk_fma_f32 v[76:77], v[60:61], v[50:51], v[144:145] op_sel_hi:[1,0,1]
    s_add_u32 m0, s74, 54272
    s_add_u32 s59, s67, 8192
    buffer_load_dwordx4 v37, s[16:19], s59 offen lds
    v_pk_fma_f32 v[78:79], v[62:63], v[50:51], v[146:147] op_sel_hi:[1,0,1]
    v_pk_fma_f32 v[80:81], v[64:65], v[50:51], v[148:149] op_sel_hi:[1,0,1]
    v_pk_fma_f32 v[82:83], v[66:67], v[50:51], v[150:151] op_sel_hi:[1,0,1]
    v_pk_mul_f32 v[144:145], v[76:77], v[54:55] op_sel_hi:[1,0]
    v_pk_mul_f32 v[146:147], v[78:79], v[54:55] op_sel_hi:[1,0]
    v_pk_mul_f32 v[148:149], v[80:81], v[54:55] op_sel_hi:[1,0]
    v_pk_mul_f32 v[150:151], v[82:83], v[54:55] op_sel_hi:[1,0]
    v_exp_f32 v144, v144
    v_exp_f32 v145, v145
    v_pk_fma_f32 v[84:85], v[68:69], v[50:51], v[152:153] op_sel_hi:[1,0,1]
    s_add_u32 m0, s74, 55296
    s_add_u32 s59, s67, 16384
    buffer_load_dwordx4 v37, s[16:19], s59 offen lds
    v_exp_f32 v146, v146
    v_exp_f32 v147, v147
    v_pk_fma_f32 v[86:87], v[70:71], v[50:51], v[154:155] op_sel_hi:[1,0,1]
    v_exp_f32 v148, v148
    v_exp_f32 v149, v149
    v_pk_fma_f32 v[88:89], v[72:73], v[50:51], v[156:157] op_sel_hi:[1,0,1]
    v_exp_f32 v150, v150
    v_exp_f32 v151, v151
    v_pk_fma_f32 v[90:91], v[74:75], v[50:51], v[158:159] op_sel_hi:[1,0,1]
    v_pk_fma_f32 v[144:145], v[144:145], v[58:59], v[58:59] op_sel_hi:[1,0,0]
    s_add_u32 m0, s74, 56320
    s_add_u32 s59, s67, 24576
    buffer_load_dwordx4 v37, s[16:19], s59 offen lds
    s_waitcnt vmcnt(10)
    v_pk_fma_f32 v[146:147], v[146:147], v[58:59], v[58:59] op_sel_hi:[1,0,0]
    v_pk_fma_f32 v[148:149], v[148:149], v[58:59], v[58:59] op_sel_hi:[1,0,0]
    v_pk_fma_f32 v[150:151], v[150:151], v[58:59], v[58:59] op_sel_hi:[1,0,0]
    v_rcp_f32 v144, v144
    v_rcp_f32 v145, v145
    v_pk_mul_f32 v[76:77], v[76:77], v[84:85]
    v_rcp_f32 v146, v146
    v_rcp_f32 v147, v147
    v_pk_mul_f32 v[78:79], v[78:79], v[86:87]
    v_rcp_f32 v148, v148
    ds_read_b64_tr_b16 a[0:1], v10 offset:0
    ds_read_b64_tr_b16 a[2:3], v10 offset:1024
    ds_read_b64_tr_b16 a[4:5], v11 offset:0
    ds_read_b64_tr_b16 a[6:7], v11 offset:1024
    v_rcp_f32 v149, v149
    v_pk_mul_f32 v[80:81], v[80:81], v[88:89]
    v_rcp_f32 v150, v150
    v_rcp_f32 v151, v151
    v_pk_mul_f32 v[82:83], v[82:83], v[90:91]
    v_pk_mul_f32 v[76:77], v[76:77], v[144:145]
    v_pk_mul_f32 v[78:79], v[78:79], v[146:147]
    v_pk_mul_f32 v[80:81], v[80:81], v[148:149]
    v_pk_mul_f32 v[82:83], v[82:83], v[150:151]
    v_cvt_pk_bf16_f32 v120, v76, v77
    ds_read_b64_tr_b16 a[8:9], v10 offset:2048
    ds_read_b64_tr_b16 a[10:11], v10 offset:3072
    ds_read_b64_tr_b16 a[12:13], v11 offset:2048
    ds_read_b64_tr_b16 a[14:15], v11 offset:3072
    v_cvt_pk_bf16_f32 v121, v78, v79
    v_cvt_pk_bf16_f32 v122, v80, v81
    v_cvt_pk_bf16_f32 v123, v82, v83
    s_add_u32 s57, s56, 1024
    buffer_store_dwordx4 v[120:123], v42, s[20:23], s57 offen sc1
    ds_read_b128 v[60:63], v9 offset:256
    ds_read_b128 v[64:67], v9 offset:288
    ds_read_b128 v[68:71], v9 offset:320
    ds_read_b128 v[72:75], v9 offset:352
    s_waitcnt lgkmcnt(12)
    v_pk_fma_f32 v[76:77], v[96:97], v[48:49], v[160:161] op_sel_hi:[1,0,1]
    ds_read_b64_tr_b16 a[16:17], v10 offset:4096
    ds_read_b64_tr_b16 a[18:19], v10 offset:5120
    ds_read_b64_tr_b16 a[20:21], v11 offset:4096
    ds_read_b64_tr_b16 a[22:23], v11 offset:5120
    v_pk_fma_f32 v[78:79], v[98:99], v[48:49], v[162:163] op_sel_hi:[1,0,1]
    v_pk_fma_f32 v[80:81], v[100:101], v[48:49], v[164:165] op_sel_hi:[1,0,1]
    v_pk_fma_f32 v[82:83], v[102:103], v[48:49], v[166:167] op_sel_hi:[1,0,1]
    v_pk_mul_f32 v[160:161], v[76:77], v[52:53] op_sel_hi:[1,0]
    v_pk_mul_f32 v[162:163], v[78:79], v[52:53] op_sel_hi:[1,0]
    v_pk_mul_f32 v[164:165], v[80:81], v[52:53] op_sel_hi:[1,0]
    v_pk_mul_f32 v[166:167], v[82:83], v[52:53] op_sel_hi:[1,0]
    v_exp_f32 v160, v160
    v_exp_f32 v161, v161
    v_pk_fma_f32 v[84:85], v[104:105], v[48:49], v[168:169] op_sel_hi:[1,0,1]
    ds_read_b64_tr_b16 a[24:25], v10 offset:6144
    ds_read_b64_tr_b16 a[26:27], v10 offset:7168
    ds_read_b64_tr_b16 a[28:29], v11 offset:6144
    ds_read_b64_tr_b16 a[30:31], v11 offset:7168
    v_exp_f32 v162, v162
    v_exp_f32 v163, v163
    v_pk_fma_f32 v[86:87], v[106:107], v[48:49], v[170:171] op_sel_hi:[1,0,1]
    v_exp_f32 v164, v164
    v_exp_f32 v165, v165
    v_pk_fma_f32 v[88:89], v[108:109], v[48:49], v[172:173] op_sel_hi:[1,0,1]
    v_exp_f32 v166, v166
    v_exp_f32 v167, v167
    v_pk_fma_f32 v[90:91], v[110:111], v[48:49], v[174:175] op_sel_hi:[1,0,1]
    v_pk_fma_f32 v[160:161], v[160:161], v[56:57], v[56:57] op_sel_hi:[1,0,0]
    ds_read_b64_tr_b16 a[32:33], v10 offset:8192
    ds_read_b64_tr_b16 a[34:35], v10 offset:9216
    ds_read_b64_tr_b16 a[36:37], v11 offset:8192
    ds_read_b64_tr_b16 a[38:39], v11 offset:9216
    v_pk_fma_f32 v[162:163], v[162:163], v[56:57], v[56:57] op_sel_hi:[1,0,0]
    v_pk_fma_f32 v[164:165], v[164:165], v[56:57], v[56:57] op_sel_hi:[1,0,0]
    v_pk_fma_f32 v[166:167], v[166:167], v[56:57], v[56:57] op_sel_hi:[1,0,0]
    v_rcp_f32 v160, v160
    v_rcp_f32 v161, v161
    v_pk_mul_f32 v[76:77], v[76:77], v[84:85]
    v_rcp_f32 v162, v162
    v_rcp_f32 v163, v163
    v_pk_mul_f32 v[78:79], v[78:79], v[86:87]
    v_rcp_f32 v164, v164
    ds_read_b64_tr_b16 a[40:41], v10 offset:10240
    ds_read_b64_tr_b16 a[42:43], v10 offset:11264
    ds_read_b64_tr_b16 a[44:45], v11 offset:10240
    ds_read_b64_tr_b16 a[46:47], v11 offset:11264
    v_rcp_f32 v165, v165
    v_pk_mul_f32 v[80:81], v[80:81], v[88:89]
    v_rcp_f32 v166, v166
    v_rcp_f32 v167, v167
    v_pk_mul_f32 v[82:83], v[82:83], v[90:91]
    v_pk_mul_f32 v[76:77], v[76:77], v[160:161]
    v_pk_mul_f32 v[78:79], v[78:79], v[162:163]
    v_pk_mul_f32 v[80:81], v[80:81], v[164:165]
    v_pk_mul_f32 v[82:83], v[82:83], v[166:167]
    v_cvt_pk_bf16_f32 v92, v76, v77
    ds_read_b64_tr_b16 a[48:49], v12 offset:0
    ds_read_b64_tr_b16 a[50:51], v12 offset:1024
    ds_read_b64_tr_b16 a[52:53], v13 offset:0
    ds_read_b64_tr_b16 a[54:55], v13 offset:1024
    v_cvt_pk_bf16_f32 v93, v78, v79
    v_cvt_pk_bf16_f32 v94, v80, v81
    v_cvt_pk_bf16_f32 v95, v82, v83
    s_add_u32 s57, s56, 2048
    buffer_store_dwordx4 v[92:95], v42, s[20:23], s57 offen sc1
    v_pk_fma_f32 v[76:77], v[96:97], v[50:51], v[176:177] op_sel_hi:[1,0,1]
    v_pk_fma_f32 v[78:79], v[98:99], v[50:51], v[178:179] op_sel_hi:[1,0,1]
    v_pk_fma_f32 v[80:81], v[100:101], v[50:51], v[180:181] op_sel_hi:[1,0,1]
    v_pk_fma_f32 v[82:83], v[102:103], v[50:51], v[182:183] op_sel_hi:[1,0,1]
    v_pk_mul_f32 v[176:177], v[76:77], v[54:55] op_sel_hi:[1,0]
    ds_read_b64_tr_b16 a[56:57], v12 offset:2048
    ds_read_b64_tr_b16 a[58:59], v12 offset:3072
    ds_read_b64_tr_b16 a[60:61], v13 offset:2048
    ds_read_b64_tr_b16 a[62:63], v13 offset:3072
    v_pk_mul_f32 v[178:179], v[78:79], v[54:55] op_sel_hi:[1,0]
    v_pk_mul_f32 v[180:181], v[80:81], v[54:55] op_sel_hi:[1,0]
    v_pk_mul_f32 v[182:183], v[82:83], v[54:55] op_sel_hi:[1,0]
    v_exp_f32 v176, v176
    v_exp_f32 v177, v177
    v_pk_fma_f32 v[84:85], v[104:105], v[50:51], v[184:185] op_sel_hi:[1,0,1]
    v_exp_f32 v178, v178
    v_exp_f32 v179, v179
    v_pk_fma_f32 v[86:87], v[106:107], v[50:51], v[186:187] op_sel_hi:[1,0,1]
    v_exp_f32 v180, v180
    ds_read_b64_tr_b16 a[64:65], v12 offset:4096
    ds_read_b64_tr_b16 a[66:67], v12 offset:5120
    ds_read_b64_tr_b16 a[68:69], v13 offset:4096
    ds_read_b64_tr_b16 a[70:71], v13 offset:5120
    v_exp_f32 v181, v181
    v_pk_fma_f32 v[88:89], v[108:109], v[50:51], v[188:189] op_sel_hi:[1,0,1]
    v_exp_f32 v182, v182
    v_exp_f32 v183, v183
    v_pk_fma_f32 v[90:91], v[110:111], v[50:51], v[190:191] op_sel_hi:[1,0,1]
    v_pk_fma_f32 v[176:177], v[176:177], v[58:59], v[58:59] op_sel_hi:[1,0,0]
    v_pk_fma_f32 v[178:179], v[178:179], v[58:59], v[58:59] op_sel_hi:[1,0,0]
    v_pk_fma_f32 v[180:181], v[180:181], v[58:59], v[58:59] op_sel_hi:[1,0,0]
    v_pk_fma_f32 v[182:183], v[182:183], v[58:59], v[58:59] op_sel_hi:[1,0,0]
    v_rcp_f32 v176, v176
    ds_read_b64_tr_b16 a[72:73], v12 offset:6144
    ds_read_b64_tr_b16 a[74:75], v12 offset:7168
    ds_read_b64_tr_b16 a[76:77], v13 offset:6144
    ds_read_b64_tr_b16 a[78:79], v13 offset:7168
    v_rcp_f32 v177, v177
    v_pk_mul_f32 v[76:77], v[76:77], v[84:85]
    v_rcp_f32 v178, v178
    v_rcp_f32 v179, v179
    v_pk_mul_f32 v[78:79], v[78:79], v[86:87]
    v_rcp_f32 v180, v180
    v_rcp_f32 v181, v181
    v_pk_mul_f32 v[80:81], v[80:81], v[88:89]
    v_rcp_f32 v182, v182
    v_rcp_f32 v183, v183
    ds_read_b64_tr_b16 a[96:97], v12 offset:8192
    ds_read_b64_tr_b16 a[98:99], v12 offset:9216
    ds_read_b64_tr_b16 a[100:101], v13 offset:8192
    ds_read_b64_tr_b16 a[102:103], v13 offset:9216
    v_pk_mul_f32 v[82:83], v[82:83], v[90:91]
    v_pk_mul_f32 v[76:77], v[76:77], v[176:177]
    v_pk_mul_f32 v[78:79], v[78:79], v[178:179]
    v_pk_mul_f32 v[80:81], v[80:81], v[180:181]
    v_pk_mul_f32 v[82:83], v[82:83], v[182:183]
    v_cvt_pk_bf16_f32 v120, v76, v77
    v_cvt_pk_bf16_f32 v121, v78, v79
    v_cvt_pk_bf16_f32 v122, v80, v81
    v_cvt_pk_bf16_f32 v123, v82, v83
    s_add_u32 s57, s56, 3072
    ds_read_b64_tr_b16 a[104:105], v12 offset:10240
    ds_read_b64_tr_b16 a[106:107], v12 offset:11264
    ds_read_b64_tr_b16 a[108:109], v13 offset:10240
    ds_read_b64_tr_b16 a[110:111], v13 offset:11264
    s_waitcnt lgkmcnt(0)
    buffer_store_dwordx4 v[120:123], v42, s[20:23], s57 offen sc1
    v_cmp_gt_u32 vcc, 16, v0
    v_mov_b32 v47, 0
    s_nop 0
    v_cndmask_b32 v43, v47, v46, vcc
    s_waitcnt vmcnt(12)
    v_cmp_ne_u32 vcc, v43, v127
    s_cbranch_vccnz L_slow_18
L_back_19:
    s_barrier
    s_lshl_b32 s70, s47, 5
    s_lshl_b32 s71, s44, 3
    s_add_u32 s70, s70, s71
    s_add_u32 s67, s66, 8
    s_cmp_ge_u32 s67, 14
    s_cselect_b32 s59, 14, 0
    s_sub_u32 s67, s67, s59
    s_lshl_b32 s67, s67, 15
    s_add_u32 s67, s77, s67
    s_lshl_b32 s70, s70, 3
    s_add_u32 s70, s70, s48
    s_lshl_b32 s70, s70, 8
    s_add_u32 s70, s70, 1048576
    v_lshlrev_b32 v44, 3, v2
    v_lshl_add_u32 v44, v3, 13, v44
    buffer_load_dwordx2 v[14:15], v44, s[20:23], s70 offen offset:0 sc1
    buffer_load_dwordx2 v[16:17], v44, s[20:23], s70 offen offset:2048 sc1
    s_add_u32 s70, s70, 4096
    buffer_load_dwordx2 v[18:19], v44, s[20:23], s70 offen offset:0 sc1
    s_add_u32 m0, s78, 98304
    s_add_u32 s59, s67, 0
    buffer_load_dwordx4 v37, s[16:19], s59 offen lds
    buffer_load_dwordx2 v[20:21], v44, s[20:23], s70 offen offset:2048 sc1
    ds_read_b128 v[96:99], v9 offset:384
    ds_read_b128 v[100:103], v9 offset:416
    ds_read_b128 v[104:107], v9 offset:448
    ds_read_b128 v[108:111], v9 offset:480
    v_pk_fma_f32 v[76:77], v[60:61], v[48:49], v[192:193] op_sel_hi:[1,0,1]
    v_pk_fma_f32 v[78:79], v[62:63], v[48:49], v[194:195] op_sel_hi:[1,0,1]
    v_pk_fma_f32 v[80:81], v[64:65], v[48:49], v[196:197] op_sel_hi:[1,0,1]
    v_pk_fma_f32 v[82:83], v[66:67], v[48:49], v[198:199] op_sel_hi:[1,0,1]
    v_pk_mul_f32 v[192:193], v[76:77], v[52:53] op_sel_hi:[1,0]
    s_add_u32 m0, s78, 99328
    s_add_u32 s59, s67, 8192
    buffer_load_dwordx4 v37, s[16:19], s59 offen lds
    v_pk_mul_f32 v[194:195], v[78:79], v[52:53] op_sel_hi:[1,0]
    v_pk_mul_f32 v[196:197], v[80:81], v[52:53] op_sel_hi:[1,0]
    v_pk_mul_f32 v[198:199], v[82:83], v[52:53] op_sel_hi:[1,0]
    v_exp_f32 v192, v192
    v_exp_f32 v193, v193
    v_pk_fma_f32 v[84:85], v[68:69], v[48:49], v[200:201] op_sel_hi:[1,0,1]
    v_exp_f32 v194, v194
    v_exp_f32 v195, v195
    v_pk_fma_f32 v[86:87], v[70:71], v[48:49], v[202:203] op_sel_hi:[1,0,1]
    v_exp_f32 v196, v196
    s_add_u32 m0, s78, 100352
    s_add_u32 s59, s67, 16384
    buffer_load_dwordx4 v37, s[16:19], s59 offen lds
    v_exp_f32 v197, v197
    v_pk_fma_f32 v[88:89], v[72:73], v[48:49], v[204:205] op_sel_hi:[1,0,1]
    v_exp_f32 v198, v198
    v_exp_f32 v199, v199
    v_pk_fma_f32 v[90:91], v[74:75], v[48:49], v[206:207] op_sel_hi:[1,0,1]
    v_pk_fma_f32 v[192:193], v[192:193], v[56:57], v[56:57] op_sel_hi:[1,0,0]
    v_pk_fma_f32 v[194:195], v[194:195], v[56:57], v[56:57] op_sel_hi:[1,0,0]
    v_pk_fma_f32 v[196:197], v[196:197], v[56:57], v[56:57] op_sel_hi:[1,0,0]
    v_pk_fma_f32 v[198:199], v[198:199], v[56:57], v[56:57] op_sel_hi:[1,0,0]
    v_rcp_f32 v192, v192
    s_add_u32 m0, s78, 101376
    s_add_u32 s59, s67, 24576
    buffer_load_dwordx4 v37, s[16:19], s59 offen lds
    v_rcp_f32 v193, v193
    v_pk_mul_f32 v[76:77], v[76:77], v[84:85]
    v_rcp_f32 v194, v194
    v_rcp_f32 v195, v195
    v_pk_mul_f32 v[78:79], v[78:79], v[86:87]
    v_rcp_f32 v196, v196
    v_rcp_f32 v197, v197
    v_pk_mul_f32 v[80:81], v[80:81], v[88:89]
    v_rcp_f32 v198, v198
    v_rcp_f32 v199, v199
    s_add_u32 s67, s66, 9
    s_cmp_ge_u32 s67, 14
    s_cselect_b32 s59, 14, 0
    s_sub_u32 s67, s67, s59
    s_lshl_b32 s67, s67, 15
    s_add_u32 s67, s77, s67
    v_pk_mul_f32 v[82:83], v[82:83], v[90:91]
    v_pk_mul_f32 v[76:77], v[76:77], v[192:193]
    v_pk_mul_f32 v[78:79], v[78:79], v[194:195]
    v_pk_mul_f32 v[80:81], v[80:81], v[196:197]
    v_pk_mul_f32 v[82:83], v[82:83], v[198:199]
    v_cvt_pk_bf16_f32 v92, v76, v77
    v_cvt_pk_bf16_f32 v93, v78, v79
    v_cvt_pk_bf16_f32 v94, v80, v81
    v_cvt_pk_bf16_f32 v95, v82, v83
    s_add_u32 s57, s56, 4096
    s_add_u32 m0, s78, 102400
    s_add_u32 s59, s67, 0
    buffer_load_dwordx4 v37, s[16:19], s59 offen lds
    buffer_store_dwordx4 v[92:95], v42, s[20:23], s57 offen sc1
    v_pk_fma_f32 v[76:77], v[60:61], v[50:51], v[208:209] op_sel_hi:[1,0,1]
    v_pk_fma_f32 v[78:79], v[62:63], v[50:51], v[210:211] op_sel_hi:[1,0,1]
    v_pk_fma_f32 v[80:81], v[64:65], v[50:51], v[212:213] op_sel_hi:[1,0,1]
    v_pk_fma_f32 v[82:83], v[66:67], v[50:51], v[214:215] op_sel_hi:[1,0,1]
    v_pk_mul_f32 v[208:209], v[76:77], v[54:55] op_sel_hi:[1,0]
    v_pk_mul_f32 v[210:211], v[78:79], v[54:55] op_sel_hi:[1,0]
    v_pk_mul_f32 v[212:213], v[80:81], v[54:55] op_sel_hi:[1,0]
    v_pk_mul_f32 v[214:215], v[82:83], v[54:55] op_sel_hi:[1,0]
    v_exp_f32 v208, v208
    s_add_u32 m0, s78, 103424
    s_add_u32 s59, s67, 8192
    buffer_load_dwordx4 v37, s[16:19], s59 offen lds
    v_exp_f32 v209, v209
    v_pk_fma_f32 v[84:85], v[68:69], v[50:51], v[216:217] op_sel_hi:[1,0,1]
    v_exp_f32 v210, v210
    v_exp_f32 v211, v211
    v_pk_fma_f32 v[86:87], v[70:71], v[50:51], v[218:219] op_sel_hi:[1,0,1]
    v_exp_f32 v212, v212
    v_exp_f32 v213, v213
    v_pk_fma_f32 v[88:89], v[72:73], v[50:51], v[220:221] op_sel_hi:[1,0,1]
    v_exp_f32 v214, v214
    v_exp_f32 v215, v215
    s_add_u32 m0, s78, 104448
    s_add_u32 s59, s67, 16384
    buffer_load_dwordx4 v37, s[16:19], s59 offen lds
    v_pk_fma_f32 v[90:91], v[74:75], v[50:51], v[222:223] op_sel_hi:[1,0,1]
    v_pk_fma_f32 v[208:209], v[208:209], v[58:59], v[58:59] op_sel_hi:[1,0,0]
    v_pk_fma_f32 v[210:211], v[210:211], v[58:59], v[58:59] op_sel_hi:[1,0,0]
    v_pk_fma_f32 v[212:213], v[212:213], v[58:59], v[58:59] op_sel_hi:[1,0,0]
    v_pk_fma_f32 v[214:215], v[214:215], v[58:59], v[58:59] op_sel_hi:[1,0,0]
    v_rcp_f32 v208, v208
    v_rcp_f32 v209, v209
    v_pk_mul_f32 v[76:77], v[76:77], v[84:85]
    v_rcp_f32 v210, v210
    v_rcp_f32 v211, v211
    s_add_u32 m0, s78, 105472
    s_add_u32 s59, s67, 24576
    buffer_load_dwordx4 v37, s[16:19], s59 offen lds
    v_pk_mul_f32 v[78:79], v[78:79], v[86:87]
    v_rcp_f32 v212, v212
    v_rcp_f32 v213, v213
    v_pk_mul_f32 v[80:81], v[80:81], v[88:89]
    v_rcp_f32 v214, v214
    v_rcp_f32 v215, v215
    v_pk_mul_f32 v[82:83], v[82:83], v[90:91]
    v_pk_mul_f32 v[76:77], v[76:77], v[208:209]
    v_pk_mul_f32 v[78:79], v[78:79], v[210:211]
    v_pk_mul_f32 v[80:81], v[80:81], v[212:213]
    s_add_u32 s67, s66, 10
    s_cmp_ge_u32 s67, 14
    s_cselect_b32 s59, 14, 0
    s_sub_u32 s67, s67, s59
    s_lshl_b32 s67, s67, 15
    s_add_u32 s67, s77, s67
    v_pk_mul_f32 v[82:83], v[82:83], v[214:215]
    v_cvt_pk_bf16_f32 v120, v76, v77
    v_cvt_pk_bf16_f32 v121, v78, v79
    v_cvt_pk_bf16_f32 v122, v80, v81
    v_cvt_pk_bf16_f32 v123, v82, v83
    s_add_u32 s57, s56, 5120
    buffer_store_dwordx4 v[120:123], v42, s[20:23], s57 offen sc1
    s_waitcnt lgkmcnt(0)
    v_pk_fma_f32 v[76:77], v[96:97], v[48:49], v[224:225] op_sel_hi:[1,0,1]
    v_pk_fma_f32 v[78:79], v[98:99], v[48:49], v[226:227] op_sel_hi:[1,0,1]
    v_pk_fma_f32 v[80:81], v[100:101], v[48:49], v[228:229] op_sel_hi:[1,0,1]
    s_add_u32 m0, s78, 106496
    s_add_u32 s59, s67, 0
    buffer_load_dwordx4 v37, s[16:19], s59 offen lds
    v_pk_fma_f32 v[82:83], v[102:103], v[48:49], v[230:231] op_sel_hi:[1,0,1]
    v_pk_mul_f32 v[224:225], v[76:77], v[52:53] op_sel_hi:[1,0]
    v_pk_mul_f32 v[226:227], v[78:79], v[52:53] op_sel_hi:[1,0]
    v_pk_mul_f32 v[228:229], v[80:81], v[52:53] op_sel_hi:[1,0]
    v_pk_mul_f32 v[230:231], v[82:83], v[52:53] op_sel_hi:[1,0]
    v_exp_f32 v224, v224
    v_exp_f32 v225, v225
    v_pk_fma_f32 v[84:85], v[104:105], v[48:49], v[232:233] op_sel_hi:[1,0,1]
    v_exp_f32 v226, v226
    v_exp_f32 v227, v227
    s_add_u32 m0, s78, 107520
    s_add_u32 s59, s67, 8192
    buffer_load_dwordx4 v37, s[16:19], s59 offen lds
    v_pk_fma_f32 v[86:87], v[106:107], v[48:49], v[234:235] op_sel_hi:[1,0,1]
    v_exp_f32 v228, v228
    v_exp_f32 v229, v229
    v_pk_fma_f32 v[88:89], v[108:109], v[48:49], v[236:237] op_sel_hi:[1,0,1]
    v_exp_f32 v230, v230
    v_exp_f32 v231, v231
    v_pk_fma_f32 v[90:91], v[110:111], v[48:49], v[238:239] op_sel_hi:[1,0,1]
    v_pk_fma_f32 v[224:225], v[224:225], v[56:57], v[56:57] op_sel_hi:[1,0,0]
    v_pk_fma_f32 v[226:227], v[226:227], v[56:57], v[56:57] op_sel_hi:[1,0,0]
    v_pk_fma_f32 v[228:229], v[228:229], v[56:57], v[56:57] op_sel_hi:[1,0,0]
    s_add_u32 m0, s78, 108544
    s_add_u32 s59, s67, 16384
    buffer_load_dwordx4 v37, s[16:19], s59 offen lds
    v_pk_fma_f32 v[230:231], v[230:231], v[56:57], v[56:57] op_sel_hi:[1,0,0]
    v_rcp_f32 v224, v224
    v_rcp_f32 v225, v225
    v_pk_mul_f32 v[76:77], v[76:77], v[84:85]
    v_rcp_f32 v226, v226
    v_rcp_f32 v227, v227
    v_pk_mul_f32 v[78:79], v[78:79], v[86:87]
    v_rcp_f32 v228, v228
    v_rcp_f32 v229, v229
    v_pk_mul_f32 v[80:81], v[80:81], v[88:89]
    s_add_u32 m0, s78, 109568
    s_add_u32 s59, s67, 24576
    buffer_load_dwordx4 v37, s[16:19], s59 offen lds
    v_rcp_f32 v230, v230
    v_rcp_f32 v231, v231
    v_pk_mul_f32 v[82:83], v[82:83], v[90:91]
    v_pk_mul_f32 v[76:77], v[76:77], v[224:225]
    v_pk_mul_f32 v[78:79], v[78:79], v[226:227]
    v_pk_mul_f32 v[80:81], v[80:81], v[228:229]
    v_pk_mul_f32 v[82:83], v[82:83], v[230:231]
    v_cvt_pk_bf16_f32 v92, v76, v77
    v_cvt_pk_bf16_f32 v93, v78, v79
    v_cvt_pk_bf16_f32 v94, v80, v81
    s_add_u32 s67, s66, 11
    s_cmp_ge_u32 s67, 14
    s_cselect_b32 s59, 14, 0
    s_sub_u32 s67, s67, s59
    s_lshl_b32 s67, s67, 15
    s_add_u32 s67, s77, s67
    v_cvt_pk_bf16_f32 v95, v82, v83
    s_add_u32 s57, s56, 6144
    buffer_store_dwordx4 v[92:95], v42, s[20:23], s57 offen sc1
    v_pk_fma_f32 v[76:77], v[96:97], v[50:51], v[240:241] op_sel_hi:[1,0,1]
    v_pk_fma_f32 v[78:79], v[98:99], v[50:51], v[242:243] op_sel_hi:[1,0,1]
    v_pk_fma_f32 v[80:81], v[100:101], v[50:51], v[244:245] op_sel_hi:[1,0,1]
    v_pk_fma_f32 v[82:83], v[102:103], v[50:51], v[246:247] op_sel_hi:[1,0,1]
    v_pk_mul_f32 v[240:241], v[76:77], v[54:55] op_sel_hi:[1,0]
    v_pk_mul_f32 v[242:243], v[78:79], v[54:55] op_sel_hi:[1,0]
    v_pk_mul_f32 v[244:245], v[80:81], v[54:55] op_sel_hi:[1,0]
    s_add_u32 m0, s78, 0
    s_add_u32 s59, s67, 0
    buffer_load_dwordx4 v37, s[16:19], s59 offen lds
    v_pk_mul_f32 v[246:247], v[82:83], v[54:55] op_sel_hi:[1,0]
    v_exp_f32 v240, v240
    v_exp_f32 v241, v241
    v_pk_fma_f32 v[84:85], v[104:105], v[50:51], v[248:249] op_sel_hi:[1,0,1]
    v_exp_f32 v242, v242
    v_exp_f32 v243, v243
    v_pk_fma_f32 v[86:87], v[106:107], v[50:51], v[250:251] op_sel_hi:[1,0,1]
    v_exp_f32 v244, v244
    v_exp_f32 v245, v245
    v_pk_fma_f32 v[88:89], v[108:109], v[50:51], v[252:253] op_sel_hi:[1,0,1]
    s_add_u32 m0, s78, 1024
    s_add_u32 s59, s67, 8192
    buffer_load_dwordx4 v37, s[16:19], s59 offen lds
    v_exp_f32 v246, v246
    v_exp_f32 v247, v247
    v_pk_fma_f32 v[90:91], v[110:111], v[50:51], v[254:255] op_sel_hi:[1,0,1]
    v_pk_fma_f32 v[240:241], v[240:241], v[58:59], v[58:59] op_sel_hi:[1,0,0]
    v_pk_fma_f32 v[242:243], v[242:243], v[58:59], v[58:59] op_sel_hi:[1,0,0]
    v_pk_fma_f32 v[244:245], v[244:245], v[58:59], v[58:59] op_sel_hi:[1,0,0]
    v_pk_fma_f32 v[246:247], v[246:247], v[58:59], v[58:59] op_sel_hi:[1,0,0]
    v_rcp_f32 v240, v240
    v_rcp_f32 v241, v241
    v_pk_mul_f32 v[76:77], v[76:77], v[84:85]
    s_add_u32 m0, s78, 2048
    s_add_u32 s59, s67, 16384
    buffer_load_dwordx4 v37, s[16:19], s59 offen lds
    v_rcp_f32 v242, v242
    v_rcp_f32 v243, v243
    v_pk_mul_f32 v[78:79], v[78:79], v[86:87]
    v_rcp_f32 v244, v244
    v_rcp_f32 v245, v245
    v_pk_mul_f32 v[80:81], v[80:81], v[88:89]
    v_rcp_f32 v246, v246
    v_rcp_f32 v247, v247
    v_pk_mul_f32 v[82:83], v[82:83], v[90:91]
    v_pk_mul_f32 v[76:77], v[76:77], v[240:241]
    s_add_u32 m0, s78, 3072
    s_add_u32 s59, s67, 24576
    buffer_load_dwordx4 v37, s[16:19], s59 offen lds
    v_pk_mul_f32 v[78:79], v[78:79], v[242:243]
    v_pk_mul_f32 v[80:81], v[80:81], v[244:245]
    v_pk_mul_f32 v[82:83], v[82:83], v[246:247]
    v_cvt_pk_bf16_f32 v120, v76, v77
    v_cvt_pk_bf16_f32 v121, v78, v79
    v_cvt_pk_bf16_f32 v122, v80, v81
    v_cvt_pk_bf16_f32 v123, v82, v83
    s_add_u32 s57, s56, 7168
    buffer_store_dwordx4 v[120:123], v42, s[20:23], s57 offen sc1
    s_sub_u32 s55, 64, s47
    s_cmp_eq_u32 s47, 0
    s_cselect_b32 s55, 32, s55
    s_lshl_b32 s56, s44, 3
    v_lshl_add_u32 v9, v3, 2, s56
    v_cvt_f32_u32 v9, v9
    v_cvt_f32_u32 v112, s47
    v_mul_f32 v112, 0x3a000000, v112
    v_mul_f32 v113, v112, v9
    v_cos_f32 v176, v113
    v_sin_f32 v184, v113
    v_fmamk_f32 v8, v112, 0x3f800000, v113
    s_add_u32 s67, s66, 12
    s_cmp_ge_u32 s67, 14
    s_cselect_b32 s59, 14, 0
    s_sub_u32 s67, s67, s59
    s_lshl_b32 s67, s67, 15
    s_add_u32 s67, s77, s67
    v_cos_f32 v177, v8
    v_sin_f32 v185, v8
    v_fmamk_f32 v8, v112, 0x40000000, v113
    v_cos_f32 v178, v8
    v_sin_f32 v186, v8
    v_fmamk_f32 v8, v112, 0x40400000, v113
    v_cos_f32 v179, v8
    v_sin_f32 v187, v8
    v_cvt_f32_u32 v112, s55
    v_mul_f32 v112, 0x3a000000, v112
    v_mul_f32 v113, v112, v9
    v_cos_f32 v180, v113
    s_add_u32 m0, s78, 4096
    s_add_u32 s59, s67, 0
    buffer_load_dwordx4 v37, s[16:19], s59 offen lds
    v_sin_f32 v188, v113
    v_fmamk_f32 v8, v112, 0x3f800000, v113
    v_cos_f32 v181, v8
    v_sin_f32 v189, v8
    v_fmamk_f32 v8, v112, 0x40000000, v113
    v_cos_f32 v182, v8
    v_sin_f32 v190, v8
    v_fmamk_f32 v8, v112, 0x40400000, v113
    v_cos_f32 v183, v8
    v_sin_f32 v191, v8
    s_lshl_b32 s56, s60, 4
    v_lshl_add_u32 v9, v3, 2, s56
    s_add_u32 m0, s78, 5120
    s_add_u32 s59, s67, 8192
    buffer_load_dwordx4 v37, s[16:19], s59 offen lds
    v_cvt_f32_u32 v9, v9
    v_cvt_f32_u32 v112, s76
    v_mul_f32 v112, 0x3a000000, v112
    v_mul_f32 v113, v112, v9
    v_cos_f32 v48, v113
    v_sin_f32 v56, v113
    v_fmamk_f32 v8, v112, 0x3f800000, v113
    v_cos_f32 v49, v8
    v_sin_f32 v57, v8
    v_fmamk_f32 v8, v112, 0x40000000, v113
    v_cos_f32 v50, v8
    v_sin_f32 v58, v8
    s_add_u32 m0, s78, 6144
    s_add_u32 s59, s67, 16384
    buffer_load_dwordx4 v37, s[16:19], s59 offen lds
    v_fmamk_f32 v8, v112, 0x40400000, v113
    v_cos_f32 v51, v8
    v_sin_f32 v59, v8
    v_fmamk_f32 v8, v112, 0x41000000, v113
    v_cos_f32 v52, v8
    v_sin_f32 v60, v8
    v_fmamk_f32 v8, v112, 0x41100000, v113
    v_cos_f32 v53, v8
    v_sin_f32 v61, v8
    v_fmamk_f32 v8, v112, 0x41200000, v113
    v_cos_f32 v54, v8
    v_sin_f32 v62, v8
    s_add_u32 m0, s78, 7168
    s_add_u32 s59, s67, 24576
    buffer_load_dwordx4 v37, s[16:19], s59 offen lds
    v_fmamk_f32 v8, v112, 0x41300000, v113
    v_cos_f32 v55, v8
    v_sin_f32 v63, v8
    s_cmp_eq_u32 s48, 0
    s_cbranch_scc0 L_nyq_21
    s_lshl_b32 s55, s44, 10
    s_add_u32 s55, s55, 154624
    v_lshlrev_b32 v8, 6, v4
    v_add_u32 v8, s55, v8
    s_mov_b32 exec_lo, 0xffff
    s_mov_b32 exec_hi, 0
    s_lshl_b32 s55, s44, 9
    s_add_u32 s55, s55, 148480
    v_lshlrev_b32 v9, 2, v4
    v_add_u32 v9, s55, v9
    ds_read_b32 v112, v9
    ds_read_b32 v113, v9 offset:256
    s_waitcnt lgkmcnt(0)
    ds_write_b16_d16_hi v8, v112
    ds_write_b16_d16_hi v8, v113 offset:4096
    s_mov_b64 exec, -1
    s_waitcnt lgkmcnt(0)
L_nyq_21:
    s_lshl_b32 s55, s44, 10
    s_add_u32 s67, s66, 13
    s_cmp_ge_u32 s67, 14
    s_cselect_b32 s59, 14, 0
    s_sub_u32 s67, s67, s59
    s_lshl_b32 s67, s67, 15
    s_add_u32 s67, s77, s67
    s_add_u32 s55, s55, 154624
    v_lshlrev_b32 v8, 1, v2
    v_lshl_add_u32 v8, v3, 8, v8
    v_add_u32 v8, s55, v8
    v_mov_b32 v64, 0
    v_mov_b32 v65, 0
    v_mov_b32 v66, 0
    v_mov_b32 v67, 0
    v_mov_b32 v68, 0
    v_mov_b32 v69, 0
    v_mov_b32 v70, 0
    v_mov_b32 v71, 0
    s_add_u32 m0, s78, 8192
    s_add_u32 s59, s67, 0
    buffer_load_dwordx4 v37, s[16:19], s59 offen lds
    v_mov_b32 v72, 0
    v_mov_b32 v73, 0
    v_mov_b32 v74, 0
    v_mov_b32 v75, 0
    v_mov_b32 v76, 0
    v_mov_b32 v77, 0
    v_mov_b32 v78, 0
    v_mov_b32 v79, 0
    ds_read_u16_d16_hi v64, v8 offset:0
    ds_read_u16_d16_hi v72, v8 offset:4096
    ds_read_u16_d16_hi v65, v8 offset:64
    ds_read_u16_d16_hi v73, v8 offset:4160
    s_add_u32 m0, s78, 9216
    s_add_u32 s59, s67, 8192
    buffer_load_dwordx4 v37, s[16:19], s59 offen lds
    ds_read_u16_d16_hi v66, v8 offset:128
    ds_read_u16_d16_hi v74, v8 offset:4224
    ds_read_u16_d16_hi v67, v8 offset:192
    ds_read_u16_d16_hi v75, v8 offset:4288
    ds_read_u16_d16_hi v68, v8 offset:512
    ds_read_u16_d16_hi v76, v8 offset:4608
    ds_read_u16_d16_hi v69, v8 offset:576
    ds_read_u16_d16_hi v77, v8 offset:4672
    ds_read_u16_d16_hi v70, v8 offset:640
    ds_read_u16_d16_hi v78, v8 offset:4736
    ds_read_u16_d16_hi v71, v8 offset:704
    ds_read_u16_d16_hi v79, v8 offset:4800
    s_add_u32 m0, s78, 10240
    s_add_u32 s59, s67, 16384
    buffer_load_dwordx4 v37, s[16:19], s59 offen lds
    s_waitcnt vmcnt(26)
    s_cmp_eq_u32 s47, 0
    s_cbranch_scc1 L_jz_22
    v_lshlrev_b32 v112, 16, v14
    v_and_b32 v113, 0xffff0000, v14
    v_lshlrev_b32 v114, 16, v15
    v_and_b32 v115, 0xffff0000, v15
    v_add_f32 v96, v112, v115
    v_sub_f32 v97, v113, v114
    v_sub_f32 v104, v112, v115
    v_add_f32 v105, v113, v114
    v_lshlrev_b32 v112, 16, v16
    v_and_b32 v113, 0xffff0000, v16
    v_lshlrev_b32 v114, 16, v17
    v_and_b32 v115, 0xffff0000, v17
    v_add_f32 v98, v112, v115
    v_sub_f32 v99, v113, v114
    v_sub_f32 v106, v112, v115
    v_add_f32 v107, v113, v114
    v_lshlrev_b32 v112, 16, v18
    v_and_b32 v113, 0xffff0000, v18
    v_lshlrev_b32 v114, 16, v19
    v_and_b32 v115, 0xffff0000, v19
    v_add_f32 v100, v112, v115
    v_sub_f32 v101, v113, v114
    v_sub_f32 v108, v112, v115
    v_add_f32 v109, v113, v114
    v_lshlrev_b32 v112, 16, v20
    v_and_b32 v113, 0xffff0000, v20
    v_lshlrev_b32 v114, 16, v21
    v_and_b32 v115, 0xffff0000, v21
    v_add_f32 v102, v112, v115
    v_sub_f32 v103, v113, v114
    v_sub_f32 v110, v112, v115
    v_add_f32 v111, v113, v114
    s_branch L_jd_23
L_jz_22:
    v_lshlrev_b32 v96, 16, v14
    v_and_b32 v97, 0xffff0000, v14
    v_lshlrev_b32 v104, 16, v15
    v_and_b32 v105, 0xffff0000, v15
    v_lshlrev_b32 v98, 16, v16
    v_and_b32 v99, 0xffff0000, v16
    v_lshlrev_b32 v106, 16, v17
    v_and_b32 v107, 0xffff0000, v17
    v_lshlrev_b32 v100, 16, v18
    v_and_b32 v101, 0xffff0000, v18
    v_lshlrev_b32 v108, 16, v19
    v_and_b32 v109, 0xffff0000, v19
    v_lshlrev_b32 v102, 16, v20
    v_and_b32 v103, 0xffff0000, v20
    v_lshlrev_b32 v110, 16, v21
    v_and_b32 v111, 0xffff0000, v21
L_jd_23:
    v_mul_f32 v112, v96, v176
    s_add_u32 m0, s78, 11264
    s_add_u32 s59, s67, 24576
    buffer_load_dwordx4 v37, s[16:19], s59 offen lds
    v_mul_f32 v113, v97, v176
    v_fmac_f32 v112, v97, v184
    v_fma_f32 v113, -v96, v184, v113
    v_cvt_pk_bf16_f32 v80, v112, v113
    v_mul_f32 v112, v98, v177
    v_mul_f32 v113, v99, v177
    v_fmac_f32 v112, v99, v185
    v_fma_f32 v113, -v98, v185, v113
    v_cvt_pk_bf16_f32 v81, v112, v113
    v_mul_f32 v112, v100, v178
    v_mul_f32 v113, v101, v178
    v_fmac_f32 v112, v101, v186
    v_fma_f32 v113, -v100, v186, v113
    v_cvt_pk_bf16_f32 v82, v112, v113
    v_mul_f32 v112, v102, v179
    v_mul_f32 v113, v103, v179
    v_fmac_f32 v112, v103, v187
    v_fma_f32 v113, -v102, v187, v113
    v_cvt_pk_bf16_f32 v83, v112, v113
    v_mul_f32 v112, v104, v180
    v_mul_f32 v113, v105, v180
    v_fmac_f32 v112, v105, v188
    v_fma_f32 v113, -v104, v188, v113
    v_cvt_pk_bf16_f32 v84, v112, v113
    v_mul_f32 v112, v106, v181
    v_mul_f32 v113, v107, v181
    v_fmac_f32 v112, v107, v189
    v_fma_f32 v113, -v106, v189, v113
    v_cvt_pk_bf16_f32 v85, v112, v113
    v_mul_f32 v112, v108, v182
    v_mul_f32 v113, v109, v182
    v_fmac_f32 v112, v109, v190
    v_fma_f32 v113, -v108, v190, v113
    v_cvt_pk_bf16_f32 v86, v112, v113
    v_mul_f32 v112, v110, v183
    v_mul_f32 v113, v111, v183
    v_fmac_f32 v112, v111, v191
    v_fma_f32 v113, -v110, v191, v113
    v_cvt_pk_bf16_f32 v87, v112, v113
    s_lshl_b32 s55, s44, 10
    s_add_u32 s55, s55, 81920
    v_add_u32 v8, s55, v42
    ds_write_b128 v8, v[80:83]
    ds_write_b128 v8, v[84:87] offset:4096
    s_waitcnt vmcnt(8)
    s_waitcnt lgkmcnt(0)
    s_barrier
    s_lshl_b32 s70, s45, 7
    s_lshl_b32 s71, s46, 2
    s_add_u32 s70, s70, s71
    s_add_u32 s70, s70, 331776
    v_mov_b32 v44, s70
    v_cmp_gt_u32 vcc, 1, v0
    v_mov_b32 v47, 2147483632
    s_nop 0
    v_cndmask_b32 v43, v47, v44, vcc
    buffer_store_dword v46, v43, s[20:23], 0 offen sc1
    s_lshl_b32 s55, s61, 12
    s_add_u32 s55, s55, 81920
    v_add_u32 v8, s55, v42
    ds_read_b128 v[96:99], v8 offset:0
    ds_read_b128 v[100:103], v8 offset:1024
    ds_read_b128 v[104:107], v8 offset:2048
    ds_read_b128 v[108:111], v8 offset:3072
    s_waitcnt lgkmcnt(3)
    v_mfma_f32_32x32x16_bf16 v[128:143], a[80:83], v[96:99], 0
    s_waitcnt lgkmcnt(2)
    v_mfma_f32_32x32x16_bf16 v[128:143], a[84:87], v[100:103], v[128:143]
    s_waitcnt lgkmcnt(1)
    v_mfma_f32_32x32x16_bf16 v[128:143], a[88:91], v[104:107], v[128:143]
    s_waitcnt lgkmcnt(0)
    v_mfma_f32_32x32x16_bf16 v[128:143], a[92:95], v[108:111], v[128:143]
    s_nop 11
    v_mul_f32 v112, v128, v64
    v_mul_f32 v113, v128, v72
    v_fma_f32 v112, -v136, v72, v112
    v_fma_f32 v113, -v136, v64, -v113
    v_cvt_pk_bf16_f32 v80, v112, v113
    v_mul_f32 v112, v129, v65
    v_mul_f32 v113, v129, v73
    v_fma_f32 v112, -v137, v73, v112
    v_fma_f32 v113, -v137, v65, -v113
    v_cvt_pk_bf16_f32 v81, v112, v113
    v_mul_f32 v112, v130, v66
    v_mul_f32 v113, v130, v74
    v_fma_f32 v112, -v138, v74, v112
    v_fma_f32 v113, -v138, v66, -v113
    v_cvt_pk_bf16_f32 v82, v112, v113
    v_mul_f32 v112, v131, v67
    v_mul_f32 v113, v131, v75
    v_fma_f32 v112, -v139, v75, v112
    v_fma_f32 v113, -v139, v67, -v113
    v_cvt_pk_bf16_f32 v83, v112, v113
    v_mul_f32 v112, v132, v68
    v_mul_f32 v113, v132, v76
    v_fma_f32 v112, -v140, v76, v112
    v_fma_f32 v113, -v140, v68, -v113
    v_cvt_pk_bf16_f32 v84, v112, v113
    v_mul_f32 v112, v133, v69
    v_mul_f32 v113, v133, v77
    v_fma_f32 v112, -v141, v77, v112
    v_fma_f32 v113, -v141, v69, -v113
    v_cvt_pk_bf16_f32 v85, v112, v113
    v_mul_f32 v112, v134, v70
    v_mul_f32 v113, v134, v78
    v_fma_f32 v112, -v142, v78, v112
    v_fma_f32 v113, -v142, v70, -v113
    v_cvt_pk_bf16_f32 v86, v112, v113
    v_mul_f32 v112, v135, v71
    v_mul_f32 v113, v135, v79
    v_fma_f32 v112, -v143, v79, v112
    v_fma_f32 v113, -v143, v71, -v113
    v_cvt_pk_bf16_f32 v87, v112, v113
    s_lshl_b32 s55, s61, 12
    s_lshl_b32 s56, s60, 11
    s_add_u32 s57, s55, s56
    s_add_u32 s57, s57, 90112
    v_add_u32 v8, s57, v42
    s_xor_b32 s56, s56, 2048
    s_add_u32 s57, s55, s56
    s_add_u32 s57, s57, 90112
    v_add_u32 v9, s57, v42
    ds_write_b128 v8, v[80:83]
    ds_write_b128 v8, v[84:87] offset:1024
    s_waitcnt lgkmcnt(0)
    s_barrier
    ds_read_b128 v[88:91], v9
    ds_read_b128 v[92:95], v9 offset:1024
    s_cmp_eq_u32 s60, 0
    s_cbranch_scc0 L_mb1_24
    v_mfma_f32_32x32x16_bf16 v[144:159], a[80:83], v[80:83], 0
    v_mfma_f32_32x32x16_bf16 v[144:159], a[84:87], v[84:87], v[144:159]
    s_waitcnt lgkmcnt(0)
    v_mfma_f32_32x32x16_bf16 v[144:159], a[88:91], v[88:91], v[144:159]
    v_mfma_f32_32x32x16_bf16 v[144:159], a[92:95], v[92:95], v[144:159]
    s_branch L_mbd_25
L_mb1_24:
    s_nop 8
    v_mfma_f32_32x32x16_bf16 v[144:159], a[88:91], v[80:83], 0
    v_mfma_f32_32x32x16_bf16 v[144:159], a[92:95], v[84:87], v[144:159]
    s_waitcnt lgkmcnt(0)
    v_mfma_f32_32x32x16_bf16 v[144:159], a[80:83], v[88:91], v[144:159]
    v_mfma_f32_32x32x16_bf16 v[144:159], a[84:87], v[92:95], v[144:159]
L_mbd_25:
    s_nop 7
    s_nop 3
    s_lshl_b32 s55, s61, 13
    s_lshl_b32 s56, s60, 12
    s_add_u32 s55, s55, s56
    s_add_u32 s55, s55, 147456
    v_lshlrev_b32 v8, 3, v2
    v_lshl_add_u32 v8, v3, 10, v8
    v_add_u32 v8, s55, v8
    v_mul_f32 v96, v144, v48
    v_mul_f32 v97, v144, v56
    v_fmac_f32 v96, v152, v56
    v_fma_f32 v97, -v152, v48, v97
    ds_write_b64 v8, v[96:97] offset:0
    v_mul_f32 v98, v145, v49
    v_mul_f32 v99, v145, v57
    v_fmac_f32 v98, v153, v57
    v_fma_f32 v99, -v153, v49, v99
    ds_write_b64 v8, v[98:99] offset:256
    v_mul_f32 v100, v146, v50
    v_mul_f32 v101, v146, v58
    v_fmac_f32 v100, v154, v58
    v_fma_f32 v101, -v154, v50, v101
    ds_write_b64 v8, v[100:101] offset:512
    v_mul_f32 v102, v147, v51
    v_mul_f32 v103, v147, v59
    v_fmac_f32 v102, v155, v59
    v_fma_f32 v103, -v155, v51, v103
    ds_write_b64 v8, v[102:103] offset:768
    v_mul_f32 v104, v148, v52
    v_mul_f32 v105, v148, v60
    v_fmac_f32 v104, v156, v60
    v_fma_f32 v105, -v156, v52, v105
    ds_write_b64 v8, v[104:105] offset:2048
    v_mul_f32 v106, v149, v53
    v_mul_f32 v107, v149, v61
    v_fmac_f32 v106, v157, v61
    v_fma_f32 v107, -v157, v53, v107
    ds_write_b64 v8, v[106:107] offset:2304
    v_mul_f32 v108, v150, v54
    v_mul_f32 v109, v150, v62
    v_fmac_f32 v108, v158, v62
    v_fma_f32 v109, -v158, v54, v109
    ds_write_b64 v8, v[108:109] offset:2560
    v_mul_f32 v110, v151, v55
    v_mul_f32 v111, v151, v63
    v_fmac_f32 v110, v159, v63
    v_fma_f32 v111, -v159, v55, v111
    ds_write_b64 v8, v[110:111] offset:2816
    s_waitcnt lgkmcnt(0)
    s_barrier
    s_lshr_b32 s70, s49, 1
    s_lshl_b32 s70, s70, 7
    s_add_u32 s70, s70, 331776
    v_lshlrev_b32 v44, 2, v0
    v_add_u32 v44, s70, v44
    v_cmp_gt_u32 vcc, 16, v0
    v_mov_b32 v47, 2147483632
    s_nop 0
    v_cndmask_b32 v126, v47, v44, vcc
    buffer_load_dword v127, v126, s[20:23], 0 offen sc1
    v_lshrrev_b32 v8, 3, v0
    v_and_b32 v9, 7, v0
    v_lshlrev_b32 v112, 8, v8
    v_lshl_add_u32 v112, v9, 5, v112
    v_add_u32 v112, 147456, v112
    ds_read_b128 v[96:99], v112
    ds_read_b128 v[100:103], v112 offset:16
    ds_read_b128 v[104:107], v112 offset:8192
    ds_read_b128 v[108:111], v112 offset:8208
    v_lshlrev_b32 v8, 16, v8
    v_lshl_add_u32 v8, v9, 4, v8
    s_lshl_b32 s55, s47, 11
    s_lshl_b32 s56, s48, 7
    s_add_u32 s55, s55, s56
    s_add_u32 s55, s55, 3145728
    s_waitcnt lgkmcnt(0)
    s_cmp_eq_u32 s47, 0
    s_cbranch_scc1 L_jz2_26
    v_add_f32 v112, v96, v104
    v_add_f32 v113, v97, v105
    v_sub_f32 v114, v105, v97
    v_sub_f32 v115, v96, v104
    v_cvt_pk_bf16_f32 v80, v112, v113
    v_cvt_pk_bf16_f32 v84, v114, v115
    v_add_f32 v112, v98, v106
    v_add_f32 v113, v99, v107
    v_sub_f32 v114, v107, v99
    v_sub_f32 v115, v98, v106
    v_cvt_pk_bf16_f32 v81, v112, v113
    v_cvt_pk_bf16_f32 v85, v114, v115
    v_add_f32 v112, v100, v108
    v_add_f32 v113, v101, v109
    v_sub_f32 v114, v109, v101
    v_sub_f32 v115, v100, v108
    v_cvt_pk_bf16_f32 v82, v112, v113
    v_cvt_pk_bf16_f32 v86, v114, v115
    v_add_f32 v112, v102, v110
    v_add_f32 v113, v103, v111
    v_sub_f32 v114, v111, v103
    v_sub_f32 v115, v102, v110
    v_cvt_pk_bf16_f32 v83, v112, v113
    v_cvt_pk_bf16_f32 v87, v114, v115
    s_branch L_jd2_27
L_jz2_26:
    v_cvt_pk_bf16_f32 v80, v96, v97
    v_cvt_pk_bf16_f32 v84, v104, v105
    v_cvt_pk_bf16_f32 v81, v98, v99
    v_cvt_pk_bf16_f32 v85, v106, v107
    v_cvt_pk_bf16_f32 v82, v100, v101
    v_cvt_pk_bf16_f32 v86, v108, v109
    v_cvt_pk_bf16_f32 v83, v102, v103
    v_cvt_pk_bf16_f32 v87, v110, v111
L_jd2_27:
    buffer_store_dwordx4 v[80:83], v8, s[20:23], s55 offen sc1
    buffer_store_dwordx4 v[84:87], v8, s[20:23], s55 offen offset:1024 sc1
    v_lshrrev_b32 v8, 3, v0
    v_and_b32 v9, 7, v0
    v_lshlrev_b32 v33, 15, v8
    v_lshl_add_u32 v33, v9, 4, v33
    s_lshl_b32 s55, s49, 10
    s_lshl_b32 s56, s50, 7
    s_add_u32 s69, s55, s56
    s_mul_i32 s79, s49, 229376
    s_mul_i32 s55, s44, 57344
    s_add_u32 s79, s79, s55
    s_add_u32 s79, s79, 5242880
    v_lshlrev_b32 v9, 10, v5
    v_add_u32 v8, 0, v5
    v_xor_b32 v8, v8, v4
    v_lshl_add_u32 v22, v8, 4, v9
    v_add_u32 v8, 4, v5
    v_xor_b32 v8, v8, v4
    v_lshl_add_u32 v23, v8, 4, v9
    v_add_u32 v8, 8, v5
    v_xor_b32 v8, v8, v4
    v_lshl_add_u32 v24, v8, 4, v9
    v_add_u32 v8, 12, v5
    v_xor_b32 v8, v8, v4
    v_lshl_add_u32 v25, v8, 4, v9
    v_xor_b32 v8, v3, v4
    v_lshlrev_b32 v8, 4, v8
    v_lshl_add_u32 v8, v2, 8, v8
    s_add_u32 s75, s74, 81920
    s_add_u32 s55, s74, 131072
    s_cmp_lt_u32 s44, 2
    s_cselect_b32 s75, s75, s55
    v_add_u32 v26, s75, v8
    s_add_u32 s55, s74, 49152
    v_add_u32 v32, s55, v8
    s_lshl_b32 s76, s49, 16
    s_lshl_b32 s55, s44, 8
    s_add_u32 s76, s76, s55
    s_add_u32 s76, s76, 3145728
    v_cmp_gt_u32 vcc, 16, v0
    v_mov_b32 v47, 0
    s_nop 0
    v_cndmask_b32 v43, v47, v46, vcc
    s_waitcnt vmcnt(0)
    v_cmp_ne_u32 vcc, v43, v127
    s_cbranch_vccnz L_slow_28
L_back_29:
    s_barrier
    s_lshl_b32 s70, s48, 7
    s_lshl_b32 s71, s47, 2
    s_add_u32 s70, s70, s71
    s_add_u32 s70, s70, 344064
    v_lshlrev_b32 v44, 10, v0
    v_add_u32 v44, s70, v44
    v_cmp_gt_u32 vcc, 16, v0
    v_mov_b32 v47, 2147483632
    s_nop 0
    v_cndmask_b32 v43, v47, v44, vcc
    buffer_store_dword v46, v43, s[20:23], 0 offen sc1
    s_add_u32 s65, s66, 0
    s_cmp_ge_u32 s65, 14
    s_cselect_b32 s59, 14, 0
    s_sub_u32 s65, s65, s59
    s_lshl_b32 s65, s65, 12
    s_add_u32 s65, s79, s65
    s_add_u32 s59, s65, 0
    buffer_load_dwordx4 a[192:195], v42, s[20:23], s59 offen sc1
    buffer_load_dwordx4 a[196:199], v42, s[20:23], s59 offen offset:1024 sc1
    s_add_u32 s59, s65, 2048
    buffer_load_dwordx4 a[200:203], v42, s[20:23], s59 offen sc1
    buffer_load_dwordx4 a[204:207], v42, s[20:23], s59 offen offset:1024 sc1
    s_add_u32 s65, s66, 1
    s_cmp_ge_u32 s65, 14
    s_cselect_b32 s59, 14, 0
    s_sub_u32 s65, s65, s59
    s_lshl_b32 s65, s65, 12
    s_add_u32 s65, s79, s65
    s_add_u32 s59, s65, 0
    buffer_load_dwordx4 a[208:211], v42, s[20:23], s59 offen sc1
    buffer_load_dwordx4 a[212:215], v42, s[20:23], s59 offen offset:1024 sc1
    s_add_u32 s59, s65, 2048
    buffer_load_dwordx4 a[216:219], v42, s[20:23], s59 offen sc1
    buffer_load_dwordx4 a[220:223], v42, s[20:23], s59 offen offset:1024 sc1
    s_add_u32 s65, s66, 2
    s_cmp_ge_u32 s65, 14
    s_cselect_b32 s59, 14, 0
    s_sub_u32 s65, s65, s59
    s_lshl_b32 s65, s65, 12
    s_add_u32 s65, s79, s65
    s_add_u32 s59, s65, 0
    buffer_load_dwordx4 a[224:227], v42, s[20:23], s59 offen sc1
    buffer_load_dwordx4 a[228:231], v42, s[20:23], s59 offen offset:1024 sc1
    s_add_u32 s59, s65, 2048
    buffer_load_dwordx4 a[232:235], v42, s[20:23], s59 offen sc1
    buffer_load_dwordx4 a[236:239], v42, s[20:23], s59 offen offset:1024 sc1
    s_waitcnt vmcnt(10)
    v_mfma_f32_32x32x16_bf16 v[192:207], a[0:3], a[192:195], 0
    s_add_u32 s65, s66, 3
    s_cmp_ge_u32 s65, 14
    s_cselect_b32 s59, 14, 0
    s_sub_u32 s65, s65, s59
    v_cvt_f32_u32 v96, v2
    v_mul_f32 v96, 0x3c800000, v96
    v_add_f32 v97, 0.5, v96
    v_lshlrev_b32 v100, 1, v3
    v_cvt_f32_u32 v101, v100
    v_mul_f32 v98, v96, v101
    v_mul_f32 v99, v97, v101
    v_cmp_eq_u32 vcc, 0, v3
    v_mov_b32 v102, v98
    v_mov_b32 v104, v99
    v_cos_f32 v103, v102
    v_sin_f32 v102, v102
    v_cos_f32 v105, v104
    v_sin_f32 v104, v104
    v_mul_f32 v106, 0x42000000, v96
    v_cos_f32 v106, v106
    s_nop 0
    v_cndmask_b32 v102, v102, v106, vcc
    v_mul_f32 v106, 0x42000000, v97
    v_cos_f32 v106, v106
    s_nop 0
    v_cndmask_b32 v104, v104, v106, vcc
    v_cvt_pk_bf16_f32 v102, v103, v102
    v_cvt_pk_bf16_f32 v104, v105, v104
    v_accvgpr_write_b32 a160, v102
    v_accvgpr_write_b32 a176, v104
    v_fmamk_f32 v102, v96, 0x3f800000, v98
    v_fmamk_f32 v104, v97, 0x3f800000, v99
    v_mfma_f32_32x32x16_bf16 v[208:223], a[0:3], a[196:199], 0
    s_lshl_b32 s65, s65, 12
    s_add_u32 s65, s79, s65
    s_add_u32 s59, s65, 0
    buffer_load_dwordx4 a[240:243], v42, s[20:23], s59 offen sc1
    v_cos_f32 v103, v102
    v_sin_f32 v102, v102
    v_mfma_f32_32x32x16_bf16 v[224:239], a[4:7], a[192:195], 0
    buffer_load_dwordx4 a[244:247], v42, s[20:23], s59 offen offset:1024 sc1
    v_cos_f32 v105, v104
    v_sin_f32 v104, v104
    v_cvt_pk_bf16_f32 v102, v103, v102
    v_cvt_pk_bf16_f32 v104, v105, v104
    v_accvgpr_write_b32 a161, v102
    v_mfma_f32_32x32x16_bf16 v[240:255], a[4:7], a[196:199], 0
    v_accvgpr_write_b32 a177, v104
    v_fmamk_f32 v102, v96, 0x40800000, v98
    v_fmamk_f32 v104, v97, 0x40800000, v99
    v_cos_f32 v103, v102
    v_sin_f32 v102, v102
    v_cos_f32 v105, v104
    s_waitcnt vmcnt(10)
    v_mfma_f32_32x32x16_bf16 v[192:207], a[8:11], a[200:203], v[192:207]
    s_add_u32 s59, s65, 2048
    buffer_load_dwordx4 a[248:251], v42, s[20:23], s59 offen sc1
    buffer_load_dwordx4 a[252:255], v42, s[20:23], s59 offen offset:1024 sc1
    v_sin_f32 v104, v104
    v_cvt_pk_bf16_f32 v102, v103, v102
    v_cvt_pk_bf16_f32 v104, v105, v104
    v_mfma_f32_32x32x16_bf16 v[208:223], a[8:11], a[204:207], v[208:223]
    v_accvgpr_write_b32 a162, v102
    v_accvgpr_write_b32 a178, v104
    v_fmamk_f32 v102, v96, 0x40a00000, v98
    v_fmamk_f32 v104, v97, 0x40a00000, v99
    v_cos_f32 v103, v102
    v_sin_f32 v102, v102
    v_mfma_f32_32x32x16_bf16 v[224:239], a[12:15], a[200:203], v[224:239]
    v_cos_f32 v105, v104
    v_sin_f32 v104, v104
    v_cvt_pk_bf16_f32 v102, v103, v102
    v_cvt_pk_bf16_f32 v104, v105, v104
    v_accvgpr_write_b32 a163, v102
    v_accvgpr_write_b32 a179, v104
    v_mfma_f32_32x32x16_bf16 v[240:255], a[12:15], a[204:207], v[240:255]
    v_fmamk_f32 v102, v96, 0x41000000, v98
    v_fmamk_f32 v104, v97, 0x41000000, v99
    v_cos_f32 v103, v102
    v_sin_f32 v102, v102
    v_cos_f32 v105, v104
    v_sin_f32 v104, v104
    s_waitcnt vmcnt(10)
    v_mfma_f32_32x32x16_bf16 v[192:207], a[16:19], a[208:211], v[192:207]
    s_add_u32 s65, s66, 4
    s_cmp_ge_u32 s65, 14
    s_cselect_b32 s59, 14, 0
    s_sub_u32 s65, s65, s59
    v_cvt_pk_bf16_f32 v102, v103, v102
    v_cvt_pk_bf16_f32 v104, v105, v104
    v_mfma_f32_32x32x16_bf16 v[208:223], a[16:19], a[212:215], v[208:223]
    s_lshl_b32 s65, s65, 12
    s_add_u32 s65, s79, s65
    s_add_u32 s59, s65, 0
    buffer_load_dwordx4 a[192:195], v42, s[20:23], s59 offen sc1
    v_accvgpr_write_b32 a164, v102
    v_accvgpr_write_b32 a180, v104
    v_mfma_f32_32x32x16_bf16 v[224:239], a[20:23], a[208:211], v[224:239]
    buffer_load_dwordx4 a[196:199], v42, s[20:23], s59 offen offset:1024 sc1
    v_fmamk_f32 v102, v96, 0x41100000, v98
    v_fmamk_f32 v104, v97, 0x41100000, v99
    v_cos_f32 v103, v102
    v_sin_f32 v102, v102
    v_cos_f32 v105, v104
    v_mfma_f32_32x32x16_bf16 v[240:255], a[20:23], a[212:215], v[240:255]
    v_sin_f32 v104, v104
    v_cvt_pk_bf16_f32 v102, v103, v102
    v_cvt_pk_bf16_f32 v104, v105, v104
    v_accvgpr_write_b32 a165, v102
    v_accvgpr_write_b32 a181, v104
    v_fmamk_f32 v102, v96, 0x41400000, v98
    s_waitcnt vmcnt(10)
    v_mfma_f32_32x32x16_bf16 v[192:207], a[24:27], a[216:219], v[192:207]
    s_add_u32 s59, s65, 2048
    buffer_load_dwordx4 a[200:203], v42, s[20:23], s59 offen sc1
    buffer_load_dwordx4 a[204:207], v42, s[20:23], s59 offen offset:1024 sc1
    v_fmamk_f32 v104, v97, 0x41400000, v99
    v_cos_f32 v103, v102
    v_sin_f32 v102, v102
    v_mfma_f32_32x32x16_bf16 v[208:223], a[24:27], a[220:223], v[208:223]
    v_cos_f32 v105, v104
    v_sin_f32 v104, v104
    v_cvt_pk_bf16_f32 v102, v103, v102
    v_cvt_pk_bf16_f32 v104, v105, v104
    v_accvgpr_write_b32 a166, v102
    v_accvgpr_write_b32 a182, v104
    v_mfma_f32_32x32x16_bf16 v[224:239], a[28:31], a[216:219], v[224:239]
    v_fmamk_f32 v102, v96, 0x41500000, v98
    v_fmamk_f32 v104, v97, 0x41500000, v99
    v_cos_f32 v103, v102
    v_sin_f32 v102, v102
    v_cos_f32 v105, v104
    v_sin_f32 v104, v104
    v_mfma_f32_32x32x16_bf16 v[240:255], a[28:31], a[220:223], v[240:255]
    v_cvt_pk_bf16_f32 v102, v103, v102
    v_cvt_pk_bf16_f32 v104, v105, v104
    v_accvgpr_write_b32 a167, v102
    v_accvgpr_write_b32 a183, v104
    v_fmamk_f32 v102, v96, 0x41800000, v98
    v_fmamk_f32 v104, v97, 0x41800000, v99
    s_add_u32 s55, s69, 1048576
    buffer_load_dwordx4 v[14:17], v33, s[4:7], s69 offen
    buffer_load_dwordx4 v[18:21], v33, s[4:7], s55 offen
    s_waitcnt vmcnt(12)
    v_mfma_f32_32x32x16_bf16 v[192:207], a[32:35], a[224:227], v[192:207]
    s_add_u32 s65, s66, 5
    s_cmp_ge_u32 s65, 14
    s_cselect_b32 s59, 14, 0
    s_sub_u32 s65, s65, s59
    v_cos_f32 v103, v102
    v_sin_f32 v102, v102
    v_mfma_f32_32x32x16_bf16 v[208:223], a[32:35], a[228:231], v[208:223]
    s_lshl_b32 s65, s65, 12
    s_add_u32 s65, s79, s65
    s_add_u32 s59, s65, 0
    buffer_load_dwordx4 a[208:211], v42, s[20:23], s59 offen sc1
    v_cos_f32 v105, v104
    v_sin_f32 v104, v104
    v_mfma_f32_32x32x16_bf16 v[224:239], a[36:39], a[224:227], v[224:239]
    buffer_load_dwordx4 a[212:215], v42, s[20:23], s59 offen offset:1024 sc1
    v_cvt_pk_bf16_f32 v102, v103, v102
    v_cvt_pk_bf16_f32 v104, v105, v104
    v_accvgpr_write_b32 a168, v102
    v_accvgpr_write_b32 a184, v104
    v_fmamk_f32 v102, v96, 0x41880000, v98
    v_mfma_f32_32x32x16_bf16 v[240:255], a[36:39], a[228:231], v[240:255]
    v_fmamk_f32 v104, v97, 0x41880000, v99
    v_cos_f32 v103, v102
    v_sin_f32 v102, v102
    v_cos_f32 v105, v104
    v_sin_f32 v104, v104
    v_cvt_pk_bf16_f32 v102, v103, v102
    s_waitcnt vmcnt(12)
    v_mfma_f32_32x32x16_bf16 v[192:207], a[40:43], a[232:235], v[192:207]
    s_add_u32 s59, s65, 2048
    buffer_load_dwordx4 a[216:219], v42, s[20:23], s59 offen sc1
    buffer_load_dwordx4 a[220:223], v42, s[20:23], s59 offen offset:1024 sc1
    v_cvt_pk_bf16_f32 v104, v105, v104
    v_accvgpr_write_b32 a169, v102
    v_accvgpr_write_b32 a185, v104
    v_mfma_f32_32x32x16_bf16 v[208:223], a[40:43], a[236:239], v[208:223]
    v_fmamk_f32 v102, v96, 0x41a00000, v98
    v_fmamk_f32 v104, v97, 0x41a00000, v99
    v_cos_f32 v103, v102
    v_sin_f32 v102, v102
    v_cos_f32 v105, v104
    v_sin_f32 v104, v104
    v_mfma_f32_32x32x16_bf16 v[224:239], a[44:47], a[232:235], v[224:239]
    v_cvt_pk_bf16_f32 v102, v103, v102
    v_cvt_pk_bf16_f32 v104, v105, v104
    v_accvgpr_write_b32 a170, v102
    v_accvgpr_write_b32 a186, v104
    v_fmamk_f32 v102, v96, 0x41a80000, v98
    v_fmamk_f32 v104, v97, 0x41a80000, v99
    v_mfma_f32_32x32x16_bf16 v[240:255], a[44:47], a[236:239], v[240:255]
    v_cos_f32 v103, v102
    v_sin_f32 v102, v102
    v_cos_f32 v105, v104
    v_sin_f32 v104, v104
    v_cvt_pk_bf16_f32 v102, v103, v102
    v_cvt_pk_bf16_f32 v104, v105, v104
    s_waitcnt vmcnt(12)
    v_mfma_f32_32x32x16_bf16 v[192:207], a[48:51], a[240:243], v[192:207]
    s_add_u32 s65, s66, 6
    s_cmp_ge_u32 s65, 14
    s_cselect_b32 s59, 14, 0
    s_sub_u32 s65, s65, s59
    v_accvgpr_write_b32 a171, v102
    v_accvgpr_write_b32 a187, v104
    v_mfma_f32_32x32x16_bf16 v[208:223], a[48:51], a[244:247], v[208:223]
    s_lshl_b32 s65, s65, 12
    s_add_u32 s65, s79, s65
    s_add_u32 s59, s65, 0
    buffer_load_dwordx4 a[224:227], v42, s[20:23], s59 offen sc1
    v_fmamk_f32 v102, v96, 0x41c00000, v98
    v_fmamk_f32 v104, v97, 0x41c00000, v99
    v_mfma_f32_32x32x16_bf16 v[224:239], a[52:55], a[240:243], v[224:239]
    buffer_load_dwordx4 a[228:231], v42, s[20:23], s59 offen offset:1024 sc1
    v_cos_f32 v103, v102
    v_sin_f32 v102, v102
    v_cos_f32 v105, v104
    v_sin_f32 v104, v104
    v_cvt_pk_bf16_f32 v102, v103, v102
    v_mfma_f32_32x32x16_bf16 v[240:255], a[52:55], a[244:247], v[240:255]
    v_cvt_pk_bf16_f32 v104, v105, v104
    v_accvgpr_write_b32 a172, v102
    v_accvgpr_write_b32 a188, v104
    v_fmamk_f32 v102, v96, 0x41c80000, v98
    v_fmamk_f32 v104, v97, 0x41c80000, v99
    v_cos_f32 v103, v102
    s_waitcnt vmcnt(12)
    v_mfma_f32_32x32x16_bf16 v[192:207], a[56:59], a[248:251], v[192:207]
    s_add_u32 s59, s65, 2048
    buffer_load_dwordx4 a[232:235], v42, s[20:23], s59 offen sc1
    buffer_load_dwordx4 a[236:239], v42, s[20:23], s59 offen offset:1024 sc1
    v_sin_f32 v102, v102
    v_cos_f32 v105, v104
    v_sin_f32 v104, v104
    v_mfma_f32_32x32x16_bf16 v[208:223], a[56:59], a[252:255], v[208:223]
    v_cvt_pk_bf16_f32 v102, v103, v102
    v_cvt_pk_bf16_f32 v104, v105, v104
    v_accvgpr_write_b32 a173, v102
    v_accvgpr_write_b32 a189, v104
    v_fmamk_f32 v102, v96, 0x41e00000, v98
    v_fmamk_f32 v104, v97, 0x41e00000, v99
    v_mfma_f32_32x32x16_bf16 v[224:239], a[60:63], a[248:251], v[224:239]
    v_cos_f32 v103, v102
    v_sin_f32 v102, v102
    v_cos_f32 v105, v104
    v_sin_f32 v104, v104
    v_cvt_pk_bf16_f32 v102, v103, v102
    v_cvt_pk_bf16_f32 v104, v105, v104
    v_mfma_f32_32x32x16_bf16 v[240:255], a[60:63], a[252:255], v[240:255]
    v_accvgpr_write_b32 a174, v102
    v_accvgpr_write_b32 a190, v104
    v_fmamk_f32 v102, v96, 0x41e80000, v98
    v_fmamk_f32 v104, v97, 0x41e80000, v99
    v_cos_f32 v103, v102
    v_sin_f32 v102, v102
    s_waitcnt vmcnt(12)
    v_mfma_f32_32x32x16_bf16 v[192:207], a[64:67], a[192:195], v[192:207]
    s_add_u32 s65, s66, 7
    s_cmp_ge_u32 s65, 14
    s_cselect_b32 s59, 14, 0
    s_sub_u32 s65, s65, s59
    v_cos_f32 v105, v104
    v_sin_f32 v104, v104
    v_mfma_f32_32x32x16_bf16 v[208:223], a[64:67], a[196:199], v[208:223]
    s_lshl_b32 s65, s65, 12
    s_add_u32 s65, s79, s65
    s_add_u32 s59, s65, 0
    buffer_load_dwordx4 a[240:243], v42, s[20:23], s59 offen sc1
    v_cvt_pk_bf16_f32 v102, v103, v102
    v_cvt_pk_bf16_f32 v104, v105, v104
    v_mfma_f32_32x32x16_bf16 v[224:239], a[68:71], a[192:195], v[224:239]
    buffer_load_dwordx4 a[244:247], v42, s[20:23], s59 offen offset:1024 sc1
    v_accvgpr_write_b32 a175, v102
    v_accvgpr_write_b32 a191, v104
    v_mfma_f32_32x32x16_bf16 v[240:255], a[68:71], a[196:199], v[240:255]
    s_lshl_b32 s55, s50, 6
    v_add_u32 v96, s55, v2
    v_cvt_f32_u32 v96, v96
    s_mov_b32 s56, 0x3b000000
    v_mul_f32 v96, s56, v96
    v_add_f32 v97, 0x3d800000, v96
    s_lshl_b32 s55, s44, 6
    v_lshl_add_u32 v100, v3, 2, s55
    v_cvt_f32_u32 v101, v100
    v_mul_f32 v98, v96, v101
    v_mul_f32 v99, v97, v101
    s_waitcnt vmcnt(12)
    v_mfma_f32_32x32x16_bf16 v[192:207], a[72:75], a[200:203], v[192:207]
    s_add_u32 s59, s65, 2048
    buffer_load_dwordx4 a[248:251], v42, s[20:23], s59 offen sc1
    buffer_load_dwordx4 a[252:255], v42, s[20:23], s59 offen offset:1024 sc1
    v_fmamk_f32 v102, v96, 0x426c0000, v98
    v_fmamk_f32 v104, v97, 0x426c0000, v99
    v_cos_f32 v103, v102
    v_mfma_f32_32x32x16_bf16 v[208:223], a[72:75], a[204:207], v[208:223]
    v_sin_f32 v102, -v102
    v_cos_f32 v105, v104
    v_sin_f32 v104, -v104
    v_cvt_pk_bf16_f32 v102, v103, v102
    v_cvt_pk_bf16_f32 v104, v105, v104
    v_accvgpr_write_b32 a155, v102
    v_mfma_f32_32x32x16_bf16 v[224:239], a[76:79], a[200:203], v[224:239]
    v_accvgpr_write_b32 a159, v104
    v_fmamk_f32 v102, v96, 0x42680000, v98
    v_fmamk_f32 v104, v97, 0x42680000, v99
    v_cos_f32 v103, v102
    v_sin_f32 v102, -v102
    v_cos_f32 v105, v104
    v_mfma_f32_32x32x16_bf16 v[240:255], a[76:79], a[204:207], v[240:255]
    v_sin_f32 v104, -v104
    v_cvt_pk_bf16_f32 v102, v103, v102
    v_cvt_pk_bf16_f32 v104, v105, v104
    v_accvgpr_write_b32 a154, v102
    v_accvgpr_write_b32 a158, v104
    v_fmamk_f32 v102, v96, 0x42640000, v98
    s_lshr_b32 s70, s2, 3
    s_and_b32 s70, s70, 15
    s_lshl_b32 s70, s70, 10
    s_add_u32 s70, s70, 344064
    v_lshlrev_b32 v44, 4, v0
    v_add_u32 v44, s70, v44
    v_cmp_gt_u32 vcc, 64, v0
    v_mov_b32 v47, 2147483632
    s_nop 0
    v_cndmask_b32 v27, v47, v44, vcc
    buffer_load_dwordx4 v[28:31], v27, s[20:23], 0 offen sc1
    s_waitcnt vmcnt(11)
    v_mfma_f32_32x32x16_bf16 v[192:207], a[96:99], a[208:211], v[192:207]
    s_add_u32 s65, s66, 8
    s_cmp_ge_u32 s65, 14
    s_cselect_b32 s59, 14, 0
    s_sub_u32 s65, s65, s59
    v_fmamk_f32 v104, v97, 0x42640000, v99
    v_cos_f32 v103, v102
    v_mfma_f32_32x32x16_bf16 v[208:223], a[96:99], a[212:215], v[208:223]
    s_lshl_b32 s65, s65, 12
    s_add_u32 s65, s79, s65
    s_add_u32 s59, s65, 0
    buffer_load_dwordx4 a[192:195], v42, s[20:23], s59 offen sc1
    v_sin_f32 v102, -v102
    v_cos_f32 v105, v104
    v_mfma_f32_32x32x16_bf16 v[224:239], a[100:103], a[208:211], v[224:239]
    buffer_load_dwordx4 a[196:199], v42, s[20:23], s59 offen offset:1024 sc1
    v_sin_f32 v104, -v104
    v_cvt_pk_bf16_f32 v102, v103, v102
    v_cvt_pk_bf16_f32 v104, v105, v104
    v_accvgpr_write_b32 a153, v102
    v_accvgpr_write_b32 a157, v104
    v_mfma_f32_32x32x16_bf16 v[240:255], a[100:103], a[212:215], v[240:255]
    v_fmamk_f32 v102, v96, 0x42600000, v98
    v_fmamk_f32 v104, v97, 0x42600000, v99
    v_cos_f32 v103, v102
    v_sin_f32 v102, -v102
    v_cos_f32 v105, v104
    v_sin_f32 v104, -v104
    s_waitcnt vmcnt(11)
    v_mfma_f32_32x32x16_bf16 v[192:207], a[104:107], a[216:219], v[192:207]
    ds_read_b64_tr_b16 v[48:49], v38 offset:0
    ds_read_b64_tr_b16 v[50:51], v38 offset:1024
    v_cvt_pk_bf16_f32 v102, v103, v102
    v_cvt_pk_bf16_f32 v104, v105, v104
    v_accvgpr_write_b32 a152, v102
    v_accvgpr_write_b32 a156, v104
    v_mfma_f32_32x32x16_bf16 v[208:223], a[104:107], a[220:223], v[208:223]
    ds_read_b64_tr_b16 v[52:53], v39 offset:0
    ds_read_b64_tr_b16 v[54:55], v39 offset:1024
    v_fmamk_f32 v102, v96, 0x424c0000, v98
    v_fmamk_f32 v104, v97, 0x424c0000, v99
    v_cos_f32 v103, v102
    v_sin_f32 v102, -v102
    v_mfma_f32_32x32x16_bf16 v[224:239], a[108:111], a[216:219], v[224:239]
    s_add_u32 s59, s65, 2048
    buffer_load_dwordx4 a[200:203], v42, s[20:23], s59 offen sc1
    buffer_load_dwordx4 a[204:207], v42, s[20:23], s59 offen offset:1024 sc1
    v_cos_f32 v105, v104
    v_sin_f32 v104, -v104
    v_cvt_pk_bf16_f32 v102, v103, v102
    v_mfma_f32_32x32x16_bf16 v[240:255], a[108:111], a[220:223], v[240:255]
    v_cvt_pk_bf16_f32 v104, v105, v104
    v_accvgpr_write_b32 a147, v102
    v_accvgpr_write_b32 a151, v104
    v_fmamk_f32 v102, v96, 0x42480000, v98
    v_fmamk_f32 v104, v97, 0x42480000, v99
    v_cos_f32 v103, v102
    s_waitcnt lgkmcnt(0)
    s_waitcnt vmcnt(11)
    v_mfma_f32_32x32x16_bf16 v[192:207], v[48:51], a[224:227], v[192:207]
    ds_read_b64_tr_b16 v[56:57], v38 offset:2048
    ds_read_b64_tr_b16 v[58:59], v38 offset:3072
    v_sin_f32 v102, -v102
    v_cos_f32 v105, v104
    v_sin_f32 v104, -v104
    v_cvt_pk_bf16_f32 v102, v103, v102
    v_mfma_f32_32x32x16_bf16 v[208:223], v[48:51], a[228:231], v[208:223]
    ds_read_b64_tr_b16 v[60:61], v39 offset:2048
    ds_read_b64_tr_b16 v[62:63], v39 offset:3072
    v_cvt_pk_bf16_f32 v104, v105, v104
    v_accvgpr_write_b32 a146, v102
    v_accvgpr_write_b32 a150, v104
    v_fmamk_f32 v102, v96, 0x42440000, v98
    v_mfma_f32_32x32x16_bf16 v[224:239], v[52:55], a[224:227], v[224:239]
    s_add_u32 s65, s66, 9
    s_cmp_ge_u32 s65, 14
    s_cselect_b32 s59, 14, 0
    s_sub_u32 s65, s65, s59
    v_fmamk_f32 v104, v97, 0x42440000, v99
    v_cos_f32 v103, v102
    v_mfma_f32_32x32x16_bf16 v[240:255], v[52:55], a[228:231], v[240:255]
    s_lshl_b32 s65, s65, 12
    s_add_u32 s65, s79, s65
    s_add_u32 s59, s65, 0
    buffer_load_dwordx4 a[208:211], v42, s[20:23], s59 offen sc1
    v_sin_f32 v102, -v102
    v_cos_f32 v105, v104
    buffer_load_dwordx4 a[212:215], v42, s[20:23], s59 offen offset:1024 sc1
    s_waitcnt lgkmcnt(0)
    s_waitcnt vmcnt(11)
    v_mfma_f32_32x32x16_bf16 v[192:207], v[56:59], a[232:235], v[192:207]
    ds_read_b64_tr_b16 v[48:49], v38 offset:4096
    ds_read_b64_tr_b16 v[50:51], v38 offset:5120
    v_sin_f32 v104, -v104
    v_cvt_pk_bf16_f32 v102, v103, v102
    v_cvt_pk_bf16_f32 v104, v105, v104
    v_accvgpr_write_b32 a145, v102
    v_mfma_f32_32x32x16_bf16 v[208:223], v[56:59], a[236:239], v[208:223]
    ds_read_b64_tr_b16 v[52:53], v39 offset:4096
    ds_read_b64_tr_b16 v[54:55], v39 offset:5120
    v_accvgpr_write_b32 a149, v104
    v_fmamk_f32 v102, v96, 0x42400000, v98
    v_fmamk_f32 v104, v97, 0x42400000, v99
    v_cos_f32 v103, v102
    v_mfma_f32_32x32x16_bf16 v[224:239], v[60:63], a[232:235], v[224:239]
    s_add_u32 s59, s65, 2048
    buffer_load_dwordx4 a[216:219], v42, s[20:23], s59 offen sc1
    buffer_load_dwordx4 a[220:223], v42, s[20:23], s59 offen offset:1024 sc1
    v_sin_f32 v102, -v102
    v_cos_f32 v105, v104
    v_sin_f32 v104, -v104
    v_mfma_f32_32x32x16_bf16 v[240:255], v[60:63], a[236:239], v[240:255]
    v_cvt_pk_bf16_f32 v102, v103, v102
    v_cvt_pk_bf16_f32 v104, v105, v104
    v_accvgpr_write_b32 a144, v102
    v_accvgpr_write_b32 a148, v104
    v_fmamk_f32 v102, v96, 0x422c0000, v98
    v_fmamk_f32 v104, v97, 0x422c0000, v99
    s_waitcnt lgkmcnt(0)
    v_cmp_gt_u32 vcc, 64, v0
    v_mov_b32 v47, 0
    s_nop 0
    v_cndmask_b32 v43, v47, v46, vcc
    s_waitcnt vmcnt(8)
    v_xor_b32 v28, v43, v28
    v_xor_b32 v29, v43, v29
    v_xor_b32 v30, v43, v30
    v_xor_b32 v31, v43, v31
    v_or3_b32 v28, v28, v29, v30
    v_or_b32 v28, v28, v31
    v_cmp_ne_u32 vcc, 0, v28
    s_cbranch_vccnz L_slow_31
L_back_32:
    s_barrier
    v_mfma_f32_32x32x16_bf16 v[192:207], v[48:51], a[240:243], v[192:207]
    ds_read_b64_tr_b16 v[56:57], v38 offset:6144
    ds_read_b64_tr_b16 v[58:59], v38 offset:7168
    v_cos_f32 v103, v102
    v_sin_f32 v102, -v102
    v_cos_f32 v105, v104
    v_sin_f32 v104, -v104
    v_mfma_f32_32x32x16_bf16 v[208:223], v[48:51], a[244:247], v[208:223]
    ds_read_b64_tr_b16 v[60:61], v39 offset:6144
    ds_read_b64_tr_b16 v[62:63], v39 offset:7168
    v_cvt_pk_bf16_f32 v102, v103, v102
    v_cvt_pk_bf16_f32 v104, v105, v104
    v_accvgpr_write_b32 a139, v102
    v_accvgpr_write_b32 a143, v104
    v_mfma_f32_32x32x16_bf16 v[224:239], v[52:55], a[240:243], v[224:239]
    s_add_u32 s65, s66, 10
    s_cmp_ge_u32 s65, 14
    s_cselect_b32 s59, 14, 0
    s_sub_u32 s65, s65, s59
    v_fmamk_f32 v102, v96, 0x42280000, v98
    v_fmamk_f32 v104, v97, 0x42280000, v99
    v_mfma_f32_32x32x16_bf16 v[240:255], v[52:55], a[244:247], v[240:255]
    s_lshl_b32 s65, s65, 12
    s_add_u32 s65, s79, s65
    s_add_u32 s59, s65, 0
    buffer_load_dwordx4 a[224:227], v42, s[20:23], s59 offen sc1
    v_cos_f32 v103, v102
    v_sin_f32 v102, -v102
    buffer_load_dwordx4 a[228:231], v42, s[20:23], s59 offen offset:1024 sc1
    s_waitcnt lgkmcnt(0)
    v_mfma_f32_32x32x16_bf16 v[192:207], v[56:59], a[248:251], v[192:207]
    ds_read_b64_tr_b16 v[48:49], v10 offset:0
    ds_read_b64_tr_b16 v[50:51], v10 offset:1024
    v_cos_f32 v105, v104
    v_sin_f32 v104, -v104
    v_cvt_pk_bf16_f32 v102, v103, v102
    v_cvt_pk_bf16_f32 v104, v105, v104
    v_mfma_f32_32x32x16_bf16 v[208:223], v[56:59], a[252:255], v[208:223]
    ds_read_b64_tr_b16 v[52:53], v11 offset:0
    ds_read_b64_tr_b16 v[54:55], v11 offset:1024
    v_accvgpr_write_b32 a138, v102
    v_accvgpr_write_b32 a142, v104
    v_fmamk_f32 v102, v96, 0x42240000, v98
    v_fmamk_f32 v104, v97, 0x42240000, v99
    v_mfma_f32_32x32x16_bf16 v[224:239], v[60:63], a[248:251], v[224:239]
    s_add_u32 s59, s65, 2048
    buffer_load_dwordx4 a[232:235], v42, s[20:23], s59 offen sc1
    buffer_load_dwordx4 a[236:239], v42, s[20:23], s59 offen offset:1024 sc1
    v_cos_f32 v103, v102
    v_sin_f32 v102, -v102
    v_cos_f32 v105, v104
    v_mfma_f32_32x32x16_bf16 v[240:255], v[60:63], a[252:255], v[240:255]
    s_add_u32 m0, s75, 0
    s_add_u32 s59, s76, 0
    buffer_load_dwordx4 v22, s[20:23], s59 offen sc1 lds
    v_sin_f32 v104, -v104
    v_cvt_pk_bf16_f32 v102, v103, v102
    v_cvt_pk_bf16_f32 v104, v105, v104
    s_waitcnt lgkmcnt(0)
    s_waitcnt vmcnt(11)
    v_mfma_f32_32x32x16_bf16 v[192:207], v[48:51], a[192:195], v[192:207]
    ds_read_b64_tr_b16 v[56:57], v10 offset:2048
    ds_read_b64_tr_b16 v[58:59], v10 offset:3072
    v_accvgpr_write_b32 a137, v102
    v_accvgpr_write_b32 a141, v104
    v_fmamk_f32 v102, v96, 0x42200000, v98
    v_fmamk_f32 v104, v97, 0x42200000, v99
    v_mfma_f32_32x32x16_bf16 v[208:223], v[48:51], a[196:199], v[208:223]
    ds_read_b64_tr_b16 v[60:61], v11 offset:2048
    ds_read_b64_tr_b16 v[62:63], v11 offset:3072
    v_cos_f32 v103, v102
    v_sin_f32 v102, -v102
    v_cos_f32 v105, v104
    v_sin_f32 v104, -v104
    v_mfma_f32_32x32x16_bf16 v[224:239], v[52:55], a[192:195], v[224:239]
    s_add_u32 s65, s66, 11
    s_cmp_ge_u32 s65, 14
    s_cselect_b32 s59, 14, 0
    s_sub_u32 s65, s65, s59
    v_cvt_pk_bf16_f32 v102, v103, v102
    v_cvt_pk_bf16_f32 v104, v105, v104
    v_mfma_f32_32x32x16_bf16 v[240:255], v[52:55], a[196:199], v[240:255]
    s_lshl_b32 s65, s65, 12
    s_add_u32 s65, s79, s65
    s_add_u32 s59, s65, 0
    buffer_load_dwordx4 a[240:243], v42, s[20:23], s59 offen sc1
    v_accvgpr_write_b32 a136, v102
    v_accvgpr_write_b32 a140, v104
    buffer_load_dwordx4 a[244:247], v42, s[20:23], s59 offen offset:1024 sc1
    s_waitcnt lgkmcnt(0)
    s_waitcnt vmcnt(11)
    v_mfma_f32_32x32x16_bf16 v[192:207], v[56:59], a[200:203], v[192:207]
    ds_read_b64_tr_b16 v[48:49], v10 offset:4096
    ds_read_b64_tr_b16 v[50:51], v10 offset:5120
    v_fmamk_f32 v102, v96, 0x420c0000, v98
    v_fmamk_f32 v104, v97, 0x420c0000, v99
    v_cos_f32 v103, v102
    v_sin_f32 v102, -v102
    v_mfma_f32_32x32x16_bf16 v[208:223], v[56:59], a[204:207], v[208:223]
    ds_read_b64_tr_b16 v[52:53], v11 offset:4096
    ds_read_b64_tr_b16 v[54:55], v11 offset:5120
    v_cos_f32 v105, v104
    v_sin_f32 v104, -v104
    v_cvt_pk_bf16_f32 v102, v103, v102
    v_cvt_pk_bf16_f32 v104, v105, v104
    v_mfma_f32_32x32x16_bf16 v[224:239], v[60:63], a[200:203], v[224:239]
    s_add_u32 s59, s65, 2048
    buffer_load_dwordx4 a[248:251], v42, s[20:23], s59 offen sc1
    buffer_load_dwordx4 a[252:255], v42, s[20:23], s59 offen offset:1024 sc1
    v_accvgpr_write_b32 a131, v102
    v_accvgpr_write_b32 a135, v104
    v_fmamk_f32 v102, v96, 0x42080000, v98
    v_mfma_f32_32x32x16_bf16 v[240:255], v[60:63], a[204:207], v[240:255]
    s_add_u32 m0, s75, 1024
    s_add_u32 s59, s76, 4096
    buffer_load_dwordx4 v23, s[20:23], s59 offen sc1 lds
    v_fmamk_f32 v104, v97, 0x42080000, v99
    v_cos_f32 v103, v102
    v_sin_f32 v102, -v102
    s_waitcnt lgkmcnt(0)
    s_waitcnt vmcnt(12)
    v_mfma_f32_32x32x16_bf16 v[192:207], v[48:51], a[208:211], v[192:207]
    ds_read_b64_tr_b16 v[56:57], v10 offset:6144
    ds_read_b64_tr_b16 v[58:59], v10 offset:7168
    v_cos_f32 v105, v104
    v_sin_f32 v104, -v104
    v_cvt_pk_bf16_f32 v102, v103, v102
    v_cvt_pk_bf16_f32 v104, v105, v104
    v_mfma_f32_32x32x16_bf16 v[208:223], v[48:51], a[212:215], v[208:223]
    ds_read_b64_tr_b16 v[60:61], v11 offset:6144
    ds_read_b64_tr_b16 v[62:63], v11 offset:7168
    v_accvgpr_write_b32 a130, v102
    v_accvgpr_write_b32 a134, v104
    v_fmamk_f32 v102, v96, 0x42040000, v98
    v_fmamk_f32 v104, v97, 0x42040000, v99
    v_mfma_f32_32x32x16_bf16 v[224:239], v[52:55], a[208:211], v[224:239]
    s_add_u32 s65, s66, 12
    s_cmp_ge_u32 s65, 14
    s_cselect_b32 s59, 14, 0
    s_sub_u32 s65, s65, s59
    v_cos_f32 v103, v102
    v_sin_f32 v102, -v102
    v_mfma_f32_32x32x16_bf16 v[240:255], v[52:55], a[212:215], v[240:255]
    s_lshl_b32 s65, s65, 12
    s_add_u32 s65, s79, s65
    s_add_u32 s59, s65, 0
    buffer_load_dwordx4 a[192:195], v42, s[20:23], s59 offen sc1
    v_cos_f32 v105, v104
    v_sin_f32 v104, -v104
    buffer_load_dwordx4 a[196:199], v42, s[20:23], s59 offen offset:1024 sc1
    s_waitcnt lgkmcnt(0)
    s_waitcnt vmcnt(12)
    v_mfma_f32_32x32x16_bf16 v[192:207], v[56:59], a[216:219], v[192:207]
    ds_read_b64_tr_b16 v[48:49], v10 offset:8192
    ds_read_b64_tr_b16 v[50:51], v10 offset:9216
    v_cvt_pk_bf16_f32 v102, v103, v102
    v_cvt_pk_bf16_f32 v104, v105, v104
    v_accvgpr_write_b32 a129, v102
    v_accvgpr_write_b32 a133, v104
    v_mfma_f32_32x32x16_bf16 v[208:223], v[56:59], a[220:223], v[208:223]
    ds_read_b64_tr_b16 v[52:53], v11 offset:8192
    ds_read_b64_tr_b16 v[54:55], v11 offset:9216
    v_fmamk_f32 v102, v96, 0x42000000, v98
    v_fmamk_f32 v104, v97, 0x42000000, v99
    v_cos_f32 v103, v102
    v_sin_f32 v102, -v102
    v_mfma_f32_32x32x16_bf16 v[224:239], v[60:63], a[216:219], v[224:239]
    s_add_u32 s59, s65, 2048
    buffer_load_dwordx4 a[200:203], v42, s[20:23], s59 offen sc1
    buffer_load_dwordx4 a[204:207], v42, s[20:23], s59 offen offset:1024 sc1
    v_cos_f32 v105, v104
    v_sin_f32 v104, -v104
    v_cvt_pk_bf16_f32 v102, v103, v102
    v_mfma_f32_32x32x16_bf16 v[240:255], v[60:63], a[220:223], v[240:255]
    s_add_u32 m0, s75, 2048
    s_add_u32 s59, s76, 8192
    buffer_load_dwordx4 v24, s[20:23], s59 offen sc1 lds
    v_cvt_pk_bf16_f32 v104, v105, v104
    v_accvgpr_write_b32 a128, v102
    v_accvgpr_write_b32 a132, v104
    s_waitcnt lgkmcnt(0)
    s_waitcnt vmcnt(13)
    v_mfma_f32_32x32x16_bf16 v[192:207], v[48:51], a[224:227], v[192:207]
    ds_read_b64_tr_b16 v[56:57], v10 offset:10240
    ds_read_b64_tr_b16 v[58:59], v10 offset:11264
    v_fmamk_f32 v102, v96, 0x41d80000, v98
    v_fmamk_f32 v104, v97, 0x41d80000, v99
    v_cos_f32 v103, v102
    v_sin_f32 v102, -v102
    v_mfma_f32_32x32x16_bf16 v[208:223], v[48:51], a[228:231], v[208:223]
    ds_read_b64_tr_b16 v[60:61], v11 offset:10240
    ds_read_b64_tr_b16 v[62:63], v11 offset:11264
    v_cos_f32 v105, v104
    v_sin_f32 v104, -v104
    v_cvt_pk_bf16_f32 v102, v103, v102
    v_cvt_pk_bf16_f32 v104, v105, v104
    v_mfma_f32_32x32x16_bf16 v[224:239], v[52:55], a[224:227], v[224:239]
    s_add_u32 s65, s66, 13
    s_cmp_ge_u32 s65, 14
    s_cselect_b32 s59, 14, 0
    s_sub_u32 s65, s65, s59
    v_accvgpr_write_b32 a123, v102
    v_accvgpr_write_b32 a127, v104
    v_mfma_f32_32x32x16_bf16 v[240:255], v[52:55], a[228:231], v[240:255]
    s_lshl_b32 s65, s65, 12
    s_add_u32 s65, s79, s65
    s_add_u32 s59, s65, 0
    buffer_load_dwordx4 a[208:211], v42, s[20:23], s59 offen sc1
    v_fmamk_f32 v102, v96, 0x41d00000, v98
    v_fmamk_f32 v104, v97, 0x41d00000, v99
    buffer_load_dwordx4 a[212:215], v42, s[20:23], s59 offen offset:1024 sc1
    s_waitcnt lgkmcnt(0)
    s_waitcnt vmcnt(13)
    v_mfma_f32_32x32x16_bf16 v[192:207], v[56:59], a[232:235], v[192:207]
    ds_read_b64_tr_b16 v[48:49], v12 offset:0
    ds_read_b64_tr_b16 v[50:51], v12 offset:1024
    v_cos_f32 v103, v102
    v_sin_f32 v102, -v102
    v_cos_f32 v105, v104
    v_sin_f32 v104, -v104
    v_mfma_f32_32x32x16_bf16 v[208:223], v[56:59], a[236:239], v[208:223]
    ds_read_b64_tr_b16 v[52:53], v13 offset:0
    ds_read_b64_tr_b16 v[54:55], v13 offset:1024
    v_cvt_pk_bf16_f32 v102, v103, v102
    v_cvt_pk_bf16_f32 v104, v105, v104
    v_accvgpr_write_b32 a122, v102
    v_accvgpr_write_b32 a126, v104
    v_mfma_f32_32x32x16_bf16 v[224:239], v[60:63], a[232:235], v[224:239]
    s_add_u32 s59, s65, 2048
    buffer_load_dwordx4 a[216:219], v42, s[20:23], s59 offen sc1
    buffer_load_dwordx4 a[220:223], v42, s[20:23], s59 offen offset:1024 sc1
    v_fmamk_f32 v102, v96, 0x41c80000, v98
    v_fmamk_f32 v104, v97, 0x41c80000, v99
    v_cos_f32 v103, v102
    v_mfma_f32_32x32x16_bf16 v[240:255], v[60:63], a[236:239], v[240:255]
    s_add_u32 m0, s75, 3072
    s_add_u32 s59, s76, 12288
    buffer_load_dwordx4 v25, s[20:23], s59 offen sc1 lds
    v_sin_f32 v102, -v102
    v_cos_f32 v105, v104
    v_sin_f32 v104, -v104
    s_waitcnt lgkmcnt(0)
    s_waitcnt vmcnt(13)
    v_mfma_f32_32x32x16_bf16 v[192:207], v[48:51], a[240:243], v[192:207]
    ds_read_b64_tr_b16 v[56:57], v12 offset:2048
    ds_read_b64_tr_b16 v[58:59], v12 offset:3072
    v_cvt_pk_bf16_f32 v102, v103, v102
    v_cvt_pk_bf16_f32 v104, v105, v104
    v_accvgpr_write_b32 a121, v102
    v_accvgpr_write_b32 a125, v104
    v_mfma_f32_32x32x16_bf16 v[208:223], v[48:51], a[244:247], v[208:223]
    ds_read_b64_tr_b16 v[60:61], v13 offset:2048
    ds_read_b64_tr_b16 v[62:63], v13 offset:3072
    v_fmamk_f32 v102, v96, 0x41c00000, v98
    v_fmamk_f32 v104, v97, 0x41c00000, v99
    v_cos_f32 v103, v102
    v_sin_f32 v102, -v102
    v_mfma_f32_32x32x16_bf16 v[224:239], v[52:55], a[240:243], v[224:239]
    s_add_u32 m0, s75, 4096
    s_add_u32 s59, s76, 16384
    buffer_load_dwordx4 v22, s[20:23], s59 offen sc1 lds
    v_cos_f32 v105, v104
    v_sin_f32 v104, -v104
    v_cvt_pk_bf16_f32 v102, v103, v102
    v_mfma_f32_32x32x16_bf16 v[240:255], v[52:55], a[244:247], v[240:255]
    s_add_u32 m0, s75, 5120
    s_add_u32 s59, s76, 20480
    buffer_load_dwordx4 v23, s[20:23], s59 offen sc1 lds
    v_cvt_pk_bf16_f32 v104, v105, v104
    v_accvgpr_write_b32 a120, v102
    v_accvgpr_write_b32 a124, v104
    s_waitcnt lgkmcnt(0)
    s_waitcnt vmcnt(13)
    v_mfma_f32_32x32x16_bf16 v[192:207], v[56:59], a[248:251], v[192:207]
    ds_read_b64_tr_b16 v[48:49], v12 offset:4096
    ds_read_b64_tr_b16 v[50:51], v12 offset:5120
    v_fmamk_f32 v102, v96, 0x41980000, v98
    v_fmamk_f32 v104, v97, 0x41980000, v99
    v_cos_f32 v103, v102
    v_sin_f32 v102, -v102
    v_mfma_f32_32x32x16_bf16 v[208:223], v[56:59], a[252:255], v[208:223]
    ds_read_b64_tr_b16 v[52:53], v13 offset:4096
    ds_read_b64_tr_b16 v[54:55], v13 offset:5120
    v_cos_f32 v105, v104
    v_sin_f32 v104, -v104
    v_cvt_pk_bf16_f32 v102, v103, v102
    v_cvt_pk_bf16_f32 v104, v105, v104
    v_mfma_f32_32x32x16_bf16 v[224:239], v[60:63], a[248:251], v[224:239]
    s_add_u32 m0, s75, 6144
    s_add_u32 s59, s76, 24576
    buffer_load_dwordx4 v24, s[20:23], s59 offen sc1 lds
    v_accvgpr_write_b32 a115, v102
    v_accvgpr_write_b32 a119, v104
    v_fmamk_f32 v102, v96, 0x41900000, v98
    v_mfma_f32_32x32x16_bf16 v[240:255], v[60:63], a[252:255], v[240:255]
    s_add_u32 m0, s75, 7168
    s_add_u32 s59, s76, 28672
    buffer_load_dwordx4 v25, s[20:23], s59 offen sc1 lds
    v_fmamk_f32 v104, v97, 0x41900000, v99
    v_cos_f32 v103, v102
    v_sin_f32 v102, -v102
    s_waitcnt lgkmcnt(0)
    s_waitcnt vmcnt(12)
    v_mfma_f32_32x32x16_bf16 v[192:207], v[48:51], a[192:195], v[192:207]
    ds_read_b64_tr_b16 v[56:57], v12 offset:6144
    ds_read_b64_tr_b16 v[58:59], v12 offset:7168
    v_cos_f32 v105, v104
    v_sin_f32 v104, -v104
    v_cvt_pk_bf16_f32 v102, v103, v102
    v_cvt_pk_bf16_f32 v104, v105, v104
    v_mfma_f32_32x32x16_bf16 v[208:223], v[48:51], a[196:199], v[208:223]
    ds_read_b64_tr_b16 v[60:61], v13 offset:6144
    ds_read_b64_tr_b16 v[62:63], v13 offset:7168
    v_accvgpr_write_b32 a114, v102
    v_accvgpr_write_b32 a118, v104
    v_fmamk_f32 v102, v96, 0x41880000, v98
    v_fmamk_f32 v104, v97, 0x41880000, v99
    v_mfma_f32_32x32x16_bf16 v[224:239], v[52:55], a[192:195], v[224:239]
    s_add_u32 m0, s74, 49152
    s_add_u32 s59, s76, 32768
    buffer_load_dwordx4 v22, s[20:23], s59 offen sc1 lds
    v_cos_f32 v103, v102
    v_sin_f32 v102, -v102
    v_cos_f32 v105, v104
    v_mfma_f32_32x32x16_bf16 v[240:255], v[52:55], a[196:199], v[240:255]
    s_add_u32 m0, s74, 50176
    s_add_u32 s59, s76, 36864
    buffer_load_dwordx4 v23, s[20:23], s59 offen sc1 lds
    v_sin_f32 v104, -v104
    v_cvt_pk_bf16_f32 v102, v103, v102
    v_cvt_pk_bf16_f32 v104, v105, v104
    s_waitcnt lgkmcnt(0)
    s_waitcnt vmcnt(12)
    v_mfma_f32_32x32x16_bf16 v[192:207], v[56:59], a[200:203], v[192:207]
    ds_read_b64_tr_b16 v[48:49], v12 offset:8192
    ds_read_b64_tr_b16 v[50:51], v12 offset:9216
    v_accvgpr_write_b32 a113, v102
    v_accvgpr_write_b32 a117, v104
    v_fmamk_f32 v102, v96, 0x41800000, v98
    v_fmamk_f32 v104, v97, 0x41800000, v99
    v_mfma_f32_32x32x16_bf16 v[208:223], v[56:59], a[204:207], v[208:223]
    ds_read_b64_tr_b16 v[52:53], v13 offset:8192
    ds_read_b64_tr_b16 v[54:55], v13 offset:9216
    v_cos_f32 v103, v102
    v_sin_f32 v102, -v102
    v_cos_f32 v105, v104
    v_sin_f32 v104, -v104
    v_mfma_f32_32x32x16_bf16 v[224:239], v[60:63], a[200:203], v[224:239]
    s_add_u32 m0, s74, 51200
    s_add_u32 s59, s76, 40960
    buffer_load_dwordx4 v24, s[20:23], s59 offen sc1 lds
    v_cvt_pk_bf16_f32 v102, v103, v102
    v_cvt_pk_bf16_f32 v104, v105, v104
    v_accvgpr_write_b32 a112, v102
    v_mfma_f32_32x32x16_bf16 v[240:255], v[60:63], a[204:207], v[240:255]
    s_add_u32 m0, s74, 52224
    s_add_u32 s59, s76, 45056
    buffer_load_dwordx4 v25, s[20:23], s59 offen sc1 lds
    v_accvgpr_write_b32 a116, v104
    v_fmamk_f32 v102, v96, 0x41300000, v98
    v_fmamk_f32 v104, v97, 0x41300000, v99
    s_waitcnt lgkmcnt(0)
    s_waitcnt vmcnt(11)
    v_mfma_f32_32x32x16_bf16 v[192:207], v[48:51], a[208:211], v[192:207]
    ds_read_b64_tr_b16 v[56:57], v12 offset:10240
    ds_read_b64_tr_b16 v[58:59], v12 offset:11264
    v_cos_f32 v103, v102
    v_sin_f32 v102, -v102
    v_cos_f32 v105, v104
    v_sin_f32 v104, -v104
    v_mfma_f32_32x32x16_bf16 v[208:223], v[48:51], a[212:215], v[208:223]
    ds_read_b64_tr_b16 v[60:61], v13 offset:10240
    ds_read_b64_tr_b16 v[62:63], v13 offset:11264
    v_cvt_pk_bf16_f32 v102, v103, v102
    v_cvt_pk_bf16_f32 v104, v105, v104
    v_accvgpr_write_b32 a107, v102
    v_accvgpr_write_b32 a111, v104
    v_mfma_f32_32x32x16_bf16 v[224:239], v[52:55], a[208:211], v[224:239]
    s_add_u32 m0, s74, 53248
    s_add_u32 s59, s76, 49152
    buffer_load_dwordx4 v22, s[20:23], s59 offen sc1 lds
    v_fmamk_f32 v102, v96, 0x41200000, v98
    v_fmamk_f32 v104, v97, 0x41200000, v99
    v_cos_f32 v103, v102
    v_mfma_f32_32x32x16_bf16 v[240:255], v[52:55], a[212:215], v[240:255]
    s_add_u32 m0, s74, 54272
    s_add_u32 s59, s76, 53248
    buffer_load_dwordx4 v23, s[20:23], s59 offen sc1 lds
    v_sin_f32 v102, -v102
    v_cos_f32 v105, v104
    v_sin_f32 v104, -v104
    s_waitcnt lgkmcnt(0)
    s_waitcnt vmcnt(11)
    v_mfma_f32_32x32x16_bf16 v[192:207], v[56:59], a[216:219], v[192:207]
    s_add_u32 m0, s74, 55296
    s_add_u32 s59, s76, 57344
    buffer_load_dwordx4 v24, s[20:23], s59 offen sc1 lds
    v_cvt_pk_bf16_f32 v102, v103, v102
    v_cvt_pk_bf16_f32 v104, v105, v104
    v_accvgpr_write_b32 a106, v102
    v_mfma_f32_32x32x16_bf16 v[208:223], v[56:59], a[220:223], v[208:223]
    s_add_u32 m0, s74, 56320
    s_add_u32 s59, s76, 61440
    buffer_load_dwordx4 v25, s[20:23], s59 offen sc1 lds
    v_accvgpr_write_b32 a110, v104
    v_fmamk_f32 v102, v96, 0x41100000, v98
    v_fmamk_f32 v104, v97, 0x41100000, v99
    v_mfma_f32_32x32x16_bf16 v[224:239], v[60:63], a[216:219], v[224:239]
    v_cos_f32 v103, v102
    v_sin_f32 v102, -v102
    v_cos_f32 v105, v104
    v_sin_f32 v104, -v104
    v_cvt_pk_bf16_f32 v102, v103, v102
    v_cvt_pk_bf16_f32 v104, v105, v104
    v_mfma_f32_32x32x16_bf16 v[240:255], v[60:63], a[220:223], v[240:255]
    v_accvgpr_write_b32 a105, v102
    v_accvgpr_write_b32 a109, v104
    v_fmamk_f32 v102, v96, 0x41000000, v98
    v_fmamk_f32 v104, v97, 0x41000000, v99
    v_cos_f32 v103, v102
    v_sin_f32 v102, -v102
    v_cos_f32 v105, v104
    v_sin_f32 v104, -v104
    v_cvt_pk_bf16_f32 v102, v103, v102
    v_cvt_pk_bf16_f32 v104, v105, v104
    v_accvgpr_write_b32 a104, v102
    v_accvgpr_write_b32 a108, v104
    v_fmamk_f32 v102, v96, 0x40400000, v98
    v_fmamk_f32 v104, v97, 0x40400000, v99
    v_cos_f32 v103, v102
    v_sin_f32 v102, -v102
    v_cos_f32 v105, v104
    v_sin_f32 v104, -v104
    v_cvt_pk_bf16_f32 v102, v103, v102
    v_cvt_pk_bf16_f32 v104, v105, v104
    v_accvgpr_write_b32 a99, v102
    v_accvgpr_write_b32 a103, v104
    v_fmamk_f32 v102, v96, 0x40000000, v98
    v_fmamk_f32 v104, v97, 0x40000000, v99
    v_cos_f32 v103, v102
    v_sin_f32 v102, -v102
    v_cos_f32 v105, v104
    v_sin_f32 v104, -v104
    v_cvt_pk_bf16_f32 v102, v103, v102
    v_cvt_pk_bf16_f32 v104, v105, v104
    v_accvgpr_write_b32 a98, v102
    v_accvgpr_write_b32 a102, v104
    v_fmamk_f32 v102, v96, 0x3f800000, v98
    v_fmamk_f32 v104, v97, 0x3f800000, v99
    v_cos_f32 v103, v102
    v_sin_f32 v102, -v102
    v_cos_f32 v105, v104
    v_sin_f32 v104, -v104
    v_cvt_pk_bf16_f32 v102, v103, v102
    v_cvt_pk_bf16_f32 v104, v105, v104
    v_accvgpr_write_b32 a97, v102
    v_accvgpr_write_b32 a101, v104
    v_cmp_eq_u32 vcc, 0, v100
    v_mul_f32 v102, 0x43800000, v96
    s_nop 0
    v_cndmask_b32 v102, v98, v102, vcc
    v_mul_f32 v104, 0x43800000, v97
    v_cndmask_b32 v104, v99, v104, vcc
    v_cos_f32 v103, v102
    v_sin_f32 v102, -v102
    v_cos_f32 v105, v104
    v_sin_f32 v104, -v104
    v_mov_b32 v106, 1.0
    v_cndmask_b32_e64 v106, v106, 0.5, vcc
    v_mul_f32 v103, v103, v106
    v_mul_f32 v105, v105, v106
    v_cvt_pk_bf16_f32 v102, v103, v102
    v_cvt_pk_bf16_f32 v104, v105, v104
    v_accvgpr_write_b32 a96, v102
    v_accvgpr_write_b32 a100, v104
    s_waitcnt vmcnt(0)
    v_xor_b32 v43, 0, v26
    v_xor_b32 v47, 0, v32
    ds_read_b128 v[48:51], v43
    ds_read_b128 v[52:55], v47
    s_waitcnt lgkmcnt(0)
    v_mfma_f32_32x32x16_bf16 v[128:143], v[48:51], a[96:99], 0
    v_xor_b32 v44, 32, v26
    v_xor_b32 v45, 32, v32
    v_mfma_f32_32x32x16_bf16 v[144:159], v[48:51], a[100:103], 0
    ds_read_b128 v[56:59], v44
    ds_read_b128 v[60:63], v45
    v_mfma_f32_32x32x16_bf16 v[160:175], v[52:55], a[96:99], 0
    v_mfma_f32_32x32x16_bf16 v[176:191], v[52:55], a[100:103], 0
    s_waitcnt lgkmcnt(0)
    v_mfma_f32_32x32x16_bf16 v[128:143], v[56:59], a[104:107], v[128:143]
    v_xor_b32 v43, 64, v26
    v_xor_b32 v47, 64, v32
    v_mfma_f32_32x32x16_bf16 v[144:159], v[56:59], a[108:111], v[144:159]
    ds_read_b128 v[48:51], v43
    ds_read_b128 v[52:55], v47
    v_mfma_f32_32x32x16_bf16 v[160:175], v[60:63], a[104:107], v[160:175]
    v_mfma_f32_32x32x16_bf16 v[176:191], v[60:63], a[108:111], v[176:191]
    s_waitcnt lgkmcnt(0)
    v_mfma_f32_32x32x16_bf16 v[128:143], v[48:51], a[112:115], v[128:143]
    v_xor_b32 v44, 96, v26
    v_xor_b32 v45, 96, v32
    v_mfma_f32_32x32x16_bf16 v[144:159], v[48:51], a[116:119], v[144:159]
    ds_read_b128 v[56:59], v44
    ds_read_b128 v[60:63], v45
    v_mfma_f32_32x32x16_bf16 v[160:175], v[52:55], a[112:115], v[160:175]
    v_mfma_f32_32x32x16_bf16 v[176:191], v[52:55], a[116:119], v[176:191]
    s_waitcnt lgkmcnt(0)
    v_mfma_f32_32x32x16_bf16 v[128:143], v[56:59], a[120:123], v[128:143]
    v_xor_b32 v43, 128, v26
    v_xor_b32 v47, 128, v32
    v_mfma_f32_32x32x16_bf16 v[144:159], v[56:59], a[124:127], v[144:159]
    ds_read_b128 v[48:51], v43
    ds_read_b128 v[52:55], v47
    v_mfma_f32_32x32x16_bf16 v[160:175], v[60:63], a[120:123], v[160:175]
    v_mfma_f32_32x32x16_bf16 v[176:191], v[60:63], a[124:127], v[176:191]
    s_waitcnt lgkmcnt(0)
    v_mfma_f32_32x32x16_bf16 v[128:143], v[48:51], a[128:131], v[128:143]
    v_xor_b32 v44, 160, v26
    v_xor_b32 v45, 160, v32
    v_mfma_f32_32x32x16_bf16 v[144:159], v[48:51], a[132:135], v[144:159]
    ds_read_b128 v[56:59], v44
    ds_read_b128 v[60:63], v45
    v_mfma_f32_32x32x16_bf16 v[160:175], v[52:55], a[128:131], v[160:175]
    v_mfma_f32_32x32x16_bf16 v[176:191], v[52:55], a[132:135], v[176:191]
    s_waitcnt lgkmcnt(0)
    v_mfma_f32_32x32x16_bf16 v[128:143], v[56:59], a[136:139], v[128:143]
    v_xor_b32 v43, 192, v26
    v_xor_b32 v47, 192, v32
    v_mfma_f32_32x32x16_bf16 v[144:159], v[56:59], a[140:143], v[144:159]
    ds_read_b128 v[48:51], v43
    ds_read_b128 v[52:55], v47
    v_mfma_f32_32x32x16_bf16 v[160:175], v[60:63], a[136:139], v[160:175]
    v_mfma_f32_32x32x16_bf16 v[176:191], v[60:63], a[140:143], v[176:191]
    s_waitcnt lgkmcnt(0)
    v_mfma_f32_32x32x16_bf16 v[128:143], v[48:51], a[144:147], v[128:143]
    v_xor_b32 v44, 224, v26
    v_xor_b32 v45, 224, v32
    v_mfma_f32_32x32x16_bf16 v[144:159], v[48:51], a[148:151], v[144:159]
    ds_read_b128 v[56:59], v44
    ds_read_b128 v[60:63], v45
    v_mfma_f32_32x32x16_bf16 v[160:175], v[52:55], a[144:147], v[160:175]
    v_mfma_f32_32x32x16_bf16 v[176:191], v[52:55], a[148:151], v[176:191]
    s_waitcnt lgkmcnt(0)
    v_mfma_f32_32x32x16_bf16 v[128:143], v[56:59], a[152:155], v[128:143]
    v_mfma_f32_32x32x16_bf16 v[144:159], v[56:59], a[156:159], v[144:159]
    v_mfma_f32_32x32x16_bf16 v[160:175], v[60:63], a[152:155], v[160:175]
    v_mfma_f32_32x32x16_bf16 v[176:191], v[60:63], a[156:159], v[176:191]
    s_nop 8
    v_cvt_pk_bf16_f32 v64, v128, v129
    v_cvt_pk_bf16_f32 v65, v130, v131
    v_cvt_pk_bf16_f32 v66, v132, v133
    v_cvt_pk_bf16_f32 v67, v134, v135
    v_cvt_pk_bf16_f32 v80, v144, v145
    v_cvt_pk_bf16_f32 v81, v146, v147
    v_cvt_pk_bf16_f32 v82, v148, v149
    v_cvt_pk_bf16_f32 v83, v150, v151
    v_cvt_pk_bf16_f32 v68, v136, v137
    v_cvt_pk_bf16_f32 v69, v138, v139
    v_cvt_pk_bf16_f32 v70, v140, v141
    v_cvt_pk_bf16_f32 v71, v142, v143
    v_cvt_pk_bf16_f32 v84, v152, v153
    v_cvt_pk_bf16_f32 v85, v154, v155
    v_cvt_pk_bf16_f32 v86, v156, v157
    v_cvt_pk_bf16_f32 v87, v158, v159
    v_cvt_pk_bf16_f32 v72, v160, v161
    v_cvt_pk_bf16_f32 v73, v162, v163
    v_cvt_pk_bf16_f32 v74, v164, v165
    v_cvt_pk_bf16_f32 v75, v166, v167
    v_cvt_pk_bf16_f32 v88, v176, v177
    v_cvt_pk_bf16_f32 v89, v178, v179
    v_cvt_pk_bf16_f32 v90, v180, v181
    v_cvt_pk_bf16_f32 v91, v182, v183
    v_cvt_pk_bf16_f32 v76, v168, v169
    v_cvt_pk_bf16_f32 v77, v170, v171
    v_cvt_pk_bf16_f32 v78, v172, v173
    v_cvt_pk_bf16_f32 v79, v174, v175
    v_cvt_pk_bf16_f32 v92, v184, v185
    v_cvt_pk_bf16_f32 v93, v186, v187
    v_cvt_pk_bf16_f32 v94, v188, v189
    v_cvt_pk_bf16_f32 v95, v190, v191
    v_mfma_f32_32x32x16_bf16 v[192:207], v[64:67], a[160:163], v[192:207]
    v_mfma_f32_32x32x16_bf16 v[208:223], v[64:67], a[176:179], v[208:223]
    v_mfma_f32_32x32x16_bf16 v[224:239], v[80:83], a[160:163], v[224:239]
    v_mfma_f32_32x32x16_bf16 v[240:255], v[80:83], a[176:179], v[240:255]
    v_mfma_f32_32x32x16_bf16 v[192:207], v[68:71], a[164:167], v[192:207]
    v_mfma_f32_32x32x16_bf16 v[208:223], v[68:71], a[180:183], v[208:223]
    v_mfma_f32_32x32x16_bf16 v[224:239], v[84:87], a[164:167], v[224:239]
    v_mfma_f32_32x32x16_bf16 v[240:255], v[84:87], a[180:183], v[240:255]
    v_mfma_f32_32x32x16_bf16 v[192:207], v[72:75], a[168:171], v[192:207]
    v_mfma_f32_32x32x16_bf16 v[208:223], v[72:75], a[184:187], v[208:223]
    v_mfma_f32_32x32x16_bf16 v[224:239], v[88:91], a[168:171], v[224:239]
    v_mfma_f32_32x32x16_bf16 v[240:255], v[88:91], a[184:187], v[240:255]
    v_mfma_f32_32x32x16_bf16 v[192:207], v[76:79], a[172:175], v[192:207]
    v_mfma_f32_32x32x16_bf16 v[208:223], v[76:79], a[188:191], v[208:223]
    v_mfma_f32_32x32x16_bf16 v[224:239], v[92:95], a[172:175], v[224:239]
    v_mfma_f32_32x32x16_bf16 v[240:255], v[92:95], a[188:191], v[240:255]
    v_lshlrev_b32 v8, 7, v2
    v_lshl_add_u32 v8, v3, 3, v8
    s_add_u32 s55, s74, 49152
    v_add_u32 v8, s55, v8
    v_lshlrev_b32 v9, 4, v6
    v_xor_b32 v44, 0, v9
    v_add_u32 v22, v8, v44
    v_xor_b32 v44, 16, v9
    v_add_u32 v23, v8, v44
    v_xor_b32 v44, 32, v9
    v_add_u32 v24, v8, v44
    v_xor_b32 v44, 48, v9
    v_add_u32 v25, v8, v44
    v_xor_b32 v44, 64, v9
    v_add_u32 v26, v8, v44
    v_xor_b32 v44, 80, v9
    v_add_u32 v27, v8, v44
    v_xor_b32 v44, 96, v9
    v_add_u32 v28, v8, v44
    v_xor_b32 v44, 112, v9
    v_add_u32 v29, v8, v44
    v_cvt_pk_bf16_f32 v48, v192, v193
    v_cvt_pk_bf16_f32 v49, v194, v195
    ds_write_b64 v22, v[48:49] offset:0
    v_cvt_pk_bf16_f32 v50, v196, v197
    v_cvt_pk_bf16_f32 v51, v198, v199
    ds_write_b64 v23, v[50:51] offset:0
    v_cvt_pk_bf16_f32 v52, v200, v201
    v_cvt_pk_bf16_f32 v53, v202, v203
    ds_write_b64 v24, v[52:53] offset:0
    v_cvt_pk_bf16_f32 v54, v204, v205
    v_cvt_pk_bf16_f32 v55, v206, v207
    ds_write_b64 v25, v[54:55] offset:0
    v_cvt_pk_bf16_f32 v56, v224, v225
    v_cvt_pk_bf16_f32 v57, v226, v227
    ds_write_b64 v26, v[56:57] offset:0
    v_cvt_pk_bf16_f32 v58, v228, v229
    v_cvt_pk_bf16_f32 v59, v230, v231
    ds_write_b64 v27, v[58:59] offset:0
    v_cvt_pk_bf16_f32 v60, v232, v233
    v_cvt_pk_bf16_f32 v61, v234, v235
    ds_write_b64 v28, v[60:61] offset:0
    v_cvt_pk_bf16_f32 v62, v236, v237
    v_cvt_pk_bf16_f32 v63, v238, v239
    ds_write_b64 v29, v[62:63] offset:0
    v_cvt_pk_bf16_f32 v48, v208, v209
    v_cvt_pk_bf16_f32 v49, v210, v211
    ds_write_b64 v22, v[48:49] offset:4096
    v_cvt_pk_bf16_f32 v50, v212, v213
    v_cvt_pk_bf16_f32 v51, v214, v215
    ds_write_b64 v23, v[50:51] offset:4096
    v_cvt_pk_bf16_f32 v52, v216, v217
    v_cvt_pk_bf16_f32 v53, v218, v219
    ds_write_b64 v24, v[52:53] offset:4096
    v_cvt_pk_bf16_f32 v54, v220, v221
    v_cvt_pk_bf16_f32 v55, v222, v223
    ds_write_b64 v25, v[54:55] offset:4096
    v_cvt_pk_bf16_f32 v56, v240, v241
    v_cvt_pk_bf16_f32 v57, v242, v243
    ds_write_b64 v26, v[56:57] offset:4096
    v_cvt_pk_bf16_f32 v58, v244, v245
    v_cvt_pk_bf16_f32 v59, v246, v247
    ds_write_b64 v27, v[58:59] offset:4096
    v_cvt_pk_bf16_f32 v60, v248, v249
    v_cvt_pk_bf16_f32 v61, v250, v251
    ds_write_b64 v28, v[60:61] offset:4096
    v_cvt_pk_bf16_f32 v62, v252, v253
    v_cvt_pk_bf16_f32 v63, v254, v255
    ds_write_b64 v29, v[62:63] offset:4096
    s_waitcnt lgkmcnt(0)
    s_barrier
    v_lshrrev_b32 v8, 3, v0
    v_and_b32 v9, 7, v0
    v_and_b32 v44, 7, v8
    v_xor_b32 v9, v9, v44
    v_lshlrev_b32 v9, 4, v9
    v_lshl_add_u32 v9, v8, 7, v9
    v_add_u32 v9, 49152, v9
    ds_read_b128 v[64:67], v9 offset:0
    ds_read_b128 v[68:71], v9 offset:8192
    ds_read_b128 v[72:75], v9 offset:16384
    ds_read_b128 v[76:79], v9 offset:24576
    ds_read_b128 v[80:83], v9 offset:4096
    ds_read_b128 v[84:87], v9 offset:12288
    ds_read_b128 v[88:91], v9 offset:20480
    ds_read_b128 v[92:95], v9 offset:28672
    v_mov_b32 v98, 0x00003f80
    v_mov_b32 v99, 0x3f800000
    s_waitcnt lgkmcnt(4)
    v_dot2_f32_bf16 v96, v14, v98, 0
    v_dot2_f32_bf16 v97, v14, v99, 0
    v_dot2_f32_bf16 v96, v64, v98, v96
    v_dot2_f32_bf16 v97, v64, v99, v97
    v_dot2_f32_bf16 v96, v68, v98, v96
    v_dot2_f32_bf16 v97, v68, v99, v97
    v_dot2_f32_bf16 v96, v72, v98, v96
    v_dot2_f32_bf16 v97, v72, v99, v97
    v_dot2_f32_bf16 v96, v76, v98, v96
    v_dot2_f32_bf16 v97, v76, v99, v97
    v_dot2_f32_bf16 v108, v15, v98, 0
    v_dot2_f32_bf16 v109, v15, v99, 0
    v_dot2_f32_bf16 v108, v65, v98, v108
    v_dot2_f32_bf16 v109, v65, v99, v109
    v_dot2_f32_bf16 v108, v69, v98, v108
    v_dot2_f32_bf16 v109, v69, v99, v109
    v_dot2_f32_bf16 v108, v73, v98, v108
    v_dot2_f32_bf16 v109, v73, v99, v109
    v_dot2_f32_bf16 v108, v77, v98, v108
    v_dot2_f32_bf16 v109, v77, v99, v109
    v_cvt_pk_bf16_f32 v100, v96, v97
    v_dot2_f32_bf16 v96, v16, v98, 0
    v_dot2_f32_bf16 v97, v16, v99, 0
    v_dot2_f32_bf16 v96, v66, v98, v96
    v_dot2_f32_bf16 v97, v66, v99, v97
    v_dot2_f32_bf16 v96, v70, v98, v96
    v_dot2_f32_bf16 v97, v70, v99, v97
    v_dot2_f32_bf16 v96, v74, v98, v96
    v_dot2_f32_bf16 v97, v74, v99, v97
    v_dot2_f32_bf16 v96, v78, v98, v96
    v_dot2_f32_bf16 v97, v78, v99, v97
    v_cvt_pk_bf16_f32 v101, v108, v109
    v_dot2_f32_bf16 v108, v17, v98, 0
    v_dot2_f32_bf16 v109, v17, v99, 0
    v_dot2_f32_bf16 v108, v67, v98, v108
    v_dot2_f32_bf16 v109, v67, v99, v109
    v_dot2_f32_bf16 v108, v71, v98, v108
    v_dot2_f32_bf16 v109, v71, v99, v109
    v_dot2_f32_bf16 v108, v75, v98, v108
    v_dot2_f32_bf16 v109, v75, v99, v109
    v_dot2_f32_bf16 v108, v79, v98, v108
    v_dot2_f32_bf16 v109, v79, v99, v109
    v_cvt_pk_bf16_f32 v102, v96, v97
    s_nop 1
    v_cvt_pk_bf16_f32 v103, v108, v109
    buffer_store_dwordx4 v[100:103], v33, s[24:27], s69 offen
    s_waitcnt lgkmcnt(0)
    v_dot2_f32_bf16 v96, v18, v98, 0
    v_dot2_f32_bf16 v97, v18, v99, 0
    v_dot2_f32_bf16 v96, v80, v98, v96
    v_dot2_f32_bf16 v97, v80, v99, v97
    v_dot2_f32_bf16 v96, v84, v98, v96
    v_dot2_f32_bf16 v97, v84, v99, v97
    v_dot2_f32_bf16 v96, v88, v98, v96
    v_dot2_f32_bf16 v97, v88, v99, v97
    v_dot2_f32_bf16 v96, v92, v98, v96
    v_dot2_f32_bf16 v97, v92, v99, v97
    v_dot2_f32_bf16 v108, v19, v98, 0
    v_dot2_f32_bf16 v109, v19, v99, 0
    v_dot2_f32_bf16 v108, v81, v98, v108
    v_dot2_f32_bf16 v109, v81, v99, v109
    v_dot2_f32_bf16 v108, v85, v98, v108
    v_dot2_f32_bf16 v109, v85, v99, v109
    v_dot2_f32_bf16 v108, v89, v98, v108
    v_dot2_f32_bf16 v109, v89, v99, v109
    v_dot2_f32_bf16 v108, v93, v98, v108
    v_dot2_f32_bf16 v109, v93, v99, v109
    v_cvt_pk_bf16_f32 v104, v96, v97
    v_dot2_f32_bf16 v96, v20, v98, 0
    v_dot2_f32_bf16 v97, v20, v99, 0
    v_dot2_f32_bf16 v96, v82, v98, v96
    v_dot2_f32_bf16 v97, v82, v99, v97
    v_dot2_f32_bf16 v96, v86, v98, v96
    v_dot2_f32_bf16 v97, v86, v99, v97
    v_dot2_f32_bf16 v96, v90, v98, v96
    v_dot2_f32_bf16 v97, v90, v99, v97
    v_dot2_f32_bf16 v96, v94, v98, v96
    v_dot2_f32_bf16 v97, v94, v99, v97
    v_cvt_pk_bf16_f32 v105, v108, v109
    v_dot2_f32_bf16 v108, v21, v98, 0
    v_dot2_f32_bf16 v109, v21, v99, 0
    v_dot2_f32_bf16 v108, v83, v98, v108
    v_dot2_f32_bf16 v109, v83, v99, v109
    v_dot2_f32_bf16 v108, v87, v98, v108
    v_dot2_f32_bf16 v109, v87, v99, v109
    v_dot2_f32_bf16 v108, v91, v98, v108
    v_dot2_f32_bf16 v109, v91, v99, v109
    v_dot2_f32_bf16 v108, v95, v98, v108
    v_dot2_f32_bf16 v109, v95, v99, v109
    v_cvt_pk_bf16_f32 v106, v96, v97
    s_nop 1
    v_cvt_pk_bf16_f32 v107, v108, v109
    s_add_u32 s55, s69, 1048576
    buffer_store_dwordx4 v[104:107], v33, s[24:27], s55 offen
    s_branch L_end
L_nslow_5:
    s_mov_b32 s73, 0
L_nloop_7:
    s_sleep 1
    buffer_load_dword v46, v43, s[40:43], 0 offen sc1
    s_add_u32 s73, s73, 1
    s_waitcnt vmcnt(0)
    v_readfirstlane_b32 s51, v46
    s_cmp_lg_u32 s51, 0
    s_cbranch_scc1 L_nback_6
    s_cmp_lt_u32 s73, 100000
    s_cbranch_scc1 L_nloop_7
    s_branch L_nback_6
L_cslow_12:
    s_mov_b32 s73, 0
L_cloop_14:
    s_sleep 1
    buffer_load_dwordx4 v[96:99], v126, s[20:23], s79 offen offset:0 sc1
    buffer_load_dwordx4 v[100:103], v126, s[20:23], s79 offen offset:1024 sc1
    buffer_load_dwordx4 v[104:107], v126, s[20:23], s79 offen offset:2048 sc1
    buffer_load_dwordx4 v[108:111], v126, s[20:23], s79 offen offset:3072 sc1
    s_add_u32 s73, s73, 1
    s_waitcnt vmcnt(0)
    v_xor_b32 v43, v46, v97
    v_xor_b32 v44, v46, v99
    v_or_b32 v43, v43, v44
    v_xor_b32 v44, v46, v101
    v_or_b32 v43, v43, v44
    v_xor_b32 v44, v46, v103
    v_or_b32 v43, v43, v44
    v_xor_b32 v44, v46, v105
    v_or_b32 v43, v43, v44
    v_xor_b32 v44, v46, v107
    v_or_b32 v43, v43, v44
    v_xor_b32 v44, v46, v109
    v_or_b32 v43, v43, v44
    v_xor_b32 v44, v46, v111
    v_or_b32 v43, v43, v44
    v_cmp_ne_u32 vcc, 0, v43
    s_cbranch_vccz L_cback_13
    s_cmp_lt_u32 s73, 50000
    s_cbranch_scc1 L_cloop_14
    s_branch L_cback_13
L_sslow_15:
    s_mov_b32 s73, 0
    v_lshlrev_b32 v45, 4, v2
L_sloop_17:
    s_sleep 1
    buffer_load_dwordx4 v[112:115], v45, s[20:23], s75 offen sc1
    buffer_load_dwordx4 v[116:119], v45, s[20:23], s75 offen offset:512 sc1
    s_add_u32 s73, s73, 1
    s_waitcnt vmcnt(0)
    v_xor_b32 v43, v46, v115
    v_xor_b32 v44, v46, v119
    v_or_b32 v43, v43, v44
    v_cmp_ne_u32 vcc, 0, v43
    s_cbranch_vccz L_sback_16
    s_cmp_lt_u32 s73, 50000
    s_cbranch_scc1 L_sloop_17
    s_branch L_sback_16
L_slow_18:
    s_mov_b32 s73, 0
L_loop_20:
    s_sleep 1
    buffer_load_dword v127, v126, s[20:23], 0 offen sc1
    s_add_u32 s73, s73, 1
    s_waitcnt vmcnt(0)
    v_cmp_ne_u32 vcc, v43, v127
    s_cbranch_vccz L_back_19
    s_cmp_lt_u32 s73, 50000
    s_cbranch_scc1 L_loop_20
    s_branch L_back_19
L_slow_28:
    s_mov_b32 s73, 0
L_loop_30:
    s_sleep 1
    buffer_load_dword v127, v126, s[20:23], 0 offen sc1
    s_add_u32 s73, s73, 1
    s_waitcnt vmcnt(0)
    v_cmp_ne_u32 vcc, v43, v127
    s_cbranch_vccz L_back_29
    s_cmp_lt_u32 s73, 50000
    s_cbranch_scc1 L_loop_30
    s_branch L_back_29
L_slow_31:
    s_mov_b32 s73, 0
L_loop_33:
    s_sleep 1
    buffer_load_dwordx4 v[28:31], v27, s[20:23], 0 offen sc1
    s_add_u32 s73, s73, 1
    s_waitcnt vmcnt(0)
    v_xor_b32 v28, v43, v28
    v_xor_b32 v29, v43, v29
    v_xor_b32 v30, v43, v30
    v_xor_b32 v31, v43, v31
    v_or3_b32 v28, v28, v29, v30
    v_or_b32 v28, v28, v31
    v_cmp_ne_u32 vcc, 0, v28
    s_cbranch_vccz L_back_32
    s_cmp_lt_u32 s73, 50000
    s_cbranch_scc1 L_loop_33
    s_branch L_back_32
L_mixed:
    s_sub_u32 s55, s46, 12
    s_lshl_b32 s62, s55, 6
    s_add_u32 s62, s62, 1536
    s_mul_i32 s54, s44, 57344
    s_lshl_b32 s56, s62, 1
    s_add_u32 s54, s54, s56
    s_lshl_b32 s63, s55, 12
    s_lshl_b32 s56, s44, 14
    s_add_u32 s63, s63, s56
    s_add_u32 s63, s63, 0
    s_movk_i32 s55, 3584
    v_mul_lo_u32 v9, v7, s55
    v_lshrrev_b32 v8, 1, v6
    v_and_b32 v44, 1, v5
    v_xor_b32 v8, v8, v44
    v_and_b32 v44, 1, v1
    v_lshl_or_b32 v8, v8, 1, v44
    v_lshl_add_u32 v40, v8, 4, v9
    v_xor_b32 v8, 4, v8
    v_lshl_add_u32 v41, v8, 4, v9
    s_lshr_b32 s66, s45, 1
    s_waitcnt lgkmcnt(0)
    s_and_b32 s5, s5, 0xffff
    s_and_b32 s9, s9, 0xffff
    s_and_b32 s13, s13, 0xffff
    s_or_b32 s74, s100, 1
    s_or_b32 s55, s2, s44
    s_cmp_eq_u32 s55, 0
    s_cbranch_scc0 L_ldr_34
    s_mov_b32 s40, s96
    s_and_b32 s41, s97, 0xffff
    s_mov_b32 s42, 256
    s_mov_b32 s43, 0x20000
    v_mov_b32 v9, 2147483632
    v_cmp_eq_u32 vcc, 0, v0
    v_mov_b32 v8, s74
    s_nop 0
    v_cndmask_b32_e64 v9, v9, 0, vcc
    buffer_store_dword v8, v9, s[40:43], 0 offen sc1
L_ldr_34:
    s_add_u32 s59, s66, 0
    s_and_b32 s59, s59, 7
    s_lshl_b32 s64, s59, 7
    s_add_u32 s64, s64, s53
    s_lshl_b32 s67, s59, 16
    s_add_u32 s67, s67, s63
    s_add_u32 m0, s52, 0
    s_add_u32 s59, s64, 0
    buffer_load_dwordx4 v38, s[4:7], s59 offen lds
    s_add_u32 m0, s52, 1024
    s_add_u32 s59, s64, 262144
    buffer_load_dwordx4 v39, s[4:7], s59 offen lds
    s_add_u32 m0, s52, 2048
    s_add_u32 s59, s64, 524288
    buffer_load_dwordx4 v38, s[4:7], s59 offen lds
    s_add_u32 m0, s52, 3072
    s_add_u32 s59, s64, 786432
    buffer_load_dwordx4 v39, s[4:7], s59 offen lds
    s_add_u32 m0, s52, 16384
    s_add_u32 s59, s67, 0
    buffer_load_dwordx4 v42, s[28:31], s59 offen lds
    s_add_u32 m0, s52, 17408
    s_add_u32 s59, s67, 1024
    buffer_load_dwordx4 v42, s[28:31], s59 offen lds
    s_add_u32 m0, s52, 18432
    s_add_u32 s59, s67, 2048
    buffer_load_dwordx4 v42, s[28:31], s59 offen lds
    s_add_u32 m0, s52, 19456
    s_add_u32 s59, s67, 3072
    buffer_load_dwordx4 v42, s[28:31], s59 offen lds
    s_getpc_b64 s[70:71]
L_cpf_35:
    s_sub_u32 s70, s70, L_cpf_35-parallel_sum__spectral_gfnet__glu_gated_swiglu__prompt_kernel
    s_subb_u32 s71, s71, 0
    s_lshr_b32 s72, s2, 3
    s_lshl_b32 s72, s72, 2
    s_add_u32 s72, s72, s44
    s_lshl_b32 s72, s72, 9
    s_add_u32 s73, s72, 0
    s_min_u32 s73, s73, L_end-parallel_sum__spectral_gfnet__glu_gated_swiglu__prompt_kernel
    s_load_dword s69, s[70:71], s73
    s_add_u32 s73, s72, 128
    s_min_u32 s73, s73, L_end-parallel_sum__spectral_gfnet__glu_gated_swiglu__prompt_kernel
    s_load_dword s69, s[70:71], s73
    s_add_u32 s73, s72, 256
    s_min_u32 s73, s73, L_end-parallel_sum__spectral_gfnet__glu_gated_swiglu__prompt_kernel
    s_load_dword s69, s[70:71], s73
    s_add_u32 s73, s72, 384
    s_min_u32 s73, s73, L_end-parallel_sum__spectral_gfnet__glu_gated_swiglu__prompt_kernel
    s_load_dword s69, s[70:71], s73
    s_add_u32 s59, s66, 1
    s_and_b32 s59, s59, 7
    s_lshl_b32 s64, s59, 7
    s_add_u32 s64, s64, s53
    s_lshl_b32 s67, s59, 16
    s_add_u32 s67, s67, s63
    s_add_u32 m0, s52, 32768
    s_add_u32 s59, s64, 0
    buffer_load_dwordx4 v38, s[4:7], s59 offen lds
    s_add_u32 m0, s52, 33792
    s_add_u32 s59, s64, 262144
    buffer_load_dwordx4 v39, s[4:7], s59 offen lds
    s_add_u32 m0, s52, 34816
    s_add_u32 s59, s64, 524288
    buffer_load_dwordx4 v38, s[4:7], s59 offen lds
    s_add_u32 m0, s52, 35840
    s_add_u32 s59, s64, 786432
    buffer_load_dwordx4 v39, s[4:7], s59 offen lds
    s_add_u32 m0, s52, 49152
    s_add_u32 s59, s67, 0
    buffer_load_dwordx4 v42, s[28:31], s59 offen lds
    s_add_u32 m0, s52, 50176
    s_add_u32 s59, s67, 1024
    buffer_load_dwordx4 v42, s[28:31], s59 offen lds
    s_add_u32 m0, s52, 51200
    s_add_u32 s59, s67, 2048
    buffer_load_dwordx4 v42, s[28:31], s59 offen lds
    s_add_u32 m0, s52, 52224
    s_add_u32 s59, s67, 3072
    buffer_load_dwordx4 v42, s[28:31], s59 offen lds
    s_mov_b32 s40, s96
    s_and_b32 s41, s97, 0xffff
    s_mov_b32 s42, 256
    s_mov_b32 s43, 0x20000
    s_mov_b32 s20, s98
    s_and_b32 s21, s99, 0xffff
    s_mov_b32 s22, 33554432
    s_mov_b32 s23, 0x20000
    s_mov_b32 s32, s88
    s_and_b32 s33, s89, 0xffff
    s_mov_b32 s34, 1052672
    s_mov_b32 s35, 0x20000
    s_mov_b32 s36, s90
    s_and_b32 s37, s91, 0xffff
    s_mov_b32 s38, 1052672
    s_mov_b32 s39, 0x20000
    s_mov_b32 s16, s92
    s_and_b32 s17, s93, 0xffff
    s_mov_b32 s18, 1835008
    s_mov_b32 s19, 0x20000
    s_mov_b32 s24, s94
    s_and_b32 s25, s95, 0xffff
    s_mov_b32 s26, 2097152
    s_mov_b32 s27, 0x20000
    v_lshrrev_b32 v8, 1, v2
    v_and_b32 v8, 7, v8
    v_xor_b32 v8, v8, v3
    v_lshlrev_b32 v9, 7, v2
    s_lshl_b32 s55, s61, 13
    v_add_u32 v9, s55, v9
    v_xor_b32 v44, 0, v8
    v_lshl_add_u32 v10, v44, 4, v9
    v_add_u32 v14, 32768, v10
    v_add_u32 v18, 65536, v10
    v_add_u32 v22, 98304, v10
    v_xor_b32 v44, 2, v8
    v_lshl_add_u32 v11, v44, 4, v9
    v_add_u32 v15, 32768, v11
    v_add_u32 v19, 65536, v11
    v_add_u32 v23, 98304, v11
    v_xor_b32 v44, 4, v8
    v_lshl_add_u32 v12, v44, 4, v9
    v_add_u32 v16, 32768, v12
    v_add_u32 v20, 65536, v12
    v_add_u32 v24, 98304, v12
    v_xor_b32 v44, 6, v8
    v_lshl_add_u32 v13, v44, 4, v9
    v_add_u32 v17, 32768, v13
    v_add_u32 v21, 65536, v13
    v_add_u32 v25, 98304, v13
    s_lshl_b32 s55, s60, 11
    s_add_u32 s55, s55, 16384
    v_add_u32 v26, s55, v42
    v_add_u32 v27, 32768, v26
    v_add_u32 v28, 65536, v26
    v_add_u32 v29, 98304, v26
    v_lshrrev_b32 v8, 2, v4
    v_and_b32 v9, 1, v5
    v_lshl_add_u32 v44, v3, 3, v8
    v_lshlrev_b32 v44, 7, v44
    v_lshl_add_u32 v44, v9, 13, v44
    v_and_b32 v45, 3, v4
    v_lshl_add_u32 v44, v45, 3, v44
    v_add_u32 v44, 49152, v44
    v_lshrrev_b32 v8, 1, v8
    v_lshl_or_b32 v8, v9, 1, v8
    s_lshl_b32 s55, s60, 1
    v_xor_b32 v8, s55, v8
    v_xor_b32 v45, 0, v8
    v_lshl_add_u32 v30, v45, 5, v44
    v_add_u32 v32, 65536, v30
    v_xor_b32 v45, 1, v8
    v_lshl_add_u32 v31, v45, 5, v44
    v_add_u32 v33, 65536, v31
    v_add_u32 v112, 0, v2
    v_lshrrev_b32 v113, 1, v112
    v_cvt_f32_u32 v113, v113
    v_mul_f32 v113, 0x3c800000, v113
    v_and_b32 v114, 1, v112
    v_cvt_f32_u32 v114, v114
    v_mul_f32 v114, 0xbe800000, v114
    v_cmp_eq_u32 vcc, 1, v112
    s_nop 1
    v_cndmask_b32_e64 v113, v113, 0.5, vcc
    v_cndmask_b32_e64 v114, v114, 0, vcc
    v_lshlrev_b32 v115, 2, v3
    v_cvt_f32_u32 v115, v115
    v_fmac_f32 v114, v113, v115
    v_mov_b32 v118, v114
    v_fmamk_f32 v119, v113, 0x3f800000, v114
    v_fmamk_f32 v120, v113, 0x40000000, v114
    v_fmamk_f32 v121, v113, 0x40400000, v114
    v_cos_f32 v118, v118
    v_cos_f32 v119, v119
    v_cos_f32 v120, v120
    v_cos_f32 v121, v121
    s_nop 0
    v_cvt_pk_bf16_f32 v80, v118, v119
    v_cvt_pk_bf16_f32 v81, v120, v121
    v_fmamk_f32 v118, v113, 0x41000000, v114
    v_fmamk_f32 v119, v113, 0x41100000, v114
    v_fmamk_f32 v120, v113, 0x41200000, v114
    v_fmamk_f32 v121, v113, 0x41300000, v114
    v_cos_f32 v118, v118
    v_cos_f32 v119, v119
    v_cos_f32 v120, v120
    v_cos_f32 v121, v121
    s_nop 0
    v_cvt_pk_bf16_f32 v82, v118, v119
    v_cvt_pk_bf16_f32 v83, v120, v121
    v_fmamk_f32 v118, v113, 0x41800000, v114
    v_fmamk_f32 v119, v113, 0x41880000, v114
    v_fmamk_f32 v120, v113, 0x41900000, v114
    v_fmamk_f32 v121, v113, 0x41980000, v114
    v_cos_f32 v118, v118
    v_cos_f32 v119, v119
    v_cos_f32 v120, v120
    v_cos_f32 v121, v121
    s_nop 0
    v_cvt_pk_bf16_f32 v84, v118, v119
    v_cvt_pk_bf16_f32 v85, v120, v121
    v_fmamk_f32 v118, v113, 0x41c00000, v114
    v_fmamk_f32 v119, v113, 0x41c80000, v114
    v_fmamk_f32 v120, v113, 0x41d00000, v114
    v_fmamk_f32 v121, v113, 0x41d80000, v114
    v_cos_f32 v118, v118
    v_cos_f32 v119, v119
    v_cos_f32 v120, v120
    v_cos_f32 v121, v121
    s_nop 0
    v_cvt_pk_bf16_f32 v86, v118, v119
    v_cvt_pk_bf16_f32 v87, v120, v121
    v_fmamk_f32 v118, v113, 0x42000000, v114
    v_fmamk_f32 v119, v113, 0x42040000, v114
    v_fmamk_f32 v120, v113, 0x42080000, v114
    v_fmamk_f32 v121, v113, 0x420c0000, v114
    v_cos_f32 v118, v118
    v_cos_f32 v119, v119
    v_cos_f32 v120, v120
    v_cos_f32 v121, v121
    s_nop 0
    v_cvt_pk_bf16_f32 v88, v118, v119
    v_cvt_pk_bf16_f32 v89, v120, v121
    v_fmamk_f32 v118, v113, 0x42200000, v114
    v_fmamk_f32 v119, v113, 0x42240000, v114
    v_fmamk_f32 v120, v113, 0x42280000, v114
    v_fmamk_f32 v121, v113, 0x422c0000, v114
    v_cos_f32 v118, v118
    v_cos_f32 v119, v119
    v_cos_f32 v120, v120
    v_cos_f32 v121, v121
    s_nop 0
    v_cvt_pk_bf16_f32 v90, v118, v119
    v_cvt_pk_bf16_f32 v91, v120, v121
    v_fmamk_f32 v118, v113, 0x42400000, v114
    v_fmamk_f32 v119, v113, 0x42440000, v114
    v_fmamk_f32 v120, v113, 0x42480000, v114
    v_fmamk_f32 v121, v113, 0x424c0000, v114
    v_cos_f32 v118, v118
    v_cos_f32 v119, v119
    v_cos_f32 v120, v120
    v_cos_f32 v121, v121
    s_nop 0
    v_cvt_pk_bf16_f32 v92, v118, v119
    v_cvt_pk_bf16_f32 v93, v120, v121
    v_fmamk_f32 v118, v113, 0x42600000, v114
    v_fmamk_f32 v119, v113, 0x42640000, v114
    v_fmamk_f32 v120, v113, 0x42680000, v114
    v_fmamk_f32 v121, v113, 0x426c0000, v114
    v_cos_f32 v118, v118
    v_cos_f32 v119, v119
    v_cos_f32 v120, v120
    v_cos_f32 v121, v121
    s_nop 0
    v_cvt_pk_bf16_f32 v94, v118, v119
    v_cvt_pk_bf16_f32 v95, v120, v121
    v_add_u32 v112, 32, v2
    v_lshrrev_b32 v113, 1, v112
    v_cvt_f32_u32 v113, v113
    v_mul_f32 v113, 0x3c800000, v113
    v_and_b32 v114, 1, v112
    v_cvt_f32_u32 v114, v114
    v_mul_f32 v114, 0xbe800000, v114
    v_lshlrev_b32 v115, 2, v3
    v_cvt_f32_u32 v115, v115
    v_fmac_f32 v114, v113, v115
    v_mov_b32 v118, v114
    v_fmamk_f32 v119, v113, 0x3f800000, v114
    v_fmamk_f32 v120, v113, 0x40000000, v114
    v_fmamk_f32 v121, v113, 0x40400000, v114
    v_cos_f32 v118, v118
    v_cos_f32 v119, v119
    v_cos_f32 v120, v120
    v_cos_f32 v121, v121
    s_nop 0
    v_cvt_pk_bf16_f32 v96, v118, v119
    v_cvt_pk_bf16_f32 v97, v120, v121
    v_fmamk_f32 v118, v113, 0x41000000, v114
    v_fmamk_f32 v119, v113, 0x41100000, v114
    v_fmamk_f32 v120, v113, 0x41200000, v114
    v_fmamk_f32 v121, v113, 0x41300000, v114
    v_cos_f32 v118, v118
    v_cos_f32 v119, v119
    v_cos_f32 v120, v120
    v_cos_f32 v121, v121
    s_nop 0
    v_cvt_pk_bf16_f32 v98, v118, v119
    v_cvt_pk_bf16_f32 v99, v120, v121
    v_fmamk_f32 v118, v113, 0x41800000, v114
    v_fmamk_f32 v119, v113, 0x41880000, v114
    v_fmamk_f32 v120, v113, 0x41900000, v114
    v_fmamk_f32 v121, v113, 0x41980000, v114
    v_cos_f32 v118, v118
    v_cos_f32 v119, v119
    v_cos_f32 v120, v120
    v_cos_f32 v121, v121
    s_nop 0
    v_cvt_pk_bf16_f32 v100, v118, v119
    v_cvt_pk_bf16_f32 v101, v120, v121
    v_fmamk_f32 v118, v113, 0x41c00000, v114
    v_fmamk_f32 v119, v113, 0x41c80000, v114
    v_fmamk_f32 v120, v113, 0x41d00000, v114
    v_fmamk_f32 v121, v113, 0x41d80000, v114
    v_cos_f32 v118, v118
    v_cos_f32 v119, v119
    v_cos_f32 v120, v120
    v_cos_f32 v121, v121
    s_nop 0
    v_cvt_pk_bf16_f32 v102, v118, v119
    v_cvt_pk_bf16_f32 v103, v120, v121
    v_fmamk_f32 v118, v113, 0x42000000, v114
    v_fmamk_f32 v119, v113, 0x42040000, v114
    v_fmamk_f32 v120, v113, 0x42080000, v114
    v_fmamk_f32 v121, v113, 0x420c0000, v114
    v_cos_f32 v118, v118
    v_cos_f32 v119, v119
    v_cos_f32 v120, v120
    v_cos_f32 v121, v121
    s_nop 0
    v_cvt_pk_bf16_f32 v104, v118, v119
    v_cvt_pk_bf16_f32 v105, v120, v121
    v_fmamk_f32 v118, v113, 0x42200000, v114
    v_fmamk_f32 v119, v113, 0x42240000, v114
    v_fmamk_f32 v120, v113, 0x42280000, v114
    v_fmamk_f32 v121, v113, 0x422c0000, v114
    v_cos_f32 v118, v118
    v_cos_f32 v119, v119
    v_cos_f32 v120, v120
    v_cos_f32 v121, v121
    s_nop 0
    v_cvt_pk_bf16_f32 v106, v118, v119
    v_cvt_pk_bf16_f32 v107, v120, v121
    v_fmamk_f32 v118, v113, 0x42400000, v114
    v_fmamk_f32 v119, v113, 0x42440000, v114
    v_fmamk_f32 v120, v113, 0x42480000, v114
    v_fmamk_f32 v121, v113, 0x424c0000, v114
    v_cos_f32 v118, v118
    v_cos_f32 v119, v119
    v_cos_f32 v120, v120
    v_cos_f32 v121, v121
    s_nop 0
    v_cvt_pk_bf16_f32 v108, v118, v119
    v_cvt_pk_bf16_f32 v109, v120, v121
    v_fmamk_f32 v118, v113, 0x42600000, v114
    v_fmamk_f32 v119, v113, 0x42640000, v114
    v_fmamk_f32 v120, v113, 0x42680000, v114
    v_fmamk_f32 v121, v113, 0x426c0000, v114
    v_cos_f32 v118, v118
    v_cos_f32 v119, v119
    v_cos_f32 v120, v120
    v_cos_f32 v121, v121
    s_nop 0
    v_cvt_pk_bf16_f32 v110, v118, v119
    v_cvt_pk_bf16_f32 v111, v120, v121
    s_waitcnt vmcnt(8)
    s_barrier
    ds_read_b128 a[0:3], v10
    ds_read_b128 v[48:51], v26 offset:0
    ds_read_b128 v[52:55], v26 offset:1024
    ds_read_b128 a[4:7], v10 offset:4096
    ds_read_b128 a[8:11], v11
    ds_read_b128 v[56:59], v26 offset:4096
    ds_read_b128 v[60:63], v26 offset:5120
    ds_read_b128 a[12:15], v11 offset:4096
    s_waitcnt lgkmcnt(0)
    v_mfma_f32_32x32x16_bf16 v[128:143], a[0:3], v[48:51], 0
    ds_read_b128 a[16:19], v12
    ds_read_b128 v[64:67], v26 offset:8192
    ds_read_b128 v[68:71], v26 offset:9216
    s_add_u32 s59, s66, 2
    s_and_b32 s59, s59, 7
    s_lshl_b32 s64, s59, 7
    v_mfma_f32_32x32x16_bf16 v[144:159], a[0:3], v[52:55], 0
    ds_read_b128 a[20:23], v12 offset:4096
    ds_read_b128 a[24:27], v13
    ds_read_b128 v[72:75], v26 offset:12288
    s_add_u32 s64, s64, s53
    s_lshl_b32 s67, s59, 16
    s_add_u32 s67, s67, s63
    v_mfma_f32_32x32x16_bf16 v[160:175], a[4:7], v[48:51], 0
    ds_read_b128 v[76:79], v26 offset:13312
    ds_read_b128 a[28:31], v13 offset:4096
    v_mfma_f32_32x32x16_bf16 v[176:191], a[4:7], v[52:55], 0
    s_add_u32 m0, s52, 65536
    s_add_u32 s59, s64, 0
    buffer_load_dwordx4 v38, s[4:7], s59 offen lds
    v_mfma_f32_32x32x16_bf16 v[128:143], a[8:11], v[56:59], v[128:143]
    s_add_u32 m0, s52, 66560
    s_add_u32 s59, s64, 262144
    buffer_load_dwordx4 v39, s[4:7], s59 offen lds
    v_mfma_f32_32x32x16_bf16 v[144:159], a[8:11], v[60:63], v[144:159]
    s_add_u32 m0, s52, 67584
    s_add_u32 s59, s64, 524288
    buffer_load_dwordx4 v38, s[4:7], s59 offen lds
    v_mfma_f32_32x32x16_bf16 v[160:175], a[12:15], v[56:59], v[160:175]
    s_add_u32 m0, s52, 68608
    s_add_u32 s59, s64, 786432
    buffer_load_dwordx4 v39, s[4:7], s59 offen lds
    v_mfma_f32_32x32x16_bf16 v[176:191], a[12:15], v[60:63], v[176:191]
    s_add_u32 m0, s52, 81920
    s_add_u32 s59, s67, 0
    buffer_load_dwordx4 v42, s[28:31], s59 offen lds
    s_waitcnt lgkmcnt(0)
    s_waitcnt vmcnt(5)
    s_barrier
    v_mfma_f32_32x32x16_bf16 v[128:143], a[16:19], v[64:67], v[128:143]
    ds_read_b128 a[32:35], v14
    ds_read_b128 v[48:51], v27 offset:0
    ds_read_b128 v[52:55], v27 offset:1024
    v_mov_b32 v44, 0
    v_cmp_gt_u32 vcc, 1, v0
    v_mov_b32 v47, 2147483632
    v_mfma_f32_32x32x16_bf16 v[144:159], a[16:19], v[68:71], v[144:159]
    ds_read_b128 a[36:39], v14 offset:4096
    ds_read_b128 a[40:43], v15
    ds_read_b128 v[56:59], v27 offset:4096
    v_cndmask_b32 v43, v47, v44, vcc
    buffer_load_dword v46, v43, s[40:43], 0 offen sc1
    v_mfma_f32_32x32x16_bf16 v[160:175], a[20:23], v[64:67], v[160:175]
    ds_read_b128 v[60:63], v27 offset:5120
    ds_read_b128 a[44:47], v15 offset:4096
    v_mfma_f32_32x32x16_bf16 v[176:191], a[20:23], v[68:71], v[176:191]
    s_add_u32 m0, s52, 82944
    s_add_u32 s59, s67, 1024
    buffer_load_dwordx4 v42, s[28:31], s59 offen lds
    v_mfma_f32_32x32x16_bf16 v[128:143], a[24:27], v[72:75], v[128:143]
    s_add_u32 m0, s52, 83968
    s_add_u32 s59, s67, 2048
    buffer_load_dwordx4 v42, s[28:31], s59 offen lds
    v_mfma_f32_32x32x16_bf16 v[144:159], a[24:27], v[76:79], v[144:159]
    s_add_u32 m0, s52, 84992
    s_add_u32 s59, s67, 3072
    buffer_load_dwordx4 v42, s[28:31], s59 offen lds
    v_mfma_f32_32x32x16_bf16 v[160:175], a[28:31], v[72:75], v[160:175]
    s_add_u32 s59, s66, 3
    s_and_b32 s59, s59, 7
    s_lshl_b32 s64, s59, 7
    s_add_u32 s64, s64, s53
    s_lshl_b32 s67, s59, 16
    s_add_u32 s67, s67, s63
    v_mfma_f32_32x32x16_bf16 v[176:191], a[28:31], v[76:79], v[176:191]
    s_add_u32 m0, s52, 98304
    s_add_u32 s59, s64, 0
    buffer_load_dwordx4 v38, s[4:7], s59 offen lds
    s_waitcnt lgkmcnt(0)
    v_mfma_f32_32x32x16_bf16 v[128:143], a[32:35], v[48:51], v[128:143]
    ds_read_b128 a[48:51], v16
    ds_read_b128 v[64:67], v27 offset:8192
    ds_read_b128 v[68:71], v27 offset:9216
    v_mfma_f32_32x32x16_bf16 v[144:159], a[32:35], v[52:55], v[144:159]
    ds_read_b128 a[52:55], v16 offset:4096
    ds_read_b128 a[56:59], v17
    ds_read_b128 v[72:75], v27 offset:12288
    v_mfma_f32_32x32x16_bf16 v[160:175], a[36:39], v[48:51], v[160:175]
    ds_read_b128 v[76:79], v27 offset:13312
    ds_read_b128 a[60:63], v17 offset:4096
    v_mfma_f32_32x32x16_bf16 v[176:191], a[36:39], v[52:55], v[176:191]
    s_add_u32 m0, s52, 99328
    s_add_u32 s59, s64, 262144
    buffer_load_dwordx4 v39, s[4:7], s59 offen lds
    v_mfma_f32_32x32x16_bf16 v[128:143], a[40:43], v[56:59], v[128:143]
    s_add_u32 m0, s52, 100352
    s_add_u32 s59, s64, 524288
    buffer_load_dwordx4 v38, s[4:7], s59 offen lds
    v_mfma_f32_32x32x16_bf16 v[144:159], a[40:43], v[60:63], v[144:159]
    s_add_u32 m0, s52, 101376
    s_add_u32 s59, s64, 786432
    buffer_load_dwordx4 v39, s[4:7], s59 offen lds
    v_mfma_f32_32x32x16_bf16 v[160:175], a[44:47], v[56:59], v[160:175]
    s_add_u32 m0, s52, 114688
    s_add_u32 s59, s67, 0
    buffer_load_dwordx4 v42, s[28:31], s59 offen lds
    v_mfma_f32_32x32x16_bf16 v[176:191], a[44:47], v[60:63], v[176:191]
    s_add_u32 m0, s52, 115712
    s_add_u32 s59, s67, 1024
    buffer_load_dwordx4 v42, s[28:31], s59 offen lds
    s_waitcnt lgkmcnt(0)
    s_waitcnt vmcnt(6)
    s_barrier
    v_mfma_f32_32x32x16_bf16 v[128:143], a[48:51], v[64:67], v[128:143]
    ds_read_b128 a[64:67], v18
    ds_read_b128 v[48:51], v28 offset:0
    ds_read_b128 v[52:55], v28 offset:1024
    v_mfma_f32_32x32x16_bf16 v[144:159], a[48:51], v[68:71], v[144:159]
    ds_read_b128 a[68:71], v18 offset:4096
    ds_read_b128 a[72:75], v19
    ds_read_b128 v[56:59], v28 offset:4096
    v_mfma_f32_32x32x16_bf16 v[160:175], a[52:55], v[64:67], v[160:175]
    ds_read_b128 v[60:63], v28 offset:5120
    ds_read_b128 a[76:79], v19 offset:4096
    v_mfma_f32_32x32x16_bf16 v[176:191], a[52:55], v[68:71], v[176:191]
    s_add_u32 m0, s52, 116736
    s_add_u32 s59, s67, 2048
    buffer_load_dwordx4 v42, s[28:31], s59 offen lds
    v_mfma_f32_32x32x16_bf16 v[128:143], a[56:59], v[72:75], v[128:143]
    s_add_u32 m0, s52, 117760
    s_add_u32 s59, s67, 3072
    buffer_load_dwordx4 v42, s[28:31], s59 offen lds
    v_mfma_f32_32x32x16_bf16 v[144:159], a[56:59], v[76:79], v[144:159]
    s_add_u32 s59, s66, 4
    s_and_b32 s59, s59, 7
    s_lshl_b32 s64, s59, 7
    s_add_u32 s64, s64, s53
    s_lshl_b32 s67, s59, 16
    s_add_u32 s67, s67, s63
    v_mfma_f32_32x32x16_bf16 v[160:175], a[60:63], v[72:75], v[160:175]
    s_add_u32 m0, s52, 0
    s_add_u32 s59, s64, 0
    buffer_load_dwordx4 v38, s[4:7], s59 offen lds
    v_mfma_f32_32x32x16_bf16 v[176:191], a[60:63], v[76:79], v[176:191]
    s_add_u32 m0, s52, 1024
    s_add_u32 s59, s64, 262144
    buffer_load_dwordx4 v39, s[4:7], s59 offen lds
    s_waitcnt lgkmcnt(0)
    v_mfma_f32_32x32x16_bf16 v[128:143], a[64:67], v[48:51], v[128:143]
    ds_read_b128 a[80:83], v20
    ds_read_b128 v[64:67], v28 offset:8192
    ds_read_b128 v[68:71], v28 offset:9216
    v_mfma_f32_32x32x16_bf16 v[144:159], a[64:67], v[52:55], v[144:159]
    ds_read_b128 a[84:87], v20 offset:4096
    ds_read_b128 a[88:91], v21
    ds_read_b128 v[72:75], v28 offset:12288
    v_mfma_f32_32x32x16_bf16 v[160:175], a[68:71], v[48:51], v[160:175]
    ds_read_b128 v[76:79], v28 offset:13312
    ds_read_b128 a[92:95], v21 offset:4096
    v_mfma_f32_32x32x16_bf16 v[176:191], a[68:71], v[52:55], v[176:191]
    s_add_u32 m0, s52, 2048
    s_add_u32 s59, s64, 524288
    buffer_load_dwordx4 v38, s[4:7], s59 offen lds
    v_mfma_f32_32x32x16_bf16 v[128:143], a[72:75], v[56:59], v[128:143]
    s_add_u32 m0, s52, 3072
    s_add_u32 s59, s64, 786432
    buffer_load_dwordx4 v39, s[4:7], s59 offen lds
    v_mfma_f32_32x32x16_bf16 v[144:159], a[72:75], v[60:63], v[144:159]
    s_add_u32 m0, s52, 16384
    s_add_u32 s59, s67, 0
    buffer_load_dwordx4 v42, s[28:31], s59 offen lds
    v_mfma_f32_32x32x16_bf16 v[160:175], a[76:79], v[56:59], v[160:175]
    s_add_u32 m0, s52, 17408
    s_add_u32 s59, s67, 1024
    buffer_load_dwordx4 v42, s[28:31], s59 offen lds
    v_mfma_f32_32x32x16_bf16 v[176:191], a[76:79], v[60:63], v[176:191]
    s_add_u32 m0, s52, 18432
    s_add_u32 s59, s67, 2048
    buffer_load_dwordx4 v42, s[28:31], s59 offen lds
    s_waitcnt lgkmcnt(0)
    v_readfirstlane_b32 s51, v46
    s_cmp_eq_u32 s2, 0
    s_cselect_b32 s51, s74, s51
    s_or_b32 s70, s51, s44
    s_cmp_eq_u32 s70, 0
    s_cbranch_scc1 L_nslow_36
L_nback_37:
    s_lshl_b32 s70, s44, 2
    s_add_u32 s70, s70, 149504
    v_mov_b32 v44, s70
    v_mov_b32 v45, s51
    ds_write_b32 v44, v45
    s_waitcnt lgkmcnt(0)
    s_waitcnt vmcnt(7)
    s_barrier
    v_mov_b32 v44, 149504
    ds_read_b32 v46, v44
    v_mfma_f32_32x32x16_bf16 v[128:143], a[80:83], v[64:67], v[128:143]
    ds_read_b128 a[96:99], v22
    ds_read_b128 v[48:51], v29 offset:0
    ds_read_b128 v[52:55], v29 offset:1024
    v_mfma_f32_32x32x16_bf16 v[144:159], a[80:83], v[68:71], v[144:159]
    ds_read_b128 a[100:103], v22 offset:4096
    ds_read_b128 a[104:107], v23
    ds_read_b128 v[56:59], v29 offset:4096
    v_mfma_f32_32x32x16_bf16 v[160:175], a[84:87], v[64:67], v[160:175]
    ds_read_b128 v[60:63], v29 offset:5120
    ds_read_b128 a[108:111], v23 offset:4096
    v_mfma_f32_32x32x16_bf16 v[176:191], a[84:87], v[68:71], v[176:191]
    s_add_u32 m0, s52, 19456
    s_add_u32 s59, s67, 3072
    buffer_load_dwordx4 v42, s[28:31], s59 offen lds
    v_mfma_f32_32x32x16_bf16 v[128:143], a[88:91], v[72:75], v[128:143]
    s_add_u32 s59, s66, 5
    s_and_b32 s59, s59, 7
    s_lshl_b32 s64, s59, 7
    s_add_u32 s64, s64, s53
    s_lshl_b32 s67, s59, 16
    s_add_u32 s67, s67, s63
    v_mfma_f32_32x32x16_bf16 v[144:159], a[88:91], v[76:79], v[144:159]
    s_add_u32 m0, s52, 32768
    s_add_u32 s59, s64, 0
    buffer_load_dwordx4 v38, s[4:7], s59 offen lds
    v_mfma_f32_32x32x16_bf16 v[160:175], a[92:95], v[72:75], v[160:175]
    s_add_u32 m0, s52, 33792
    s_add_u32 s59, s64, 262144
    buffer_load_dwordx4 v39, s[4:7], s59 offen lds
    v_mfma_f32_32x32x16_bf16 v[176:191], a[92:95], v[76:79], v[176:191]
    s_add_u32 m0, s52, 34816
    s_add_u32 s59, s64, 524288
    buffer_load_dwordx4 v38, s[4:7], s59 offen lds
    s_waitcnt lgkmcnt(0)
    v_mfma_f32_32x32x16_bf16 v[128:143], a[96:99], v[48:51], v[128:143]
    ds_read_b128 a[112:115], v24
    ds_read_b128 v[64:67], v29 offset:8192
    ds_read_b128 v[68:71], v29 offset:9216
    v_mfma_f32_32x32x16_bf16 v[144:159], a[96:99], v[52:55], v[144:159]
    ds_read_b128 a[116:119], v24 offset:4096
    ds_read_b128 a[120:123], v25
    ds_read_b128 v[72:75], v29 offset:12288
    v_mfma_f32_32x32x16_bf16 v[160:175], a[100:103], v[48:51], v[160:175]
    ds_read_b128 v[76:79], v29 offset:13312
    ds_read_b128 a[124:127], v25 offset:4096
    v_mfma_f32_32x32x16_bf16 v[176:191], a[100:103], v[52:55], v[176:191]
    s_add_u32 m0, s52, 35840
    s_add_u32 s59, s64, 786432
    buffer_load_dwordx4 v39, s[4:7], s59 offen lds
    v_mfma_f32_32x32x16_bf16 v[128:143], a[104:107], v[56:59], v[128:143]
    s_add_u32 m0, s52, 49152
    s_add_u32 s59, s67, 0
    buffer_load_dwordx4 v42, s[28:31], s59 offen lds
    v_mfma_f32_32x32x16_bf16 v[144:159], a[104:107], v[60:63], v[144:159]
    s_add_u32 m0, s52, 50176
    s_add_u32 s59, s67, 1024
    buffer_load_dwordx4 v42, s[28:31], s59 offen lds
    v_mfma_f32_32x32x16_bf16 v[160:175], a[108:111], v[56:59], v[160:175]
    s_add_u32 m0, s52, 51200
    s_add_u32 s59, s67, 2048
    buffer_load_dwordx4 v42, s[28:31], s59 offen lds
    v_mfma_f32_32x32x16_bf16 v[176:191], a[108:111], v[60:63], v[176:191]
    s_add_u32 m0, s52, 52224
    s_add_u32 s59, s67, 3072
    buffer_load_dwordx4 v42, s[28:31], s59 offen lds
    s_waitcnt lgkmcnt(0)
    s_waitcnt vmcnt(8)
    s_barrier
    v_mfma_f32_32x32x16_bf16 v[128:143], a[112:115], v[64:67], v[128:143]
    ds_read_b128 a[128:131], v10
    ds_read_b128 v[48:51], v26 offset:0
    ds_read_b128 v[52:55], v26 offset:1024
    s_add_u32 s59, s66, 6
    s_and_b32 s59, s59, 7
    s_lshl_b32 s64, s59, 7
    v_mfma_f32_32x32x16_bf16 v[144:159], a[112:115], v[68:71], v[144:159]
    ds_read_b128 a[132:135], v10 offset:4096
    ds_read_b128 a[136:139], v11
    ds_read_b128 v[56:59], v26 offset:4096
    s_add_u32 s64, s64, s53
    s_lshl_b32 s67, s59, 16
    s_add_u32 s67, s67, s63
    v_mfma_f32_32x32x16_bf16 v[160:175], a[116:119], v[64:67], v[160:175]
    ds_read_b128 v[60:63], v26 offset:5120
    ds_read_b128 a[140:143], v11 offset:4096
    v_mfma_f32_32x32x16_bf16 v[176:191], a[116:119], v[68:71], v[176:191]
    s_add_u32 m0, s52, 65536
    s_add_u32 s59, s64, 0
    buffer_load_dwordx4 v38, s[4:7], s59 offen lds
    v_mfma_f32_32x32x16_bf16 v[128:143], a[120:123], v[72:75], v[128:143]
    s_add_u32 m0, s52, 66560
    s_add_u32 s59, s64, 262144
    buffer_load_dwordx4 v39, s[4:7], s59 offen lds
    v_mfma_f32_32x32x16_bf16 v[144:159], a[120:123], v[76:79], v[144:159]
    s_add_u32 m0, s52, 67584
    s_add_u32 s59, s64, 524288
    buffer_load_dwordx4 v38, s[4:7], s59 offen lds
    v_mfma_f32_32x32x16_bf16 v[160:175], a[124:127], v[72:75], v[160:175]
    s_add_u32 m0, s52, 68608
    s_add_u32 s59, s64, 786432
    buffer_load_dwordx4 v39, s[4:7], s59 offen lds
    v_mfma_f32_32x32x16_bf16 v[176:191], a[124:127], v[76:79], v[176:191]
    s_add_u32 m0, s52, 81920
    s_add_u32 s59, s67, 0
    buffer_load_dwordx4 v42, s[28:31], s59 offen lds
    s_waitcnt lgkmcnt(0)
    v_mfma_f32_32x32x16_bf16 v[128:143], a[128:131], v[48:51], v[128:143]
    ds_read_b128 a[144:147], v12
    ds_read_b128 v[64:67], v26 offset:8192
    ds_read_b128 v[68:71], v26 offset:9216
    v_mfma_f32_32x32x16_bf16 v[144:159], a[128:131], v[52:55], v[144:159]
    ds_read_b128 a[148:151], v12 offset:4096
    ds_read_b128 a[152:155], v13
    ds_read_b128 v[72:75], v26 offset:12288
    v_mfma_f32_32x32x16_bf16 v[160:175], a[132:135], v[48:51], v[160:175]
    ds_read_b128 v[76:79], v26 offset:13312
    ds_read_b128 a[156:159], v13 offset:4096
    v_mfma_f32_32x32x16_bf16 v[176:191], a[132:135], v[52:55], v[176:191]
    s_add_u32 m0, s52, 82944
    s_add_u32 s59, s67, 1024
    buffer_load_dwordx4 v42, s[28:31], s59 offen lds
    v_mfma_f32_32x32x16_bf16 v[128:143], a[136:139], v[56:59], v[128:143]
    s_add_u32 m0, s52, 83968
    s_add_u32 s59, s67, 2048
    buffer_load_dwordx4 v42, s[28:31], s59 offen lds
    v_mfma_f32_32x32x16_bf16 v[144:159], a[136:139], v[60:63], v[144:159]
    s_add_u32 m0, s52, 84992
    s_add_u32 s59, s67, 3072
    buffer_load_dwordx4 v42, s[28:31], s59 offen lds
    v_mfma_f32_32x32x16_bf16 v[160:175], a[140:143], v[56:59], v[160:175]
    v_mfma_f32_32x32x16_bf16 v[176:191], a[140:143], v[60:63], v[176:191]
    s_waitcnt lgkmcnt(0)
    s_waitcnt vmcnt(8)
    s_barrier
    v_mfma_f32_32x32x16_bf16 v[128:143], a[144:147], v[64:67], v[128:143]
    ds_read_b128 a[160:163], v14
    ds_read_b128 v[48:51], v27 offset:0
    ds_read_b128 v[52:55], v27 offset:1024
    s_add_u32 s59, s66, 7
    s_and_b32 s59, s59, 7
    s_lshl_b32 s64, s59, 7
    v_mfma_f32_32x32x16_bf16 v[144:159], a[144:147], v[68:71], v[144:159]
    ds_read_b128 a[164:167], v14 offset:4096
    ds_read_b128 a[168:171], v15
    ds_read_b128 v[56:59], v27 offset:4096
    s_add_u32 s64, s64, s53
    s_lshl_b32 s67, s59, 16
    s_add_u32 s67, s67, s63
    v_mfma_f32_32x32x16_bf16 v[160:175], a[148:151], v[64:67], v[160:175]
    ds_read_b128 v[60:63], v27 offset:5120
    ds_read_b128 a[172:175], v15 offset:4096
    v_mfma_f32_32x32x16_bf16 v[176:191], a[148:151], v[68:71], v[176:191]
    s_add_u32 m0, s52, 98304
    s_add_u32 s59, s64, 0
    buffer_load_dwordx4 v38, s[4:7], s59 offen lds
    v_mfma_f32_32x32x16_bf16 v[128:143], a[152:155], v[72:75], v[128:143]
    s_add_u32 m0, s52, 99328
    s_add_u32 s59, s64, 262144
    buffer_load_dwordx4 v39, s[4:7], s59 offen lds
    v_mfma_f32_32x32x16_bf16 v[144:159], a[152:155], v[76:79], v[144:159]
    s_add_u32 m0, s52, 100352
    s_add_u32 s59, s64, 524288
    buffer_load_dwordx4 v38, s[4:7], s59 offen lds
    v_mfma_f32_32x32x16_bf16 v[160:175], a[156:159], v[72:75], v[160:175]
    s_add_u32 m0, s52, 101376
    s_add_u32 s59, s64, 786432
    buffer_load_dwordx4 v39, s[4:7], s59 offen lds
    v_mfma_f32_32x32x16_bf16 v[176:191], a[156:159], v[76:79], v[176:191]
    s_add_u32 m0, s52, 114688
    s_add_u32 s59, s67, 0
    buffer_load_dwordx4 v42, s[28:31], s59 offen lds
    s_waitcnt lgkmcnt(0)
    v_mfma_f32_32x32x16_bf16 v[128:143], a[160:163], v[48:51], v[128:143]
    ds_read_b128 a[176:179], v16
    ds_read_b128 v[64:67], v27 offset:8192
    ds_read_b128 v[68:71], v27 offset:9216
    v_mfma_f32_32x32x16_bf16 v[144:159], a[160:163], v[52:55], v[144:159]
    ds_read_b128 a[180:183], v16 offset:4096
    ds_read_b128 a[184:187], v17
    ds_read_b128 v[72:75], v27 offset:12288
    v_mfma_f32_32x32x16_bf16 v[160:175], a[164:167], v[48:51], v[160:175]
    ds_read_b128 v[76:79], v27 offset:13312
    ds_read_b128 a[188:191], v17 offset:4096
    v_mfma_f32_32x32x16_bf16 v[176:191], a[164:167], v[52:55], v[176:191]
    s_add_u32 m0, s52, 115712
    s_add_u32 s59, s67, 1024
    buffer_load_dwordx4 v42, s[28:31], s59 offen lds
    v_mfma_f32_32x32x16_bf16 v[128:143], a[168:171], v[56:59], v[128:143]
    s_add_u32 m0, s52, 116736
    s_add_u32 s59, s67, 2048
    buffer_load_dwordx4 v42, s[28:31], s59 offen lds
    v_mfma_f32_32x32x16_bf16 v[144:159], a[168:171], v[60:63], v[144:159]
    s_add_u32 m0, s52, 117760
    s_add_u32 s59, s67, 3072
    buffer_load_dwordx4 v42, s[28:31], s59 offen lds
    v_mfma_f32_32x32x16_bf16 v[160:175], a[172:175], v[56:59], v[160:175]
    v_mfma_f32_32x32x16_bf16 v[176:191], a[172:175], v[60:63], v[176:191]
    s_waitcnt lgkmcnt(0)
    s_waitcnt vmcnt(8)
    s_barrier
    v_mfma_f32_32x32x16_bf16 v[128:143], a[176:179], v[64:67], v[128:143]
    ds_read_b128 a[192:195], v18
    ds_read_b128 v[48:51], v28 offset:0
    ds_read_b128 v[52:55], v28 offset:1024
    s_add_u32 s59, s66, 0
    s_and_b32 s59, s59, 7
    s_mul_i32 s65, s59, 229376
    v_mfma_f32_32x32x16_bf16 v[144:159], a[176:179], v[68:71], v[144:159]
    ds_read_b128 a[196:199], v18 offset:4096
    ds_read_b128 a[200:203], v19
    ds_read_b128 v[56:59], v28 offset:4096
    s_add_u32 s65, s65, s54
    s_lshl_b32 s55, s45, 7
    s_lshl_b32 s56, s61, 6
    v_mfma_f32_32x32x16_bf16 v[160:175], a[180:183], v[64:67], v[160:175]
    ds_read_b128 v[60:63], v28 offset:5120
    ds_read_b128 a[204:207], v19 offset:4096
    s_add_u32 s55, s55, s56
    s_lshl_b32 s55, s55, 4
    s_add_u32 s69, s55, 0
    buffer_load_dwordx4 v[120:123], v42, s[20:23], s69 offen sc1
    v_mfma_f32_32x32x16_bf16 v[176:191], a[180:183], v[68:71], v[176:191]
    s_add_u32 m0, s68, 49152
    s_add_u32 s59, s65, 0
    buffer_load_dwordx4 v40, s[8:11], s59 offen lds
    v_mfma_f32_32x32x16_bf16 v[128:143], a[184:187], v[72:75], v[128:143]
    s_add_u32 m0, s68, 50176
    s_add_u32 s59, s65, 28672
    buffer_load_dwordx4 v40, s[8:11], s59 offen lds
    v_mfma_f32_32x32x16_bf16 v[144:159], a[184:187], v[76:79], v[144:159]
    s_add_u32 m0, s68, 57344
    s_add_u32 s59, s65, 0
    buffer_load_dwordx4 v41, s[12:15], s59 offen lds
    v_mfma_f32_32x32x16_bf16 v[160:175], a[188:191], v[72:75], v[160:175]
    s_add_u32 m0, s68, 58368
    s_add_u32 s59, s65, 28672
    buffer_load_dwordx4 v41, s[12:15], s59 offen lds
    v_mfma_f32_32x32x16_bf16 v[176:191], a[188:191], v[76:79], v[176:191]
    s_waitcnt lgkmcnt(0)
    v_mfma_f32_32x32x16_bf16 v[128:143], a[192:195], v[48:51], v[128:143]
    ds_read_b128 a[208:211], v20
    ds_read_b128 v[64:67], v28 offset:8192
    ds_read_b128 v[68:71], v28 offset:9216
    v_mfma_f32_32x32x16_bf16 v[144:159], a[192:195], v[52:55], v[144:159]
    ds_read_b128 a[212:215], v20 offset:4096
    ds_read_b128 a[216:219], v21
    ds_read_b128 v[72:75], v28 offset:12288
    v_mfma_f32_32x32x16_bf16 v[160:175], a[196:199], v[48:51], v[160:175]
    ds_read_b128 v[76:79], v28 offset:13312
    ds_read_b128 a[220:223], v21 offset:4096
    v_mfma_f32_32x32x16_bf16 v[176:191], a[196:199], v[52:55], v[176:191]
    v_mfma_f32_32x32x16_bf16 v[128:143], a[200:203], v[56:59], v[128:143]
    v_mfma_f32_32x32x16_bf16 v[144:159], a[200:203], v[60:63], v[144:159]
    v_mfma_f32_32x32x16_bf16 v[160:175], a[204:207], v[56:59], v[160:175]
    v_mfma_f32_32x32x16_bf16 v[176:191], a[204:207], v[60:63], v[176:191]
    s_waitcnt lgkmcnt(0)
    s_waitcnt vmcnt(5)
    s_barrier
    v_mfma_f32_32x32x16_bf16 v[128:143], a[208:211], v[64:67], v[128:143]
    ds_read_b128 a[224:227], v22
    ds_read_b128 v[48:51], v29 offset:0
    ds_read_b128 v[52:55], v29 offset:1024
    s_add_u32 s59, s66, 1
    s_and_b32 s59, s59, 7
    s_mul_i32 s65, s59, 229376
    v_mfma_f32_32x32x16_bf16 v[144:159], a[208:211], v[68:71], v[144:159]
    ds_read_b128 a[228:231], v22 offset:4096
    ds_read_b128 a[232:235], v23
    ds_read_b128 v[56:59], v29 offset:4096
    s_add_u32 s65, s65, s54
    v_mfma_f32_32x32x16_bf16 v[160:175], a[212:215], v[64:67], v[160:175]
    ds_read_b128 v[60:63], v29 offset:5120
    ds_read_b128 a[236:239], v23 offset:4096
    v_mfma_f32_32x32x16_bf16 v[176:191], a[212:215], v[68:71], v[176:191]
    s_add_u32 m0, s68, 65536
    s_add_u32 s59, s65, 0
    buffer_load_dwordx4 v40, s[8:11], s59 offen lds
    v_mfma_f32_32x32x16_bf16 v[128:143], a[216:219], v[72:75], v[128:143]
    s_add_u32 m0, s68, 66560
    s_add_u32 s59, s65, 28672
    buffer_load_dwordx4 v40, s[8:11], s59 offen lds
    v_mfma_f32_32x32x16_bf16 v[144:159], a[216:219], v[76:79], v[144:159]
    s_add_u32 m0, s68, 73728
    s_add_u32 s59, s65, 0
    buffer_load_dwordx4 v41, s[12:15], s59 offen lds
    v_mfma_f32_32x32x16_bf16 v[160:175], a[220:223], v[72:75], v[160:175]
    s_add_u32 m0, s68, 74752
    s_add_u32 s59, s65, 28672
    buffer_load_dwordx4 v41, s[12:15], s59 offen lds
    v_mfma_f32_32x32x16_bf16 v[176:191], a[220:223], v[76:79], v[176:191]
    s_add_u32 s59, s66, 2
    s_and_b32 s59, s59, 7
    s_mul_i32 s65, s59, 229376
    s_add_u32 s65, s65, s54
    s_add_u32 m0, s68, 81920
    s_add_u32 s59, s65, 0
    buffer_load_dwordx4 v40, s[8:11], s59 offen lds
    s_waitcnt lgkmcnt(0)
    v_mfma_f32_32x32x16_bf16 v[128:143], a[224:227], v[48:51], v[128:143]
    ds_read_b128 a[240:243], v24
    ds_read_b128 v[64:67], v29 offset:8192
    ds_read_b128 v[68:71], v29 offset:9216
    v_mfma_f32_32x32x16_bf16 v[144:159], a[224:227], v[52:55], v[144:159]
    ds_read_b128 a[244:247], v24 offset:4096
    ds_read_b128 a[248:251], v25
    ds_read_b128 v[72:75], v29 offset:12288
    v_mfma_f32_32x32x16_bf16 v[160:175], a[228:231], v[48:51], v[160:175]
    ds_read_b128 v[76:79], v29 offset:13312
    ds_read_b128 a[252:255], v25 offset:4096
    v_mfma_f32_32x32x16_bf16 v[176:191], a[228:231], v[52:55], v[176:191]
    s_add_u32 m0, s68, 82944
    s_add_u32 s59, s65, 28672
    buffer_load_dwordx4 v40, s[8:11], s59 offen lds
    v_mfma_f32_32x32x16_bf16 v[128:143], a[232:235], v[56:59], v[128:143]
    s_add_u32 m0, s68, 90112
    s_add_u32 s59, s65, 0
    buffer_load_dwordx4 v41, s[12:15], s59 offen lds
    v_mfma_f32_32x32x16_bf16 v[144:159], a[232:235], v[60:63], v[144:159]
    s_add_u32 m0, s68, 91136
    s_add_u32 s59, s65, 28672
    buffer_load_dwordx4 v41, s[12:15], s59 offen lds
    v_mfma_f32_32x32x16_bf16 v[160:175], a[236:239], v[56:59], v[160:175]
    v_mfma_f32_32x32x16_bf16 v[176:191], a[236:239], v[60:63], v[176:191]
    s_waitcnt lgkmcnt(0)
    s_waitcnt vmcnt(8)
    s_barrier
    v_mfma_f32_32x32x16_bf16 v[128:143], a[240:243], v[64:67], v[128:143]
    ds_read_b64_tr_b16 v[48:49], v30 offset:0
    ds_read_b64_tr_b16 v[50:51], v30 offset:512
    ds_read_b64_tr_b16 v[52:53], v31 offset:0
    s_add_u32 s59, s66, 3
    s_and_b32 s59, s59, 7
    s_mul_i32 s65, s59, 229376
    v_mfma_f32_32x32x16_bf16 v[144:159], a[240:243], v[68:71], v[144:159]
    ds_read_b64_tr_b16 v[54:55], v31 offset:512
    ds_read_b64_tr_b16 v[56:57], v30 offset:2048
    ds_read_b64_tr_b16 v[58:59], v30 offset:2560
    s_add_u32 s65, s65, s54
    v_mfma_f32_32x32x16_bf16 v[160:175], a[244:247], v[64:67], v[160:175]
    ds_read_b64_tr_b16 v[60:61], v31 offset:2048
    ds_read_b64_tr_b16 v[62:63], v31 offset:2560
    v_mfma_f32_32x32x16_bf16 v[176:191], a[244:247], v[68:71], v[176:191]
    s_add_u32 m0, s68, 98304
    s_add_u32 s59, s65, 0
    buffer_load_dwordx4 v40, s[8:11], s59 offen lds
    v_mfma_f32_32x32x16_bf16 v[128:143], a[248:251], v[72:75], v[128:143]
    s_add_u32 m0, s68, 99328
    s_add_u32 s59, s65, 28672
    buffer_load_dwordx4 v40, s[8:11], s59 offen lds
    v_mfma_f32_32x32x16_bf16 v[144:159], a[248:251], v[76:79], v[144:159]
    s_add_u32 m0, s68, 106496
    s_add_u32 s59, s65, 0
    buffer_load_dwordx4 v41, s[12:15], s59 offen lds
    v_mfma_f32_32x32x16_bf16 v[160:175], a[252:255], v[72:75], v[160:175]
    s_add_u32 m0, s68, 107520
    s_add_u32 s59, s65, 28672
    buffer_load_dwordx4 v41, s[12:15], s59 offen lds
    v_mfma_f32_32x32x16_bf16 v[176:191], a[252:255], v[76:79], v[176:191]
    s_add_u32 s59, s66, 4
    s_and_b32 s59, s59, 7
    s_mul_i32 s65, s59, 229376
    s_add_u32 s65, s65, s54
    s_add_u32 m0, s68, 114688
    s_add_u32 s59, s65, 0
    buffer_load_dwordx4 v40, s[8:11], s59 offen lds
    s_add_u32 m0, s68, 115712
    s_add_u32 s59, s65, 28672
    buffer_load_dwordx4 v40, s[8:11], s59 offen lds
    s_add_u32 m0, s68, 122880
    s_add_u32 s59, s65, 0
    buffer_load_dwordx4 v41, s[12:15], s59 offen lds
    s_add_u32 m0, s68, 123904
    s_add_u32 s59, s65, 28672
    buffer_load_dwordx4 v41, s[12:15], s59 offen lds
    v_cmp_ne_u32 vcc, v46, v123
    s_cbranch_vccnz L_rslow_39
L_rback_40:
    s_lshl_b32 s55, s44, 8
    s_add_u32 s55, s55, 148480
    v_lshlrev_b32 v8, 2, v1
    v_add_u32 v8, s55, v8
    v_mul_f32 v121, 0x36000000, v121
    ds_write_b32 v8, v121
    v_lshlrev_b32 v9, 4, v3
    v_add_u32 v9, s55, v9
    s_waitcnt lgkmcnt(0)
    ds_read_b128 v[112:115], v9 offset:0
    ds_read_b128 v[116:119], v9 offset:32
    ds_read_b128 v[120:123], v9 offset:64
    ds_read_b128 v[124:127], v9 offset:96
    s_waitcnt lgkmcnt(3)
    v_pk_mul_f32 v[128:129], v[128:129], v[112:113]
    v_pk_mul_f32 v[130:131], v[130:131], v[114:115]
    v_pk_mul_f32 v[144:145], v[144:145], v[112:113]
    v_pk_mul_f32 v[146:147], v[146:147], v[114:115]
    v_cvt_pk_bf16_f32 v192, v128, v129
    v_cvt_pk_bf16_f32 v193, v130, v131
    v_cvt_pk_bf16_f32 v208, v144, v145
    v_cvt_pk_bf16_f32 v209, v146, v147
    ds_read_b128 v[112:115], v9 offset:128
    s_waitcnt lgkmcnt(3)
    v_pk_mul_f32 v[132:133], v[132:133], v[116:117]
    v_pk_mul_f32 v[134:135], v[134:135], v[118:119]
    v_pk_mul_f32 v[148:149], v[148:149], v[116:117]
    v_pk_mul_f32 v[150:151], v[150:151], v[118:119]
    v_cvt_pk_bf16_f32 v194, v132, v133
    v_cvt_pk_bf16_f32 v195, v134, v135
    v_cvt_pk_bf16_f32 v210, v148, v149
    v_cvt_pk_bf16_f32 v211, v150, v151
    ds_read_b128 v[116:119], v9 offset:160
    s_waitcnt lgkmcnt(3)
    v_pk_mul_f32 v[136:137], v[136:137], v[120:121]
    v_pk_mul_f32 v[138:139], v[138:139], v[122:123]
    v_pk_mul_f32 v[152:153], v[152:153], v[120:121]
    v_pk_mul_f32 v[154:155], v[154:155], v[122:123]
    v_cvt_pk_bf16_f32 v196, v136, v137
    v_cvt_pk_bf16_f32 v197, v138, v139
    v_cvt_pk_bf16_f32 v212, v152, v153
    v_cvt_pk_bf16_f32 v213, v154, v155
    ds_read_b128 v[120:123], v9 offset:192
    s_waitcnt lgkmcnt(3)
    v_pk_mul_f32 v[140:141], v[140:141], v[124:125]
    v_pk_mul_f32 v[142:143], v[142:143], v[126:127]
    v_pk_mul_f32 v[156:157], v[156:157], v[124:125]
    v_pk_mul_f32 v[158:159], v[158:159], v[126:127]
    v_cvt_pk_bf16_f32 v198, v140, v141
    v_cvt_pk_bf16_f32 v199, v142, v143
    v_cvt_pk_bf16_f32 v214, v156, v157
    v_cvt_pk_bf16_f32 v215, v158, v159
    ds_read_b128 v[124:127], v9 offset:224
    s_waitcnt lgkmcnt(3)
    v_pk_mul_f32 v[160:161], v[160:161], v[112:113]
    v_pk_mul_f32 v[162:163], v[162:163], v[114:115]
    v_pk_mul_f32 v[176:177], v[176:177], v[112:113]
    v_pk_mul_f32 v[178:179], v[178:179], v[114:115]
    v_cvt_pk_bf16_f32 v200, v160, v161
    v_cvt_pk_bf16_f32 v201, v162, v163
    v_cvt_pk_bf16_f32 v216, v176, v177
    v_cvt_pk_bf16_f32 v217, v178, v179
    s_waitcnt lgkmcnt(2)
    v_pk_mul_f32 v[164:165], v[164:165], v[116:117]
    v_pk_mul_f32 v[166:167], v[166:167], v[118:119]
    v_pk_mul_f32 v[180:181], v[180:181], v[116:117]
    v_pk_mul_f32 v[182:183], v[182:183], v[118:119]
    v_cvt_pk_bf16_f32 v202, v164, v165
    v_cvt_pk_bf16_f32 v203, v166, v167
    v_cvt_pk_bf16_f32 v218, v180, v181
    v_cvt_pk_bf16_f32 v219, v182, v183
    s_waitcnt lgkmcnt(1)
    v_pk_mul_f32 v[168:169], v[168:169], v[120:121]
    v_pk_mul_f32 v[170:171], v[170:171], v[122:123]
    v_pk_mul_f32 v[184:185], v[184:185], v[120:121]
    v_pk_mul_f32 v[186:187], v[186:187], v[122:123]
    v_cvt_pk_bf16_f32 v204, v168, v169
    v_cvt_pk_bf16_f32 v205, v170, v171
    v_cvt_pk_bf16_f32 v220, v184, v185
    v_cvt_pk_bf16_f32 v221, v186, v187
    s_waitcnt lgkmcnt(0)
    v_pk_mul_f32 v[172:173], v[172:173], v[124:125]
    v_pk_mul_f32 v[174:175], v[174:175], v[126:127]
    v_pk_mul_f32 v[188:189], v[188:189], v[124:125]
    v_pk_mul_f32 v[190:191], v[190:191], v[126:127]
    v_cvt_pk_bf16_f32 v206, v172, v173
    v_cvt_pk_bf16_f32 v207, v174, v175
    v_cvt_pk_bf16_f32 v222, v188, v189
    v_cvt_pk_bf16_f32 v223, v190, v191
    s_lshl_b32 s55, s45, 1
    s_add_u32 s55, s55, s61
    s_lshl_b32 s55, s55, 3
    s_sub_u32 s56, s46, 12
    s_lshl_b32 s56, s56, 1
    s_add_u32 s56, s56, s60
    s_add_u32 s55, s55, s56
    s_lshl_b32 s55, s55, 8
    s_add_u32 s55, s55, 1048576
    v_lshlrev_b32 v8, 3, v2
    v_lshl_add_u32 v8, v3, 17, v8
    v_mfma_f32_32x32x16_bf16 v[128:143], v[80:83], v[192:195], 0
    v_mfma_f32_32x32x16_bf16 v[144:159], v[80:83], v[208:211], 0
    v_mfma_f32_32x32x16_bf16 v[128:143], v[84:87], v[196:199], v[128:143]
    v_mfma_f32_32x32x16_bf16 v[144:159], v[84:87], v[212:215], v[144:159]
    v_mfma_f32_32x32x16_bf16 v[128:143], v[88:91], v[200:203], v[128:143]
    v_mfma_f32_32x32x16_bf16 v[144:159], v[88:91], v[216:219], v[144:159]
    v_mfma_f32_32x32x16_bf16 v[128:143], v[92:95], v[204:207], v[128:143]
    v_mfma_f32_32x32x16_bf16 v[144:159], v[92:95], v[220:223], v[144:159]
    v_mfma_f32_32x32x16_bf16 v[160:175], v[96:99], v[192:195], 0
    v_mfma_f32_32x32x16_bf16 v[176:191], v[96:99], v[208:211], 0
    v_mfma_f32_32x32x16_bf16 v[160:175], v[100:103], v[196:199], v[160:175]
    s_nop 8
    v_cvt_pk_bf16_f32 v112, v128, v144
    v_cvt_pk_bf16_f32 v113, v129, v145
    s_add_u32 s56, s55, 0
    buffer_store_dwordx2 v[112:113], v8, s[20:23], s56 offen sc1
    v_cvt_pk_bf16_f32 v114, v130, v146
    v_cvt_pk_bf16_f32 v115, v131, v147
    v_mfma_f32_32x32x16_bf16 v[176:191], v[100:103], v[212:215], v[176:191]
    s_add_u32 s56, s55, 65536
    buffer_store_dwordx2 v[114:115], v8, s[20:23], s56 offen sc1
    v_cvt_pk_bf16_f32 v116, v132, v148
    v_cvt_pk_bf16_f32 v117, v133, v149
    s_add_u32 s56, s55, 262144
    buffer_store_dwordx2 v[116:117], v8, s[20:23], s56 offen sc1
    v_mfma_f32_32x32x16_bf16 v[160:175], v[104:107], v[200:203], v[160:175]
    v_cvt_pk_bf16_f32 v118, v134, v150
    v_cvt_pk_bf16_f32 v119, v135, v151
    s_add_u32 s56, s55, 327680
    buffer_store_dwordx2 v[118:119], v8, s[20:23], s56 offen sc1
    v_cvt_pk_bf16_f32 v120, v136, v152
    v_cvt_pk_bf16_f32 v121, v137, v153
    v_mfma_f32_32x32x16_bf16 v[176:191], v[104:107], v[216:219], v[176:191]
    s_add_u32 s56, s55, 524288
    buffer_store_dwordx2 v[120:121], v8, s[20:23], s56 offen sc1
    v_cvt_pk_bf16_f32 v122, v138, v154
    v_cvt_pk_bf16_f32 v123, v139, v155
    s_add_u32 s56, s55, 589824
    buffer_store_dwordx2 v[122:123], v8, s[20:23], s56 offen sc1
    v_mfma_f32_32x32x16_bf16 v[160:175], v[108:111], v[204:207], v[160:175]
    v_cvt_pk_bf16_f32 v124, v140, v156
    v_cvt_pk_bf16_f32 v125, v141, v157
    s_add_u32 s56, s55, 786432
    buffer_store_dwordx2 v[124:125], v8, s[20:23], s56 offen sc1
    v_cvt_pk_bf16_f32 v126, v142, v158
    v_cvt_pk_bf16_f32 v127, v143, v159
    v_mfma_f32_32x32x16_bf16 v[176:191], v[108:111], v[220:223], v[176:191]
    s_add_u32 s56, s55, 851968
    buffer_store_dwordx2 v[126:127], v8, s[20:23], s56 offen sc1
    s_nop 9
    v_cvt_pk_bf16_f32 v112, v160, v176
    v_cvt_pk_bf16_f32 v113, v161, v177
    s_add_u32 s56, s55, 1048576
    buffer_store_dwordx2 v[112:113], v8, s[20:23], s56 offen sc1
    v_cvt_pk_bf16_f32 v114, v162, v178
    v_cvt_pk_bf16_f32 v115, v163, v179
    s_add_u32 s56, s55, 1114112
    buffer_store_dwordx2 v[114:115], v8, s[20:23], s56 offen sc1
    v_cvt_pk_bf16_f32 v116, v164, v180
    v_cvt_pk_bf16_f32 v117, v165, v181
    s_add_u32 s56, s55, 1310720
    buffer_store_dwordx2 v[116:117], v8, s[20:23], s56 offen sc1
    v_cvt_pk_bf16_f32 v118, v166, v182
    v_cvt_pk_bf16_f32 v119, v167, v183
    s_add_u32 s56, s55, 1376256
    buffer_store_dwordx2 v[118:119], v8, s[20:23], s56 offen sc1
    v_cvt_pk_bf16_f32 v120, v168, v184
    v_cvt_pk_bf16_f32 v121, v169, v185
    s_add_u32 s56, s55, 1572864
    buffer_store_dwordx2 v[120:121], v8, s[20:23], s56 offen sc1
    v_cvt_pk_bf16_f32 v122, v170, v186
    v_cvt_pk_bf16_f32 v123, v171, v187
    s_add_u32 s56, s55, 1638400
    buffer_store_dwordx2 v[122:123], v8, s[20:23], s56 offen sc1
    v_cvt_pk_bf16_f32 v124, v172, v188
    v_cvt_pk_bf16_f32 v125, v173, v189
    s_add_u32 s56, s55, 1835008
    buffer_store_dwordx2 v[124:125], v8, s[20:23], s56 offen sc1
    v_cvt_pk_bf16_f32 v126, v174, v190
    v_cvt_pk_bf16_f32 v127, v175, v191
    s_add_u32 s56, s55, 1900544
    buffer_store_dwordx2 v[126:127], v8, s[20:23], s56 offen sc1
    s_waitcnt lgkmcnt(0)
    s_and_b32 s70, s45, 1
    s_cmp_eq_u32 s70, 0
    s_cbranch_scc0 L_mcs_42
    v_mov_b32 v80, 0x3f803f80
    v_mov_b32 v81, 0x3f803f80
    v_mov_b32 v82, 0x3f803f80
    v_mov_b32 v83, 0x3f803f80
    s_cmp_eq_u32 s61, 0
    s_cbranch_scc0 L_mcs1_43
    v_mfma_f32_32x32x16_bf16 v[96:111], v[80:83], v[48:51], 0
    v_mfma_f32_32x32x16_bf16 v[96:111], v[80:83], v[56:59], v[96:111]
    s_branch L_mcs2_44
L_mcs1_43:
    s_nop 8
    v_mfma_f32_32x32x16_bf16 v[96:111], v[80:83], v[52:55], 0
    v_mfma_f32_32x32x16_bf16 v[96:111], v[80:83], v[60:63], v[96:111]
L_mcs2_44:
    s_lshl_b32 s70, s60, 1
    s_add_u32 s70, s70, s61
    s_lshl_b32 s70, s70, 7
    v_lshlrev_b32 v44, 2, v2
    v_add_u32 v44, s70, v44
    v_and_b32 v45, 33, v1
    v_cmp_eq_u32 vcc, 0, v45
    v_mov_b32 v45, 2147483632
    s_nop 0
    v_cndmask_b32 v44, v45, v44, vcc
    s_lshl_b32 s70, s46, 14
    s_lshl_b32 s71, s45, 10
    s_add_u32 s70, s70, s71
    s_add_u32 s70, s70, 65536
    s_nop 7
    v_mov_b32_dpp v85, v96 quad_perm:[1,0,3,2] row_mask:0xf bank_mask:0xf
    v_cvt_pk_bf16_f32 v84, v96, v85
    v_mov_b32 v85, v46
    buffer_store_dwordx2 v[84:85], v44, s[20:23], s70 offen sc1
L_mcs_42:
    v_mfma_f32_32x32x16_bf16 v[192:207], v[48:51], a[0:3], 0
    ds_read_b64_tr_b16 v[64:65], v30 offset:4096
    ds_read_b64_tr_b16 v[66:67], v30 offset:4608
    ds_read_b64_tr_b16 v[68:69], v31 offset:4096
    v_mfma_f32_32x32x16_bf16 v[208:223], v[48:51], a[4:7], 0
    ds_read_b64_tr_b16 v[70:71], v31 offset:4608
    ds_read_b64_tr_b16 v[72:73], v30 offset:6144
    ds_read_b64_tr_b16 v[74:75], v30 offset:6656
    v_mfma_f32_32x32x16_bf16 v[224:239], v[52:55], a[0:3], 0
    ds_read_b64_tr_b16 v[76:77], v31 offset:6144
    ds_read_b64_tr_b16 v[78:79], v31 offset:6656
    v_mfma_f32_32x32x16_bf16 v[240:255], v[52:55], a[4:7], 0
    v_mfma_f32_32x32x16_bf16 v[192:207], v[56:59], a[8:11], v[192:207]
    v_mfma_f32_32x32x16_bf16 v[208:223], v[56:59], a[12:15], v[208:223]
    v_mfma_f32_32x32x16_bf16 v[224:239], v[60:63], a[8:11], v[224:239]
    v_mfma_f32_32x32x16_bf16 v[240:255], v[60:63], a[12:15], v[240:255]
    s_waitcnt lgkmcnt(0)
    s_waitcnt vmcnt(28)
    s_barrier
    s_and_b32 s70, s45, 1
    s_cmp_eq_u32 s70, 1
    s_cbranch_scc0 L_mcs_45
    v_mov_b32 v80, 0x3f803f80
    v_mov_b32 v81, 0x3f803f80
    v_mov_b32 v82, 0x3f803f80
    v_mov_b32 v83, 0x3f803f80
    s_cmp_eq_u32 s61, 0
    s_cbranch_scc0 L_mcs1_46
    v_mfma_f32_32x32x16_bf16 v[96:111], v[80:83], v[64:67], 0
    v_mfma_f32_32x32x16_bf16 v[96:111], v[80:83], v[72:75], v[96:111]
    s_branch L_mcs2_47
L_mcs1_46:
    s_nop 8
    v_mfma_f32_32x32x16_bf16 v[96:111], v[80:83], v[68:71], 0
    v_mfma_f32_32x32x16_bf16 v[96:111], v[80:83], v[76:79], v[96:111]
L_mcs2_47:
    s_lshl_b32 s70, s60, 1
    s_add_u32 s70, s70, s61
    s_lshl_b32 s70, s70, 7
    v_lshlrev_b32 v44, 2, v2
    v_add_u32 v44, s70, v44
    v_and_b32 v45, 33, v1
    v_cmp_eq_u32 vcc, 0, v45
    v_mov_b32 v45, 2147483632
    s_nop 0
    v_cndmask_b32 v44, v45, v44, vcc
    s_lshl_b32 s70, s46, 14
    s_lshl_b32 s71, s45, 10
    s_add_u32 s70, s70, s71
    s_add_u32 s70, s70, 65536
    s_nop 7
    v_mov_b32_dpp v85, v96 quad_perm:[1,0,3,2] row_mask:0xf bank_mask:0xf
    v_cvt_pk_bf16_f32 v84, v96, v85
    v_mov_b32 v85, v46
    buffer_store_dwordx2 v[84:85], v44, s[20:23], s70 offen sc1
L_mcs_45:
    v_mfma_f32_32x32x16_bf16 v[192:207], v[64:67], a[16:19], v[192:207]
    ds_read_b64_tr_b16 v[48:49], v30 offset:16384
    ds_read_b64_tr_b16 v[50:51], v30 offset:16896
    ds_read_b64_tr_b16 v[52:53], v31 offset:16384
    s_add_u32 s59, s66, 5
    s_and_b32 s59, s59, 7
    s_mul_i32 s65, s59, 229376
    v_mfma_f32_32x32x16_bf16 v[208:223], v[64:67], a[20:23], v[208:223]
    ds_read_b64_tr_b16 v[54:55], v31 offset:16896
    ds_read_b64_tr_b16 v[56:57], v30 offset:18432
    ds_read_b64_tr_b16 v[58:59], v30 offset:18944
    s_add_u32 s65, s65, s54
    v_mfma_f32_32x32x16_bf16 v[224:239], v[68:71], a[16:19], v[224:239]
    ds_read_b64_tr_b16 v[60:61], v31 offset:18432
    ds_read_b64_tr_b16 v[62:63], v31 offset:18944
    v_mfma_f32_32x32x16_bf16 v[240:255], v[68:71], a[20:23], v[240:255]
    s_add_u32 m0, s68, 49152
    s_add_u32 s59, s65, 0
    buffer_load_dwordx4 v40, s[8:11], s59 offen lds
    v_mfma_f32_32x32x16_bf16 v[192:207], v[72:75], a[24:27], v[192:207]
    s_add_u32 m0, s68, 50176
    s_add_u32 s59, s65, 28672
    buffer_load_dwordx4 v40, s[8:11], s59 offen lds
    v_mfma_f32_32x32x16_bf16 v[208:223], v[72:75], a[28:31], v[208:223]
    s_add_u32 m0, s68, 57344
    s_add_u32 s59, s65, 0
    buffer_load_dwordx4 v41, s[12:15], s59 offen lds
    v_mfma_f32_32x32x16_bf16 v[224:239], v[76:79], a[24:27], v[224:239]
    s_add_u32 m0, s68, 58368
    s_add_u32 s59, s65, 28672
    buffer_load_dwordx4 v41, s[12:15], s59 offen lds
    v_mfma_f32_32x32x16_bf16 v[240:255], v[76:79], a[28:31], v[240:255]
    s_waitcnt lgkmcnt(0)
    v_mfma_f32_32x32x16_bf16 v[192:207], v[48:51], a[32:35], v[192:207]
    ds_read_b64_tr_b16 v[64:65], v30 offset:20480
    ds_read_b64_tr_b16 v[66:67], v30 offset:20992
    ds_read_b64_tr_b16 v[68:69], v31 offset:20480
    v_mfma_f32_32x32x16_bf16 v[208:223], v[48:51], a[36:39], v[208:223]
    ds_read_b64_tr_b16 v[70:71], v31 offset:20992
    ds_read_b64_tr_b16 v[72:73], v30 offset:22528
    ds_read_b64_tr_b16 v[74:75], v30 offset:23040
    v_mfma_f32_32x32x16_bf16 v[224:239], v[52:55], a[32:35], v[224:239]
    ds_read_b64_tr_b16 v[76:77], v31 offset:22528
    ds_read_b64_tr_b16 v[78:79], v31 offset:23040
    v_mfma_f32_32x32x16_bf16 v[240:255], v[52:55], a[36:39], v[240:255]
    v_mfma_f32_32x32x16_bf16 v[192:207], v[56:59], a[40:43], v[192:207]
    v_mfma_f32_32x32x16_bf16 v[208:223], v[56:59], a[44:47], v[208:223]
    v_mfma_f32_32x32x16_bf16 v[224:239], v[60:63], a[40:43], v[224:239]
    v_mfma_f32_32x32x16_bf16 v[240:255], v[60:63], a[44:47], v[240:255]
    s_waitcnt lgkmcnt(0)
    s_waitcnt vmcnt(4)
    s_barrier
    s_sub_u32 s70, s46, 12
    s_lshl_b32 s70, s70, 10
    s_lshl_b32 s71, s45, 2
    s_add_u32 s70, s70, s71
    s_add_u32 s70, s70, 333824
    v_lshlrev_b32 v44, 7, v0
    v_add_u32 v44, s70, v44
    v_cmp_gt_u32 vcc, 8, v0
    v_mov_b32 v47, 2147483632
    s_nop 0
    v_cndmask_b32 v43, v47, v44, vcc
    buffer_store_dword v46, v43, s[20:23], 0 offen sc1
    v_mfma_f32_32x32x16_bf16 v[192:207], v[64:67], a[48:51], v[192:207]
    ds_read_b64_tr_b16 v[48:49], v30 offset:32768
    ds_read_b64_tr_b16 v[50:51], v30 offset:33280
    ds_read_b64_tr_b16 v[52:53], v31 offset:32768
    s_add_u32 s59, s66, 6
    s_and_b32 s59, s59, 7
    s_mul_i32 s65, s59, 229376
    v_mfma_f32_32x32x16_bf16 v[208:223], v[64:67], a[52:55], v[208:223]
    ds_read_b64_tr_b16 v[54:55], v31 offset:33280
    ds_read_b64_tr_b16 v[56:57], v30 offset:34816
    ds_read_b64_tr_b16 v[58:59], v30 offset:35328
    s_add_u32 s65, s65, s54
    s_lshl_b32 s55, s60, 4
    v_add_u32 v80, s55, v4
    v_mfma_f32_32x32x16_bf16 v[224:239], v[68:71], a[48:51], v[224:239]
    ds_read_b64_tr_b16 v[60:61], v31 offset:34816
    ds_read_b64_tr_b16 v[62:63], v31 offset:35328
    v_cvt_f32_u32 v80, v80
    v_mul_f32 v80, 0x3d000000, v80
    v_lshlrev_b32 v84, 2, v3
    v_cvt_f32_u32 v85, v84
    v_mfma_f32_32x32x16_bf16 v[240:255], v[68:71], a[52:55], v[240:255]
    s_add_u32 m0, s68, 65536
    s_add_u32 s59, s65, 0
    buffer_load_dwordx4 v40, s[8:11], s59 offen lds
    v_mul_f32 v82, v80, v85
    v_cmp_lt_u32 vcc, 15, v2
    v_mov_b32 v83, 0
    v_mfma_f32_32x32x16_bf16 v[192:207], v[72:75], a[56:59], v[192:207]
    s_add_u32 m0, s68, 66560
    s_add_u32 s59, s65, 28672
    buffer_load_dwordx4 v40, s[8:11], s59 offen lds
    v_mov_b32 v84, 0x3e800000
    v_cndmask_b32 v83, v83, v84, vcc
    v_add_f32 v82, v82, v83
    v_mfma_f32_32x32x16_bf16 v[208:223], v[72:75], a[60:63], v[208:223]
    s_add_u32 m0, s68, 73728
    s_add_u32 s59, s65, 0
    buffer_load_dwordx4 v41, s[12:15], s59 offen lds
    v_mov_b32 v86, v82
    v_fmamk_f32 v88, v80, 0x3f800000, v82
    v_cos_f32 v87, v86
    v_mfma_f32_32x32x16_bf16 v[224:239], v[76:79], a[56:59], v[224:239]
    s_add_u32 m0, s68, 74752
    s_add_u32 s59, s65, 28672
    buffer_load_dwordx4 v41, s[12:15], s59 offen lds
    v_sin_f32 v86, v86
    v_cos_f32 v89, v88
    v_sin_f32 v88, v88
    v_mfma_f32_32x32x16_bf16 v[240:255], v[76:79], a[60:63], v[240:255]
    v_cvt_pk_bf16_f32 v160, v87, v86
    v_cvt_pk_bf16_f32 v161, v89, v88
    v_fmamk_f32 v86, v80, 0x40000000, v82
    v_fmamk_f32 v88, v80, 0x40400000, v82
    v_cos_f32 v87, v86
    v_sin_f32 v86, v86
    s_waitcnt lgkmcnt(0)
    v_mfma_f32_32x32x16_bf16 v[192:207], v[48:51], a[64:67], v[192:207]
    ds_read_b64_tr_b16 v[64:65], v30 offset:36864
    ds_read_b64_tr_b16 v[66:67], v30 offset:37376
    ds_read_b64_tr_b16 v[68:69], v31 offset:36864
    v_cos_f32 v89, v88
    v_sin_f32 v88, v88
    v_cvt_pk_bf16_f32 v162, v87, v86
    v_mfma_f32_32x32x16_bf16 v[208:223], v[48:51], a[68:71], v[208:223]
    ds_read_b64_tr_b16 v[70:71], v31 offset:37376
    ds_read_b64_tr_b16 v[72:73], v30 offset:38912
    ds_read_b64_tr_b16 v[74:75], v30 offset:39424
    v_cvt_pk_bf16_f32 v163, v89, v88
    v_fmamk_f32 v86, v80, 0x41000000, v82
    v_fmamk_f32 v88, v80, 0x41100000, v82
    v_mfma_f32_32x32x16_bf16 v[224:239], v[52:55], a[64:67], v[224:239]
    ds_read_b64_tr_b16 v[76:77], v31 offset:38912
    ds_read_b64_tr_b16 v[78:79], v31 offset:39424
    v_cos_f32 v87, v86
    v_sin_f32 v86, v86
    v_cos_f32 v89, v88
    v_sin_f32 v88, v88
    v_mfma_f32_32x32x16_bf16 v[240:255], v[52:55], a[68:71], v[240:255]
    v_cvt_pk_bf16_f32 v164, v87, v86
    v_cvt_pk_bf16_f32 v165, v89, v88
    v_fmamk_f32 v86, v80, 0x41200000, v82
    v_fmamk_f32 v88, v80, 0x41300000, v82
    v_cos_f32 v87, v86
    v_sin_f32 v86, v86
    v_mfma_f32_32x32x16_bf16 v[192:207], v[56:59], a[72:75], v[192:207]
    v_cos_f32 v89, v88
    v_sin_f32 v88, v88
    v_cvt_pk_bf16_f32 v166, v87, v86
    v_cvt_pk_bf16_f32 v167, v89, v88
    v_fmamk_f32 v86, v80, 0x41800000, v82
    v_fmamk_f32 v88, v80, 0x41880000, v82
    v_mfma_f32_32x32x16_bf16 v[208:223], v[56:59], a[76:79], v[208:223]
    v_cos_f32 v87, v86
    v_sin_f32 v86, v86
    v_cos_f32 v89, v88
    v_sin_f32 v88, v88
    v_cvt_pk_bf16_f32 v168, v87, v86
    v_cvt_pk_bf16_f32 v169, v89, v88
    v_mfma_f32_32x32x16_bf16 v[224:239], v[60:63], a[72:75], v[224:239]
    v_fmamk_f32 v86, v80, 0x41900000, v82
    v_fmamk_f32 v88, v80, 0x41980000, v82
    v_cos_f32 v87, v86
    v_sin_f32 v86, v86
    v_cos_f32 v89, v88
    v_sin_f32 v88, v88
    v_mfma_f32_32x32x16_bf16 v[240:255], v[60:63], a[76:79], v[240:255]
    v_cvt_pk_bf16_f32 v170, v87, v86
    v_cvt_pk_bf16_f32 v171, v89, v88
    v_fmamk_f32 v86, v80, 0x41c00000, v82
    v_fmamk_f32 v88, v80, 0x41c80000, v82
    v_cos_f32 v87, v86
    v_sin_f32 v86, v86
    s_waitcnt lgkmcnt(0)
    s_barrier
    v_mfma_f32_32x32x16_bf16 v[192:207], v[64:67], a[80:83], v[192:207]
    ds_read_b64_tr_b16 v[48:49], v30 offset:49152
    ds_read_b64_tr_b16 v[50:51], v30 offset:49664
    ds_read_b64_tr_b16 v[52:53], v31 offset:49152
    s_add_u32 s59, s66, 7
    s_and_b32 s59, s59, 7
    s_mul_i32 s65, s59, 229376
    v_mfma_f32_32x32x16_bf16 v[208:223], v[64:67], a[84:87], v[208:223]
    ds_read_b64_tr_b16 v[54:55], v31 offset:49664
    ds_read_b64_tr_b16 v[56:57], v30 offset:51200
    ds_read_b64_tr_b16 v[58:59], v30 offset:51712
    s_add_u32 s65, s65, s54
    v_cos_f32 v89, v88
    v_sin_f32 v88, v88
    v_mfma_f32_32x32x16_bf16 v[224:239], v[68:71], a[80:83], v[224:239]
    ds_read_b64_tr_b16 v[60:61], v31 offset:51200
    ds_read_b64_tr_b16 v[62:63], v31 offset:51712
    v_cvt_pk_bf16_f32 v172, v87, v86
    v_cvt_pk_bf16_f32 v173, v89, v88
    v_fmamk_f32 v86, v80, 0x41d00000, v82
    v_fmamk_f32 v88, v80, 0x41d80000, v82
    v_mfma_f32_32x32x16_bf16 v[240:255], v[68:71], a[84:87], v[240:255]
    s_add_u32 m0, s68, 81920
    s_add_u32 s59, s65, 0
    buffer_load_dwordx4 v40, s[8:11], s59 offen lds
    v_cos_f32 v87, v86
    v_sin_f32 v86, v86
    v_cos_f32 v89, v88
    v_mfma_f32_32x32x16_bf16 v[192:207], v[72:75], a[88:91], v[192:207]
    s_add_u32 m0, s68, 82944
    s_add_u32 s59, s65, 28672
    buffer_load_dwordx4 v40, s[8:11], s59 offen lds
    v_sin_f32 v88, v88
    v_cvt_pk_bf16_f32 v174, v87, v86
    v_cvt_pk_bf16_f32 v175, v89, v88
    v_mfma_f32_32x32x16_bf16 v[208:223], v[72:75], a[92:95], v[208:223]
    s_add_u32 m0, s68, 90112
    s_add_u32 s59, s65, 0
    buffer_load_dwordx4 v41, s[12:15], s59 offen lds
    v_mfma_f32_32x32x16_bf16 v[224:239], v[76:79], a[88:91], v[224:239]
    s_add_u32 m0, s68, 91136
    s_add_u32 s59, s65, 28672
    buffer_load_dwordx4 v41, s[12:15], s59 offen lds
    v_mfma_f32_32x32x16_bf16 v[240:255], v[76:79], a[92:95], v[240:255]
    s_waitcnt lgkmcnt(0)
    v_mfma_f32_32x32x16_bf16 v[192:207], v[48:51], a[96:99], v[192:207]
    ds_read_b64_tr_b16 v[64:65], v30 offset:53248
    ds_read_b64_tr_b16 v[66:67], v30 offset:53760
    ds_read_b64_tr_b16 v[68:69], v31 offset:53248
    v_mfma_f32_32x32x16_bf16 v[208:223], v[48:51], a[100:103], v[208:223]
    ds_read_b64_tr_b16 v[70:71], v31 offset:53760
    ds_read_b64_tr_b16 v[72:73], v30 offset:55296
    ds_read_b64_tr_b16 v[74:75], v30 offset:55808
    v_mfma_f32_32x32x16_bf16 v[224:239], v[52:55], a[96:99], v[224:239]
    ds_read_b64_tr_b16 v[76:77], v31 offset:55296
    ds_read_b64_tr_b16 v[78:79], v31 offset:55808
    v_mfma_f32_32x32x16_bf16 v[240:255], v[52:55], a[100:103], v[240:255]
    v_mfma_f32_32x32x16_bf16 v[192:207], v[56:59], a[104:107], v[192:207]
    v_mfma_f32_32x32x16_bf16 v[208:223], v[56:59], a[108:111], v[208:223]
    v_mfma_f32_32x32x16_bf16 v[224:239], v[60:63], a[104:107], v[224:239]
    v_mfma_f32_32x32x16_bf16 v[240:255], v[60:63], a[108:111], v[240:255]
    s_waitcnt lgkmcnt(0)
    s_barrier
    s_mul_i32 s77, s44, 458752
    s_lshl_b32 s70, s50, 7
    s_add_u32 s77, s77, s70
    s_mul_i32 s78, s44, 12288
    s_lshl_b32 s74, s44, 13
    v_and_b32 v43, 1, v5
    v_lshlrev_b32 v43, 2, v43
    v_xor_b32 v43, v43, v6
    v_lshlrev_b32 v43, 4, v43
    v_lshl_add_u32 v37, v7, 10, v43
    s_mov_b32 s66, 0
    v_mfma_f32_32x32x16_bf16 v[192:207], v[64:67], a[112:115], v[192:207]
    ds_read_b64_tr_b16 v[48:49], v32 offset:0
    ds_read_b64_tr_b16 v[50:51], v32 offset:512
    ds_read_b64_tr_b16 v[52:53], v33 offset:0
    v_and_b32 v8, 31, v1
    v_lshlrev_b32 v126, 4, v8
    s_lshl_b32 s55, s46, 14
    v_mfma_f32_32x32x16_bf16 v[208:223], v[64:67], a[116:119], v[208:223]
    ds_read_b64_tr_b16 v[54:55], v33 offset:512
    ds_read_b64_tr_b16 v[56:57], v32 offset:2048
    ds_read_b64_tr_b16 v[58:59], v32 offset:2560
    s_add_u32 s55, s55, s52
    s_add_u32 s79, s55, 65536
    buffer_load_dwordx4 v[128:131], v126, s[20:23], s79 offen offset:0 sc1
    v_mfma_f32_32x32x16_bf16 v[224:239], v[68:71], a[112:115], v[224:239]
    ds_read_b64_tr_b16 v[60:61], v33 offset:2048
    ds_read_b64_tr_b16 v[62:63], v33 offset:2560
    buffer_load_dwordx4 v[132:135], v126, s[20:23], s79 offen offset:1024 sc1
    buffer_load_dwordx4 v[136:139], v126, s[20:23], s79 offen offset:2048 sc1
    buffer_load_dwordx4 v[140:143], v126, s[20:23], s79 offen offset:3072 sc1
    s_lshl_b32 s55, s45, 7
    v_mfma_f32_32x32x16_bf16 v[240:255], v[68:71], a[116:119], v[240:255]
    s_lshl_b32 s56, s61, 6
    s_add_u32 s55, s55, s56
    s_lshl_b32 s55, s55, 4
    s_add_u32 s75, s55, 0
    v_lshlrev_b32 v8, 4, v2
    buffer_load_dwordx4 v[112:115], v8, s[20:23], s75 offen sc1
    v_mfma_f32_32x32x16_bf16 v[192:207], v[72:75], a[120:123], v[192:207]
    buffer_load_dwordx4 v[116:119], v8, s[20:23], s75 offen offset:512 sc1
    s_mul_i32 s55, s2, 7168
    s_mul_i32 s56, s44, 1792
    s_add_u32 s55, s55, s56
    v_lshlrev_b32 v8, 7, v1
    v_cmp_gt_u32 vcc, 14, v1
    v_mfma_f32_32x32x16_bf16 v[208:223], v[72:75], a[124:127], v[208:223]
    v_mov_b32 v9, 2147483632
    v_cndmask_b32 v9, v9, v8, vcc
    s_lshl_b32 s56, s44, 8
    s_add_u32 m0, s56, 162816
    s_nop 0
    buffer_load_dword v9, s[16:19], s55 offen lds
    v_mfma_f32_32x32x16_bf16 v[224:239], v[76:79], a[120:123], v[224:239]
    v_mfma_f32_32x32x16_bf16 v[240:255], v[76:79], a[124:127], v[240:255]
    s_waitcnt lgkmcnt(0)
    v_mfma_f32_32x32x16_bf16 v[192:207], v[48:51], a[128:131], v[192:207]
    ds_read_b64_tr_b16 v[64:65], v32 offset:4096
    ds_read_b64_tr_b16 v[66:67], v32 offset:4608
    ds_read_b64_tr_b16 v[68:69], v33 offset:4096
    v_mfma_f32_32x32x16_bf16 v[208:223], v[48:51], a[132:135], v[208:223]
    ds_read_b64_tr_b16 v[70:71], v33 offset:4608
    ds_read_b64_tr_b16 v[72:73], v32 offset:6144
    ds_read_b64_tr_b16 v[74:75], v32 offset:6656
    v_mfma_f32_32x32x16_bf16 v[224:239], v[52:55], a[128:131], v[224:239]
    ds_read_b64_tr_b16 v[76:77], v33 offset:6144
    ds_read_b64_tr_b16 v[78:79], v33 offset:6656
    v_mfma_f32_32x32x16_bf16 v[240:255], v[52:55], a[132:135], v[240:255]
    v_mfma_f32_32x32x16_bf16 v[192:207], v[56:59], a[136:139], v[192:207]
    v_mfma_f32_32x32x16_bf16 v[208:223], v[56:59], a[140:143], v[208:223]
    v_mfma_f32_32x32x16_bf16 v[224:239], v[60:63], a[136:139], v[224:239]
    v_mfma_f32_32x32x16_bf16 v[240:255], v[60:63], a[140:143], v[240:255]
    s_waitcnt lgkmcnt(0)
    s_waitcnt vmcnt(16)
    s_barrier
    v_mfma_f32_32x32x16_bf16 v[192:207], v[64:67], a[144:147], v[192:207]
    ds_read_b64_tr_b16 v[48:49], v30 offset:0
    ds_read_b64_tr_b16 v[50:51], v30 offset:512
    ds_read_b64_tr_b16 v[52:53], v31 offset:0
    v_mfma_f32_32x32x16_bf16 v[208:223], v[64:67], a[148:151], v[208:223]
    ds_read_b64_tr_b16 v[54:55], v31 offset:512
    ds_read_b64_tr_b16 v[56:57], v30 offset:2048
    ds_read_b64_tr_b16 v[58:59], v30 offset:2560
    v_mfma_f32_32x32x16_bf16 v[224:239], v[68:71], a[144:147], v[224:239]
    ds_read_b64_tr_b16 v[60:61], v31 offset:2048
    ds_read_b64_tr_b16 v[62:63], v31 offset:2560
    v_mfma_f32_32x32x16_bf16 v[240:255], v[68:71], a[148:151], v[240:255]
    s_add_u32 s67, s66, 3
    s_cmp_ge_u32 s67, 14
    s_cselect_b32 s59, 14, 0
    s_sub_u32 s67, s67, s59
    s_lshl_b32 s67, s67, 15
    s_add_u32 s67, s77, s67
    v_mfma_f32_32x32x16_bf16 v[192:207], v[72:75], a[152:155], v[192:207]
    s_add_u32 m0, s78, 0
    s_add_u32 s59, s67, 0
    buffer_load_dwordx4 v37, s[16:19], s59 offen lds
    v_mfma_f32_32x32x16_bf16 v[208:223], v[72:75], a[156:159], v[208:223]
    s_add_u32 m0, s78, 1024
    s_add_u32 s59, s67, 8192
    buffer_load_dwordx4 v37, s[16:19], s59 offen lds
    v_mfma_f32_32x32x16_bf16 v[224:239], v[76:79], a[152:155], v[224:239]
    s_add_u32 m0, s78, 2048
    s_add_u32 s59, s67, 16384
    buffer_load_dwordx4 v37, s[16:19], s59 offen lds
    v_mfma_f32_32x32x16_bf16 v[240:255], v[76:79], a[156:159], v[240:255]
    s_add_u32 m0, s78, 3072
    s_add_u32 s59, s67, 24576
    buffer_load_dwordx4 v37, s[16:19], s59 offen lds
    s_waitcnt lgkmcnt(0)
    v_mfma_f32_32x32x16_bf16 v[192:207], v[48:51], a[160:163], v[192:207]
    ds_read_b64_tr_b16 v[64:65], v30 offset:4096
    ds_read_b64_tr_b16 v[66:67], v30 offset:4608
    ds_read_b64_tr_b16 v[68:69], v31 offset:4096
    v_mfma_f32_32x32x16_bf16 v[208:223], v[48:51], a[164:167], v[208:223]
    ds_read_b64_tr_b16 v[70:71], v31 offset:4608
    ds_read_b64_tr_b16 v[72:73], v30 offset:6144
    ds_read_b64_tr_b16 v[74:75], v30 offset:6656
    v_mfma_f32_32x32x16_bf16 v[224:239], v[52:55], a[160:163], v[224:239]
    ds_read_b64_tr_b16 v[76:77], v31 offset:6144
    ds_read_b64_tr_b16 v[78:79], v31 offset:6656
    v_mfma_f32_32x32x16_bf16 v[240:255], v[52:55], a[164:167], v[240:255]
    s_add_u32 s67, s66, 4
    s_cmp_ge_u32 s67, 14
    s_cselect_b32 s59, 14, 0
    s_sub_u32 s67, s67, s59
    s_lshl_b32 s67, s67, 15
    s_add_u32 s67, s77, s67
    v_mfma_f32_32x32x16_bf16 v[192:207], v[56:59], a[168:171], v[192:207]
    s_add_u32 m0, s78, 4096
    s_add_u32 s59, s67, 0
    buffer_load_dwordx4 v37, s[16:19], s59 offen lds
    v_mfma_f32_32x32x16_bf16 v[208:223], v[56:59], a[172:175], v[208:223]
    s_add_u32 m0, s78, 5120
    s_add_u32 s59, s67, 8192
    buffer_load_dwordx4 v37, s[16:19], s59 offen lds
    v_mfma_f32_32x32x16_bf16 v[224:239], v[60:63], a[168:171], v[224:239]
    s_add_u32 m0, s78, 6144
    s_add_u32 s59, s67, 16384
    buffer_load_dwordx4 v37, s[16:19], s59 offen lds
    v_mfma_f32_32x32x16_bf16 v[240:255], v[60:63], a[172:175], v[240:255]
    s_add_u32 m0, s78, 7168
    s_add_u32 s59, s67, 24576
    buffer_load_dwordx4 v37, s[16:19], s59 offen lds
    s_waitcnt lgkmcnt(0)
    s_waitcnt vmcnt(19)
    s_barrier
    v_mfma_f32_32x32x16_bf16 v[192:207], v[64:67], a[176:179], v[192:207]
    ds_read_b64_tr_b16 v[48:49], v30 offset:16384
    ds_read_b64_tr_b16 v[50:51], v30 offset:16896
    ds_read_b64_tr_b16 v[52:53], v31 offset:16384
    v_mfma_f32_32x32x16_bf16 v[208:223], v[64:67], a[180:183], v[208:223]
    ds_read_b64_tr_b16 v[54:55], v31 offset:16896
    ds_read_b64_tr_b16 v[56:57], v30 offset:18432
    ds_read_b64_tr_b16 v[58:59], v30 offset:18944
    v_mfma_f32_32x32x16_bf16 v[224:239], v[68:71], a[176:179], v[224:239]
    ds_read_b64_tr_b16 v[60:61], v31 offset:18432
    ds_read_b64_tr_b16 v[62:63], v31 offset:18944
    v_mfma_f32_32x32x16_bf16 v[240:255], v[68:71], a[180:183], v[240:255]
    s_add_u32 s67, s66, 5
    s_cmp_ge_u32 s67, 14
    s_cselect_b32 s59, 14, 0
    s_sub_u32 s67, s67, s59
    s_lshl_b32 s67, s67, 15
    s_add_u32 s67, s77, s67
    v_mfma_f32_32x32x16_bf16 v[192:207], v[72:75], a[184:187], v[192:207]
    s_add_u32 m0, s78, 8192
    s_add_u32 s59, s67, 0
    buffer_load_dwordx4 v37, s[16:19], s59 offen lds
    v_mfma_f32_32x32x16_bf16 v[208:223], v[72:75], a[188:191], v[208:223]
    s_add_u32 m0, s78, 9216
    s_add_u32 s59, s67, 8192
    buffer_load_dwordx4 v37, s[16:19], s59 offen lds
    v_mfma_f32_32x32x16_bf16 v[224:239], v[76:79], a[184:187], v[224:239]
    s_add_u32 m0, s78, 10240
    s_add_u32 s59, s67, 16384
    buffer_load_dwordx4 v37, s[16:19], s59 offen lds
    v_mfma_f32_32x32x16_bf16 v[240:255], v[76:79], a[188:191], v[240:255]
    s_add_u32 m0, s78, 11264
    s_add_u32 s59, s67, 24576
    buffer_load_dwordx4 v37, s[16:19], s59 offen lds
    s_waitcnt lgkmcnt(0)
    v_mfma_f32_32x32x16_bf16 v[192:207], v[48:51], a[192:195], v[192:207]
    ds_read_b64_tr_b16 v[64:65], v30 offset:20480
    ds_read_b64_tr_b16 v[66:67], v30 offset:20992
    ds_read_b64_tr_b16 v[68:69], v31 offset:20480
    v_mfma_f32_32x32x16_bf16 v[208:223], v[48:51], a[196:199], v[208:223]
    ds_read_b64_tr_b16 v[70:71], v31 offset:20992
    ds_read_b64_tr_b16 v[72:73], v30 offset:22528
    ds_read_b64_tr_b16 v[74:75], v30 offset:23040
    v_mfma_f32_32x32x16_bf16 v[224:239], v[52:55], a[192:195], v[224:239]
    ds_read_b64_tr_b16 v[76:77], v31 offset:22528
    ds_read_b64_tr_b16 v[78:79], v31 offset:23040
    v_mfma_f32_32x32x16_bf16 v[240:255], v[52:55], a[196:199], v[240:255]
    s_add_u32 s67, s66, 0
    s_cmp_ge_u32 s67, 14
    s_cselect_b32 s59, 14, 0
    s_sub_u32 s67, s67, s59
    s_lshl_b32 s67, s67, 15
    s_add_u32 s67, s77, s67
    v_mfma_f32_32x32x16_bf16 v[192:207], v[56:59], a[200:203], v[192:207]
    s_add_u32 m0, s78, 98304
    s_add_u32 s59, s67, 0
    buffer_load_dwordx4 v37, s[16:19], s59 offen lds
    v_mfma_f32_32x32x16_bf16 v[208:223], v[56:59], a[204:207], v[208:223]
    s_add_u32 m0, s78, 99328
    s_add_u32 s59, s67, 8192
    buffer_load_dwordx4 v37, s[16:19], s59 offen lds
    v_mfma_f32_32x32x16_bf16 v[224:239], v[60:63], a[200:203], v[224:239]
    s_add_u32 m0, s78, 100352
    s_add_u32 s59, s67, 16384
    buffer_load_dwordx4 v37, s[16:19], s59 offen lds
    v_mfma_f32_32x32x16_bf16 v[240:255], v[60:63], a[204:207], v[240:255]
    s_add_u32 m0, s78, 101376
    s_add_u32 s59, s67, 24576
    buffer_load_dwordx4 v37, s[16:19], s59 offen lds
    s_waitcnt lgkmcnt(0)
    s_waitcnt vmcnt(23)
    s_waitcnt vmcnt(19)
    v_xor_b32 v43, v46, v129
    v_xor_b32 v44, v46, v131
    v_or_b32 v43, v43, v44
    v_xor_b32 v44, v46, v133
    v_or_b32 v43, v43, v44
    v_xor_b32 v44, v46, v135
    v_or_b32 v43, v43, v44
    v_xor_b32 v44, v46, v137
    v_or_b32 v43, v43, v44
    v_xor_b32 v44, v46, v139
    v_or_b32 v43, v43, v44
    v_xor_b32 v44, v46, v141
    v_or_b32 v43, v43, v44
    v_xor_b32 v44, v46, v143
    v_or_b32 v43, v43, v44
    v_cmp_ne_u32 vcc, 0, v43
    s_cbranch_vccnz L_cslow_48
L_cback_49:
    v_and_b32 v129, 0xffff0000, v128
    v_lshlrev_b32 v128, 16, v128
    v_and_b32 v131, 0xffff0000, v130
    v_lshlrev_b32 v130, 16, v130
    v_and_b32 v133, 0xffff0000, v132
    v_lshlrev_b32 v132, 16, v132
    v_and_b32 v135, 0xffff0000, v134
    v_lshlrev_b32 v134, 16, v134
    v_and_b32 v137, 0xffff0000, v136
    v_lshlrev_b32 v136, 16, v136
    v_and_b32 v139, 0xffff0000, v138
    v_lshlrev_b32 v138, 16, v138
    v_and_b32 v141, 0xffff0000, v140
    v_lshlrev_b32 v140, 16, v140
    v_and_b32 v143, 0xffff0000, v142
    v_lshlrev_b32 v142, 16, v142
    v_add_f32 v128, v128, v136
    v_add_f32 v129, v129, v137
    v_add_f32 v130, v130, v138
    v_add_f32 v131, v131, v139
    v_add_f32 v132, v132, v140
    v_add_f32 v133, v133, v141
    v_add_f32 v134, v134, v142
    v_add_f32 v135, v135, v143
    v_add_f32 v128, v128, v132
    v_add_f32 v129, v129, v133
    v_add_f32 v130, v130, v134
    v_add_f32 v131, v131, v135
    s_lshl_b32 s70, s44, 10
    s_add_u32 s70, s70, 150528
    v_add_u32 v8, s70, v126
    ds_write_b128 v8, v[128:131]
    s_waitcnt lgkmcnt(0)
    s_barrier
    v_mfma_f32_32x32x16_bf16 v[192:207], v[64:67], a[208:211], v[192:207]
    ds_read_b64_tr_b16 v[48:49], v30 offset:32768
    ds_read_b64_tr_b16 v[50:51], v30 offset:33280
    ds_read_b64_tr_b16 v[52:53], v31 offset:32768
    v_and_b32 v8, 127, v0
    v_lshlrev_b32 v8, 2, v8
    v_add_u32 v9, 150528, v8
    v_mfma_f32_32x32x16_bf16 v[208:223], v[64:67], a[212:215], v[208:223]
    ds_read_b64_tr_b16 v[54:55], v31 offset:33280
    ds_read_b64_tr_b16 v[56:57], v30 offset:34816
    ds_read_b64_tr_b16 v[58:59], v30 offset:35328
    ds_read_b32 v122, v9 offset:0
    ds_read_b32 v123, v9 offset:1024
    ds_read_b32 v124, v9 offset:2048
    v_mfma_f32_32x32x16_bf16 v[224:239], v[68:71], a[208:211], v[224:239]
    ds_read_b64_tr_b16 v[60:61], v31 offset:34816
    ds_read_b64_tr_b16 v[62:63], v31 offset:35328
    ds_read_b32 v125, v9 offset:3072
    v_add_u32 v8, 147456, v8
    s_waitcnt lgkmcnt(0)
    v_add_f32 v122, v122, v123
    v_mfma_f32_32x32x16_bf16 v[240:255], v[68:71], a[212:215], v[240:255]
    s_add_u32 s67, s66, 1
    s_cmp_ge_u32 s67, 14
    s_cselect_b32 s59, 14, 0
    s_sub_u32 s67, s67, s59
    s_lshl_b32 s67, s67, 15
    s_add_u32 s67, s77, s67
    v_add_f32 v124, v124, v125
    v_add_f32 v124, v124, v122
    ds_write_b32 v8, v124
    s_sub_u32 s55, 64, s47
    v_mfma_f32_32x32x16_bf16 v[192:207], v[72:75], a[216:219], v[192:207]
    s_add_u32 m0, s78, 102400
    s_add_u32 s59, s67, 0
    buffer_load_dwordx4 v37, s[16:19], s59 offen lds
    s_cmp_eq_u32 s47, 0
    s_cselect_b32 s55, 32, s55
    v_mfma_f32_32x32x16_bf16 v[208:223], v[72:75], a[220:223], v[208:223]
    s_add_u32 m0, s78, 103424
    s_add_u32 s59, s67, 8192
    buffer_load_dwordx4 v37, s[16:19], s59 offen lds
    s_cmp_eq_u32 s61, 0
    s_cselect_b32 s76, s47, s55
    v_lshrrev_b32 v8, 2, v1
    v_mfma_f32_32x32x16_bf16 v[224:239], v[76:79], a[216:219], v[224:239]
    s_add_u32 m0, s78, 104448
    s_add_u32 s59, s67, 16384
    buffer_load_dwordx4 v37, s[16:19], s59 offen lds
    s_mov_b32 s55, 32896
    v_mul_lo_u32 v8, v8, s55
    v_and_b32 v9, 3, v1
    v_mfma_f32_32x32x16_bf16 v[240:255], v[76:79], a[220:223], v[240:255]
    s_add_u32 m0, s78, 105472
    s_add_u32 s59, s67, 24576
    buffer_load_dwordx4 v37, s[16:19], s59 offen lds
    v_lshl_add_u32 v8, v9, 4, v8
    s_lshl_b32 s55, s60, 10
    s_add_u32 s55, s55, s76
    s_waitcnt lgkmcnt(0)
    v_mfma_f32_32x32x16_bf16 v[192:207], v[48:51], a[224:227], v[192:207]
    ds_read_b64_tr_b16 v[64:65], v30 offset:36864
    ds_read_b64_tr_b16 v[66:67], v30 offset:37376
    ds_read_b64_tr_b16 v[68:69], v31 offset:36864
    s_mul_i32 s55, s55, 514
    s_lshl_b32 s56, s48, 6
    s_add_u32 s55, s55, s56
    v_mfma_f32_32x32x16_bf16 v[208:223], v[48:51], a[228:231], v[208:223]
    ds_read_b64_tr_b16 v[70:71], v31 offset:37376
    ds_read_b64_tr_b16 v[72:73], v30 offset:38912
    ds_read_b64_tr_b16 v[74:75], v30 offset:39424
    s_lshl_b32 s56, s44, 10
    s_add_u32 m0, s56, 154624
    s_nop 0
    buffer_load_dwordx4 v8, s[32:35], s55 offen lds
    v_mfma_f32_32x32x16_bf16 v[224:239], v[52:55], a[224:227], v[224:239]
    ds_read_b64_tr_b16 v[76:77], v31 offset:38912
    ds_read_b64_tr_b16 v[78:79], v31 offset:39424
    s_add_u32 m0, s56, 158720
    s_nop 0
    buffer_load_dwordx4 v8, s[36:39], s55 offen lds
    s_mov_b32 s56, 32896
    v_mul_lo_u32 v9, v4, s56
    v_mfma_f32_32x32x16_bf16 v[240:255], v[52:55], a[228:231], v[240:255]
    s_add_u32 s67, s66, 2
    s_cmp_ge_u32 s67, 14
    s_cselect_b32 s59, 14, 0
    s_sub_u32 s67, s67, s59
    s_lshl_b32 s67, s67, 15
    s_add_u32 s67, s77, s67
    v_add_u32 v9, 510, v9
    s_lshl_b32 s56, s48, 6
    s_sub_u32 s58, s55, s56
    v_mfma_f32_32x32x16_bf16 v[192:207], v[56:59], a[232:235], v[192:207]
    s_add_u32 m0, s78, 106496
    s_add_u32 s59, s67, 0
    buffer_load_dwordx4 v37, s[16:19], s59 offen lds
    s_cmp_eq_u32 s48, 0
    s_cselect_b32 s56, 16, 0
    v_cmp_gt_u32 vcc, s56, v1
    v_mfma_f32_32x32x16_bf16 v[208:223], v[56:59], a[236:239], v[208:223]
    s_add_u32 m0, s78, 107520
    s_add_u32 s59, s67, 8192
    buffer_load_dwordx4 v37, s[16:19], s59 offen lds
    v_mov_b32 v8, 2147483632
    v_cndmask_b32 v125, v8, v9, vcc
    s_lshl_b32 s56, s44, 9
    v_mfma_f32_32x32x16_bf16 v[224:239], v[60:63], a[232:235], v[224:239]
    s_add_u32 m0, s78, 108544
    s_add_u32 s59, s67, 16384
    buffer_load_dwordx4 v37, s[16:19], s59 offen lds
    s_add_u32 m0, s56, 148480
    s_nop 0
    buffer_load_dword v125, s[32:35], s58 offen lds
    v_mfma_f32_32x32x16_bf16 v[240:255], v[60:63], a[236:239], v[240:255]
    s_add_u32 m0, s78, 109568
    s_add_u32 s59, s67, 24576
    buffer_load_dwordx4 v37, s[16:19], s59 offen lds
    s_add_u32 m0, s56, 148736
    s_nop 0
    buffer_load_dword v125, s[36:39], s58 offen lds
    s_waitcnt lgkmcnt(0)
    s_barrier
    v_mfma_f32_32x32x16_bf16 v[192:207], v[64:67], a[240:243], v[192:207]
    v_mfma_f32_32x32x16_bf16 v[208:223], v[64:67], a[244:247], v[208:223]
    v_mfma_f32_32x32x16_bf16 v[224:239], v[68:71], a[240:243], v[224:239]
    v_mfma_f32_32x32x16_bf16 v[240:255], v[68:71], a[244:247], v[240:255]
    v_mfma_f32_32x32x16_bf16 v[192:207], v[72:75], a[248:251], v[192:207]
    v_mfma_f32_32x32x16_bf16 v[208:223], v[72:75], a[252:255], v[208:223]
    v_mfma_f32_32x32x16_bf16 v[224:239], v[76:79], a[248:251], v[224:239]
    v_mfma_f32_32x32x16_bf16 v[240:255], v[76:79], a[252:255], v[240:255]
    s_waitcnt lgkmcnt(0)
    s_barrier
    s_lshr_b32 s70, s48, 1
    s_lshl_b32 s70, s70, 10
    s_lshr_b32 s71, s2, 3
    s_and_b32 s71, s71, 7
    s_lshl_b32 s71, s71, 7
    s_add_u32 s70, s70, s71
    s_add_u32 s70, s70, 333824
    v_lshlrev_b32 v44, 2, v0
    v_add_u32 v44, s70, v44
    v_cmp_gt_u32 vcc, 16, v0
    v_mov_b32 v47, 2147483632
    s_nop 0
    v_cndmask_b32 v126, v47, v44, vcc
    buffer_load_dword v127, v126, s[20:23], 0 offen sc1
    v_lshrrev_b32 v8, 2, v4
    v_lshl_add_u32 v9, v3, 2, v8
    v_lshlrev_b32 v9, 7, v9
    v_lshrrev_b32 v8, 1, v8
    v_lshl_add_u32 v9, v8, 6, v9
    v_and_b32 v8, 1, v5
    v_lshl_add_u32 v9, v8, 5, v9
    v_and_b32 v8, 3, v4
    v_lshl_add_u32 v9, v8, 3, v9
    s_add_u32 s55, s78, 98304
    v_add_u32 v10, s55, v9
    v_xor_b32 v11, 64, v10
    s_add_u32 s55, s78, 0
    v_add_u32 v12, s55, v9
    v_xor_b32 v13, 64, v12
    s_add_u32 s55, s74, 49152
    v_add_u32 v38, s55, v9
    v_xor_b32 v39, 64, v38
    s_waitcnt vmcnt(30)
    v_xor_b32 v43, v46, v115
    v_xor_b32 v44, v46, v119
    v_or_b32 v43, v43, v44
    v_cmp_ne_u32 vcc, 0, v43
    s_cbranch_vccnz L_sslow_51
L_sback_52:
    s_mov_b32 s55, 0xbfb8aa3b
    v_sub_f32 v48, 0, v112
    v_mul_f32 v52, s55, v113
    v_mov_b32 v56, v114
    v_sub_f32 v50, 0, v116
    s_add_u32 s67, s66, 6
    s_cmp_ge_u32 s67, 14
    s_cselect_b32 s59, 14, 0
    s_sub_u32 s67, s67, s59
    s_lshl_b32 s67, s67, 15
    s_add_u32 s67, s77, s67
    v_mul_f32 v54, s55, v117
    v_mov_b32 v58, v118
    s_mul_i32 s56, s60, 256
    s_add_u32 s56, s56, 147456
    v_lshlrev_b32 v9, 4, v3
    v_add_u32 v9, s56, v9
    s_lshl_b32 s56, s45, 1
    s_add_u32 s56, s56, s61
    s_mul_i32 s56, s56, 229376
    s_lshr_b32 s57, s62, 4
    s_add_u32 m0, s74, 49152
    s_add_u32 s59, s67, 0
    buffer_load_dwordx4 v37, s[16:19], s59 offen lds
    s_mul_i32 s58, s60, 2
    s_add_u32 s57, s57, s58
    s_lshl_b32 s57, s57, 11
    s_add_u32 s56, s56, s57
    s_add_u32 s56, s56, 5242880
    ds_read_b128 v[60:63], v9 offset:0
    ds_read_b128 v[64:67], v9 offset:32
    ds_read_b128 v[68:71], v9 offset:64
    ds_read_b128 v[72:75], v9 offset:96
    ds_read_b128 v[96:99], v9 offset:128
    s_add_u32 m0, s74, 50176
    s_add_u32 s59, s67, 8192
    buffer_load_dwordx4 v37, s[16:19], s59 offen lds
    ds_read_b128 v[100:103], v9 offset:160
    ds_read_b128 v[104:107], v9 offset:192
    ds_read_b128 v[108:111], v9 offset:224
    s_waitcnt lgkmcnt(4)
    v_pk_fma_f32 v[76:77], v[60:61], v[48:49], v[192:193] op_sel_hi:[1,0,1]
    v_pk_fma_f32 v[78:79], v[62:63], v[48:49], v[194:195] op_sel_hi:[1,0,1]
    v_pk_fma_f32 v[80:81], v[64:65], v[48:49], v[196:197] op_sel_hi:[1,0,1]
    v_pk_fma_f32 v[82:83], v[66:67], v[48:49], v[198:199] op_sel_hi:[1,0,1]
    v_pk_mul_f32 v[192:193], v[76:77], v[52:53] op_sel_hi:[1,0]
    v_pk_mul_f32 v[194:195], v[78:79], v[52:53] op_sel_hi:[1,0]
    v_pk_mul_f32 v[196:197], v[80:81], v[52:53] op_sel_hi:[1,0]
    s_add_u32 m0, s74, 51200
    s_add_u32 s59, s67, 16384
    buffer_load_dwordx4 v37, s[16:19], s59 offen lds
    v_pk_mul_f32 v[198:199], v[82:83], v[52:53] op_sel_hi:[1,0]
    v_exp_f32 v192, v192
    v_exp_f32 v193, v193
    v_pk_fma_f32 v[84:85], v[68:69], v[48:49], v[200:201] op_sel_hi:[1,0,1]
    v_exp_f32 v194, v194
    v_exp_f32 v195, v195
    v_pk_fma_f32 v[86:87], v[70:71], v[48:49], v[202:203] op_sel_hi:[1,0,1]
    v_exp_f32 v196, v196
    v_exp_f32 v197, v197
    v_pk_fma_f32 v[88:89], v[72:73], v[48:49], v[204:205] op_sel_hi:[1,0,1]
    s_add_u32 m0, s74, 52224
    s_add_u32 s59, s67, 24576
    buffer_load_dwordx4 v37, s[16:19], s59 offen lds
    v_exp_f32 v198, v198
    v_exp_f32 v199, v199
    v_pk_fma_f32 v[90:91], v[74:75], v[48:49], v[206:207] op_sel_hi:[1,0,1]
    v_pk_fma_f32 v[192:193], v[192:193], v[56:57], v[56:57] op_sel_hi:[1,0,0]
    v_pk_fma_f32 v[194:195], v[194:195], v[56:57], v[56:57] op_sel_hi:[1,0,0]
    v_pk_fma_f32 v[196:197], v[196:197], v[56:57], v[56:57] op_sel_hi:[1,0,0]
    v_pk_fma_f32 v[198:199], v[198:199], v[56:57], v[56:57] op_sel_hi:[1,0,0]
    v_rcp_f32 v192, v192
    v_rcp_f32 v193, v193
    v_pk_mul_f32 v[76:77], v[76:77], v[84:85]
    s_add_u32 s67, s66, 7
    s_cmp_ge_u32 s67, 14
    s_cselect_b32 s59, 14, 0
    s_sub_u32 s67, s67, s59
    s_lshl_b32 s67, s67, 15
    s_add_u32 s67, s77, s67
    v_rcp_f32 v194, v194
    v_rcp_f32 v195, v195
    v_pk_mul_f32 v[78:79], v[78:79], v[86:87]
    v_rcp_f32 v196, v196
    v_rcp_f32 v197, v197
    v_pk_mul_f32 v[80:81], v[80:81], v[88:89]
    v_rcp_f32 v198, v198
    v_rcp_f32 v199, v199
    v_pk_mul_f32 v[82:83], v[82:83], v[90:91]
    v_pk_mul_f32 v[76:77], v[76:77], v[192:193]
    s_add_u32 m0, s74, 53248
    s_add_u32 s59, s67, 0
    buffer_load_dwordx4 v37, s[16:19], s59 offen lds
    v_pk_mul_f32 v[78:79], v[78:79], v[194:195]
    v_pk_mul_f32 v[80:81], v[80:81], v[196:197]
    v_pk_mul_f32 v[82:83], v[82:83], v[198:199]
    v_cvt_pk_bf16_f32 v92, v76, v77
    v_cvt_pk_bf16_f32 v93, v78, v79
    v_cvt_pk_bf16_f32 v94, v80, v81
    v_cvt_pk_bf16_f32 v95, v82, v83
    s_add_u32 s57, s56, 0
    buffer_store_dwordx4 v[92:95], v42, s[20:23], s57 offen sc1
    v_pk_fma_f32 v[76:77], v[60:61], v[50:51], v[208:209] op_sel_hi:[1,0,1]
    s_add_u32 m0, s74, 54272
    s_add_u32 s59, s67, 8192
    buffer_load_dwordx4 v37, s[16:19], s59 offen lds
    v_pk_fma_f32 v[78:79], v[62:63], v[50:51], v[210:211] op_sel_hi:[1,0,1]
    v_pk_fma_f32 v[80:81], v[64:65], v[50:51], v[212:213] op_sel_hi:[1,0,1]
    v_pk_fma_f32 v[82:83], v[66:67], v[50:51], v[214:215] op_sel_hi:[1,0,1]
    v_pk_mul_f32 v[208:209], v[76:77], v[54:55] op_sel_hi:[1,0]
    v_pk_mul_f32 v[210:211], v[78:79], v[54:55] op_sel_hi:[1,0]
    v_pk_mul_f32 v[212:213], v[80:81], v[54:55] op_sel_hi:[1,0]
    v_pk_mul_f32 v[214:215], v[82:83], v[54:55] op_sel_hi:[1,0]
    v_exp_f32 v208, v208
    v_exp_f32 v209, v209
    v_pk_fma_f32 v[84:85], v[68:69], v[50:51], v[216:217] op_sel_hi:[1,0,1]
    s_add_u32 m0, s74, 55296
    s_add_u32 s59, s67, 16384
    buffer_load_dwordx4 v37, s[16:19], s59 offen lds
    v_exp_f32 v210, v210
    v_exp_f32 v211, v211
    v_pk_fma_f32 v[86:87], v[70:71], v[50:51], v[218:219] op_sel_hi:[1,0,1]
    v_exp_f32 v212, v212
    v_exp_f32 v213, v213
    v_pk_fma_f32 v[88:89], v[72:73], v[50:51], v[220:221] op_sel_hi:[1,0,1]
    v_exp_f32 v214, v214
    v_exp_f32 v215, v215
    v_pk_fma_f32 v[90:91], v[74:75], v[50:51], v[222:223] op_sel_hi:[1,0,1]
    v_pk_fma_f32 v[208:209], v[208:209], v[58:59], v[58:59] op_sel_hi:[1,0,0]
    s_add_u32 m0, s74, 56320
    s_add_u32 s59, s67, 24576
    buffer_load_dwordx4 v37, s[16:19], s59 offen lds
    s_waitcnt vmcnt(11)
    v_pk_fma_f32 v[210:211], v[210:211], v[58:59], v[58:59] op_sel_hi:[1,0,0]
    v_pk_fma_f32 v[212:213], v[212:213], v[58:59], v[58:59] op_sel_hi:[1,0,0]
    v_pk_fma_f32 v[214:215], v[214:215], v[58:59], v[58:59] op_sel_hi:[1,0,0]
    v_rcp_f32 v208, v208
    v_rcp_f32 v209, v209
    v_pk_mul_f32 v[76:77], v[76:77], v[84:85]
    v_rcp_f32 v210, v210
    v_rcp_f32 v211, v211
    v_pk_mul_f32 v[78:79], v[78:79], v[86:87]
    v_rcp_f32 v212, v212
    ds_read_b64_tr_b16 a[0:1], v10 offset:0
    ds_read_b64_tr_b16 a[2:3], v10 offset:1024
    ds_read_b64_tr_b16 a[4:5], v11 offset:0
    ds_read_b64_tr_b16 a[6:7], v11 offset:1024
    v_rcp_f32 v213, v213
    v_pk_mul_f32 v[80:81], v[80:81], v[88:89]
    v_rcp_f32 v214, v214
    v_rcp_f32 v215, v215
    v_pk_mul_f32 v[82:83], v[82:83], v[90:91]
    v_pk_mul_f32 v[76:77], v[76:77], v[208:209]
    v_pk_mul_f32 v[78:79], v[78:79], v[210:211]
    v_pk_mul_f32 v[80:81], v[80:81], v[212:213]
    v_pk_mul_f32 v[82:83], v[82:83], v[214:215]
    v_cvt_pk_bf16_f32 v120, v76, v77
    ds_read_b64_tr_b16 a[8:9], v10 offset:2048
    ds_read_b64_tr_b16 a[10:11], v10 offset:3072
    ds_read_b64_tr_b16 a[12:13], v11 offset:2048
    ds_read_b64_tr_b16 a[14:15], v11 offset:3072
    v_cvt_pk_bf16_f32 v121, v78, v79
    v_cvt_pk_bf16_f32 v122, v80, v81
    v_cvt_pk_bf16_f32 v123, v82, v83
    s_add_u32 s57, s56, 1024
    buffer_store_dwordx4 v[120:123], v42, s[20:23], s57 offen sc1
    v_cmp_gt_u32 vcc, 16, v0
    v_mov_b32 v47, 0
    s_nop 0
    v_cndmask_b32 v43, v47, v46, vcc
    s_waitcnt vmcnt(10)
    v_cmp_ne_u32 vcc, v43, v127
    s_cbranch_vccnz L_slow_54
L_back_55:
    s_barrier
    ds_read_b64_tr_b16 a[16:17], v10 offset:4096
    ds_read_b64_tr_b16 a[18:19], v10 offset:5120
    ds_read_b64_tr_b16 a[20:21], v11 offset:4096
    ds_read_b64_tr_b16 a[22:23], v11 offset:5120
    s_lshl_b32 s70, s47, 5
    s_lshl_b32 s71, s44, 3
    s_add_u32 s70, s70, s71
    s_lshl_b32 s70, s70, 3
    s_add_u32 s70, s70, s48
    s_lshl_b32 s70, s70, 8
    s_add_u32 s70, s70, 1048576
    v_lshlrev_b32 v44, 3, v2
    v_lshl_add_u32 v44, v3, 13, v44
    buffer_load_dwordx2 v[14:15], v44, s[20:23], s70 offen offset:0 sc1
    ds_read_b64_tr_b16 a[24:25], v10 offset:6144
    ds_read_b64_tr_b16 a[26:27], v10 offset:7168
    ds_read_b64_tr_b16 a[28:29], v11 offset:6144
    ds_read_b64_tr_b16 a[30:31], v11 offset:7168
    buffer_load_dwordx2 v[16:17], v44, s[20:23], s70 offen offset:2048 sc1
    s_add_u32 s70, s70, 4096
    buffer_load_dwordx2 v[18:19], v44, s[20:23], s70 offen offset:0 sc1
    buffer_load_dwordx2 v[20:21], v44, s[20:23], s70 offen offset:2048 sc1
    s_waitcnt lgkmcnt(15)
    v_pk_fma_f32 v[76:77], v[96:97], v[48:49], v[224:225] op_sel_hi:[1,0,1]
    v_pk_fma_f32 v[78:79], v[98:99], v[48:49], v[226:227] op_sel_hi:[1,0,1]
    v_pk_fma_f32 v[80:81], v[100:101], v[48:49], v[228:229] op_sel_hi:[1,0,1]
    v_pk_fma_f32 v[82:83], v[102:103], v[48:49], v[230:231] op_sel_hi:[1,0,1]
    v_pk_mul_f32 v[224:225], v[76:77], v[52:53] op_sel_hi:[1,0]
    v_pk_mul_f32 v[226:227], v[78:79], v[52:53] op_sel_hi:[1,0]
    ds_read_b64_tr_b16 a[32:33], v10 offset:8192
    ds_read_b64_tr_b16 a[34:35], v10 offset:9216
    ds_read_b64_tr_b16 a[36:37], v11 offset:8192
    ds_read_b64_tr_b16 a[38:39], v11 offset:9216
    v_pk_mul_f32 v[228:229], v[80:81], v[52:53] op_sel_hi:[1,0]
    v_pk_mul_f32 v[230:231], v[82:83], v[52:53] op_sel_hi:[1,0]
    v_exp_f32 v224, v224
    v_exp_f32 v225, v225
    v_pk_fma_f32 v[84:85], v[104:105], v[48:49], v[232:233] op_sel_hi:[1,0,1]
    v_exp_f32 v226, v226
    v_exp_f32 v227, v227
    v_pk_fma_f32 v[86:87], v[106:107], v[48:49], v[234:235] op_sel_hi:[1,0,1]
    v_exp_f32 v228, v228
    v_exp_f32 v229, v229
    ds_read_b64_tr_b16 a[40:41], v10 offset:10240
    ds_read_b64_tr_b16 a[42:43], v10 offset:11264
    ds_read_b64_tr_b16 a[44:45], v11 offset:10240
    ds_read_b64_tr_b16 a[46:47], v11 offset:11264
    v_pk_fma_f32 v[88:89], v[108:109], v[48:49], v[236:237] op_sel_hi:[1,0,1]
    v_exp_f32 v230, v230
    v_exp_f32 v231, v231
    v_pk_fma_f32 v[90:91], v[110:111], v[48:49], v[238:239] op_sel_hi:[1,0,1]
    v_pk_fma_f32 v[224:225], v[224:225], v[56:57], v[56:57] op_sel_hi:[1,0,0]
    v_pk_fma_f32 v[226:227], v[226:227], v[56:57], v[56:57] op_sel_hi:[1,0,0]
    v_pk_fma_f32 v[228:229], v[228:229], v[56:57], v[56:57] op_sel_hi:[1,0,0]
    v_pk_fma_f32 v[230:231], v[230:231], v[56:57], v[56:57] op_sel_hi:[1,0,0]
    v_rcp_f32 v224, v224
    v_rcp_f32 v225, v225
    ds_read_b64_tr_b16 a[48:49], v12 offset:0
    ds_read_b64_tr_b16 a[50:51], v12 offset:1024
    ds_read_b64_tr_b16 a[52:53], v13 offset:0
    ds_read_b64_tr_b16 a[54:55], v13 offset:1024
    v_pk_mul_f32 v[76:77], v[76:77], v[84:85]
    v_rcp_f32 v226, v226
    v_rcp_f32 v227, v227
    v_pk_mul_f32 v[78:79], v[78:79], v[86:87]
    v_rcp_f32 v228, v228
    v_rcp_f32 v229, v229
    v_pk_mul_f32 v[80:81], v[80:81], v[88:89]
    v_rcp_f32 v230, v230
    v_rcp_f32 v231, v231
    v_pk_mul_f32 v[82:83], v[82:83], v[90:91]
    ds_read_b64_tr_b16 a[56:57], v12 offset:2048
    ds_read_b64_tr_b16 a[58:59], v12 offset:3072
    ds_read_b64_tr_b16 a[60:61], v13 offset:2048
    ds_read_b64_tr_b16 a[62:63], v13 offset:3072
    v_pk_mul_f32 v[76:77], v[76:77], v[224:225]
    v_pk_mul_f32 v[78:79], v[78:79], v[226:227]
    v_pk_mul_f32 v[80:81], v[80:81], v[228:229]
    v_pk_mul_f32 v[82:83], v[82:83], v[230:231]
    v_cvt_pk_bf16_f32 v92, v76, v77
    v_cvt_pk_bf16_f32 v93, v78, v79
    v_cvt_pk_bf16_f32 v94, v80, v81
    v_cvt_pk_bf16_f32 v95, v82, v83
    s_add_u32 s57, s56, 2048
    buffer_store_dwordx4 v[92:95], v42, s[20:23], s57 offen sc1
    ds_read_b64_tr_b16 a[64:65], v12 offset:4096
    ds_read_b64_tr_b16 a[66:67], v12 offset:5120
    ds_read_b64_tr_b16 a[68:69], v13 offset:4096
    ds_read_b64_tr_b16 a[70:71], v13 offset:5120
    v_pk_fma_f32 v[76:77], v[96:97], v[50:51], v[240:241] op_sel_hi:[1,0,1]
    v_pk_fma_f32 v[78:79], v[98:99], v[50:51], v[242:243] op_sel_hi:[1,0,1]
    v_pk_fma_f32 v[80:81], v[100:101], v[50:51], v[244:245] op_sel_hi:[1,0,1]
    v_pk_fma_f32 v[82:83], v[102:103], v[50:51], v[246:247] op_sel_hi:[1,0,1]
    v_pk_mul_f32 v[240:241], v[76:77], v[54:55] op_sel_hi:[1,0]
    v_pk_mul_f32 v[242:243], v[78:79], v[54:55] op_sel_hi:[1,0]
    v_pk_mul_f32 v[244:245], v[80:81], v[54:55] op_sel_hi:[1,0]
    v_pk_mul_f32 v[246:247], v[82:83], v[54:55] op_sel_hi:[1,0]
    v_exp_f32 v240, v240
    v_exp_f32 v241, v241
    ds_read_b64_tr_b16 a[72:73], v12 offset:6144
    ds_read_b64_tr_b16 a[74:75], v12 offset:7168
    ds_read_b64_tr_b16 a[76:77], v13 offset:6144
    ds_read_b64_tr_b16 a[78:79], v13 offset:7168
    v_pk_fma_f32 v[84:85], v[104:105], v[50:51], v[248:249] op_sel_hi:[1,0,1]
    v_exp_f32 v242, v242
    v_exp_f32 v243, v243
    v_pk_fma_f32 v[86:87], v[106:107], v[50:51], v[250:251] op_sel_hi:[1,0,1]
    v_exp_f32 v244, v244
    v_exp_f32 v245, v245
    v_pk_fma_f32 v[88:89], v[108:109], v[50:51], v[252:253] op_sel_hi:[1,0,1]
    v_exp_f32 v246, v246
    v_exp_f32 v247, v247
    v_pk_fma_f32 v[90:91], v[110:111], v[50:51], v[254:255] op_sel_hi:[1,0,1]
    ds_read_b64_tr_b16 a[96:97], v12 offset:8192
    ds_read_b64_tr_b16 a[98:99], v12 offset:9216
    ds_read_b64_tr_b16 a[100:101], v13 offset:8192
    ds_read_b64_tr_b16 a[102:103], v13 offset:9216
    v_pk_fma_f32 v[240:241], v[240:241], v[58:59], v[58:59] op_sel_hi:[1,0,0]
    v_pk_fma_f32 v[242:243], v[242:243], v[58:59], v[58:59] op_sel_hi:[1,0,0]
    v_pk_fma_f32 v[244:245], v[244:245], v[58:59], v[58:59] op_sel_hi:[1,0,0]
    v_pk_fma_f32 v[246:247], v[246:247], v[58:59], v[58:59] op_sel_hi:[1,0,0]
    v_rcp_f32 v240, v240
    v_rcp_f32 v241, v241
    v_pk_mul_f32 v[76:77], v[76:77], v[84:85]
    v_rcp_f32 v242, v242
    v_rcp_f32 v243, v243
    v_pk_mul_f32 v[78:79], v[78:79], v[86:87]
    ds_read_b64_tr_b16 a[104:105], v12 offset:10240
    ds_read_b64_tr_b16 a[106:107], v12 offset:11264
    ds_read_b64_tr_b16 a[108:109], v13 offset:10240
    ds_read_b64_tr_b16 a[110:111], v13 offset:11264
    s_waitcnt lgkmcnt(0)
    v_rcp_f32 v244, v244
    v_rcp_f32 v245, v245
    v_pk_mul_f32 v[80:81], v[80:81], v[88:89]
    v_rcp_f32 v246, v246
    v_rcp_f32 v247, v247
    v_pk_mul_f32 v[82:83], v[82:83], v[90:91]
    v_pk_mul_f32 v[76:77], v[76:77], v[240:241]
    v_pk_mul_f32 v[78:79], v[78:79], v[242:243]
    v_pk_mul_f32 v[80:81], v[80:81], v[244:245]
    v_pk_mul_f32 v[82:83], v[82:83], v[246:247]
    s_add_u32 s67, s66, 8
    s_cmp_ge_u32 s67, 14
    s_cselect_b32 s59, 14, 0
    s_sub_u32 s67, s67, s59
    s_lshl_b32 s67, s67, 15
    s_add_u32 s67, s77, s67
    v_cvt_pk_bf16_f32 v120, v76, v77
    v_cvt_pk_bf16_f32 v121, v78, v79
    v_cvt_pk_bf16_f32 v122, v80, v81
    v_cvt_pk_bf16_f32 v123, v82, v83
    s_add_u32 s57, s56, 3072
    buffer_store_dwordx4 v[120:123], v42, s[20:23], s57 offen sc1
    s_sub_u32 s55, 64, s47
    s_cmp_eq_u32 s47, 0
    s_cselect_b32 s55, 32, s55
    s_lshl_b32 s56, s44, 3
    v_lshl_add_u32 v9, v3, 2, s56
    v_cvt_f32_u32 v9, v9
    v_cvt_f32_u32 v112, s47
    v_mul_f32 v112, 0x3a000000, v112
    v_mul_f32 v113, v112, v9
    v_cos_f32 v176, v113
    v_sin_f32 v184, v113
    v_fmamk_f32 v8, v112, 0x3f800000, v113
    s_add_u32 m0, s78, 98304
    s_add_u32 s59, s67, 0
    buffer_load_dwordx4 v37, s[16:19], s59 offen lds
    v_cos_f32 v177, v8
    v_sin_f32 v185, v8
    v_fmamk_f32 v8, v112, 0x40000000, v113
    v_cos_f32 v178, v8
    v_sin_f32 v186, v8
    v_fmamk_f32 v8, v112, 0x40400000, v113
    v_cos_f32 v179, v8
    v_sin_f32 v187, v8
    v_cvt_f32_u32 v112, s55
    v_mul_f32 v112, 0x3a000000, v112
    v_mul_f32 v113, v112, v9
    v_cos_f32 v180, v113
    s_add_u32 m0, s78, 99328
    s_add_u32 s59, s67, 8192
    buffer_load_dwordx4 v37, s[16:19], s59 offen lds
    v_sin_f32 v188, v113
    v_fmamk_f32 v8, v112, 0x3f800000, v113
    v_cos_f32 v181, v8
    v_sin_f32 v189, v8
    v_fmamk_f32 v8, v112, 0x40000000, v113
    v_cos_f32 v182, v8
    v_sin_f32 v190, v8
    v_fmamk_f32 v8, v112, 0x40400000, v113
    v_cos_f32 v183, v8
    v_sin_f32 v191, v8
    s_lshl_b32 s56, s60, 4
    v_lshl_add_u32 v9, v3, 2, s56
    s_add_u32 m0, s78, 100352
    s_add_u32 s59, s67, 16384
    buffer_load_dwordx4 v37, s[16:19], s59 offen lds
    v_cvt_f32_u32 v9, v9
    v_cvt_f32_u32 v112, s76
    v_mul_f32 v112, 0x3a000000, v112
    v_mul_f32 v113, v112, v9
    v_cos_f32 v48, v113
    v_sin_f32 v56, v113
    v_fmamk_f32 v8, v112, 0x3f800000, v113
    v_cos_f32 v49, v8
    v_sin_f32 v57, v8
    v_fmamk_f32 v8, v112, 0x40000000, v113
    v_cos_f32 v50, v8
    v_sin_f32 v58, v8
    s_add_u32 m0, s78, 101376
    s_add_u32 s59, s67, 24576
    buffer_load_dwordx4 v37, s[16:19], s59 offen lds
    v_fmamk_f32 v8, v112, 0x40400000, v113
    v_cos_f32 v51, v8
    v_sin_f32 v59, v8
    v_fmamk_f32 v8, v112, 0x41000000, v113
    v_cos_f32 v52, v8
    v_sin_f32 v60, v8
    v_fmamk_f32 v8, v112, 0x41100000, v113
    v_cos_f32 v53, v8
    v_sin_f32 v61, v8
    v_fmamk_f32 v8, v112, 0x41200000, v113
    v_cos_f32 v54, v8
    v_sin_f32 v62, v8
    s_add_u32 s67, s66, 9
    s_cmp_ge_u32 s67, 14
    s_cselect_b32 s59, 14, 0
    s_sub_u32 s67, s67, s59
    s_lshl_b32 s67, s67, 15
    s_add_u32 s67, s77, s67
    v_fmamk_f32 v8, v112, 0x41300000, v113
    v_cos_f32 v55, v8
    v_sin_f32 v63, v8
    s_cmp_eq_u32 s48, 0
    s_cbranch_scc0 L_nyq_57
    s_lshl_b32 s55, s44, 10
    s_add_u32 s55, s55, 154624
    v_lshlrev_b32 v8, 6, v4
    v_add_u32 v8, s55, v8
    s_mov_b32 exec_lo, 0xffff
    s_mov_b32 exec_hi, 0
    s_lshl_b32 s55, s44, 9
    s_add_u32 s55, s55, 148480
    v_lshlrev_b32 v9, 2, v4
    v_add_u32 v9, s55, v9
    ds_read_b32 v112, v9
    ds_read_b32 v113, v9 offset:256
    s_waitcnt lgkmcnt(0)
    ds_write_b16_d16_hi v8, v112
    ds_write_b16_d16_hi v8, v113 offset:4096
    s_mov_b64 exec, -1
    s_waitcnt lgkmcnt(0)
L_nyq_57:
    s_lshl_b32 s55, s44, 10
    s_add_u32 m0, s78, 102400
    s_add_u32 s59, s67, 0
    buffer_load_dwordx4 v37, s[16:19], s59 offen lds
    s_add_u32 s55, s55, 154624
    v_lshlrev_b32 v8, 1, v2
    v_lshl_add_u32 v8, v3, 8, v8
    v_add_u32 v8, s55, v8
    v_mov_b32 v64, 0
    v_mov_b32 v65, 0
    v_mov_b32 v66, 0
    v_mov_b32 v67, 0
    v_mov_b32 v68, 0
    v_mov_b32 v69, 0
    v_mov_b32 v70, 0
    v_mov_b32 v71, 0
    s_add_u32 m0, s78, 103424
    s_add_u32 s59, s67, 8192
    buffer_load_dwordx4 v37, s[16:19], s59 offen lds
    v_mov_b32 v72, 0
    v_mov_b32 v73, 0
    v_mov_b32 v74, 0
    v_mov_b32 v75, 0
    v_mov_b32 v76, 0
    v_mov_b32 v77, 0
    v_mov_b32 v78, 0
    v_mov_b32 v79, 0
    ds_read_u16_d16_hi v64, v8 offset:0
    ds_read_u16_d16_hi v72, v8 offset:4096
    ds_read_u16_d16_hi v65, v8 offset:64
    ds_read_u16_d16_hi v73, v8 offset:4160
    s_add_u32 m0, s78, 104448
    s_add_u32 s59, s67, 16384
    buffer_load_dwordx4 v37, s[16:19], s59 offen lds
    ds_read_u16_d16_hi v66, v8 offset:128
    ds_read_u16_d16_hi v74, v8 offset:4224
    ds_read_u16_d16_hi v67, v8 offset:192
    ds_read_u16_d16_hi v75, v8 offset:4288
    ds_read_u16_d16_hi v68, v8 offset:512
    ds_read_u16_d16_hi v76, v8 offset:4608
    ds_read_u16_d16_hi v69, v8 offset:576
    ds_read_u16_d16_hi v77, v8 offset:4672
    ds_read_u16_d16_hi v70, v8 offset:640
    ds_read_u16_d16_hi v78, v8 offset:4736
    ds_read_u16_d16_hi v71, v8 offset:704
    ds_read_u16_d16_hi v79, v8 offset:4800
    s_add_u32 m0, s78, 105472
    s_add_u32 s59, s67, 24576
    buffer_load_dwordx4 v37, s[16:19], s59 offen lds
    s_waitcnt vmcnt(10)
    s_cmp_eq_u32 s47, 0
    s_cbranch_scc1 L_jz_58
    v_lshlrev_b32 v112, 16, v14
    v_and_b32 v113, 0xffff0000, v14
    v_lshlrev_b32 v114, 16, v15
    v_and_b32 v115, 0xffff0000, v15
    v_add_f32 v96, v112, v115
    v_sub_f32 v97, v113, v114
    v_sub_f32 v104, v112, v115
    v_add_f32 v105, v113, v114
    v_lshlrev_b32 v112, 16, v16
    v_and_b32 v113, 0xffff0000, v16
    v_lshlrev_b32 v114, 16, v17
    v_and_b32 v115, 0xffff0000, v17
    v_add_f32 v98, v112, v115
    v_sub_f32 v99, v113, v114
    v_sub_f32 v106, v112, v115
    v_add_f32 v107, v113, v114
    v_lshlrev_b32 v112, 16, v18
    v_and_b32 v113, 0xffff0000, v18
    v_lshlrev_b32 v114, 16, v19
    v_and_b32 v115, 0xffff0000, v19
    v_add_f32 v100, v112, v115
    v_sub_f32 v101, v113, v114
    v_sub_f32 v108, v112, v115
    v_add_f32 v109, v113, v114
    v_lshlrev_b32 v112, 16, v20
    v_and_b32 v113, 0xffff0000, v20
    v_lshlrev_b32 v114, 16, v21
    v_and_b32 v115, 0xffff0000, v21
    v_add_f32 v102, v112, v115
    v_sub_f32 v103, v113, v114
    v_sub_f32 v110, v112, v115
    v_add_f32 v111, v113, v114
    s_branch L_jd_59
L_jz_58:
    v_lshlrev_b32 v96, 16, v14
    v_and_b32 v97, 0xffff0000, v14
    v_lshlrev_b32 v104, 16, v15
    v_and_b32 v105, 0xffff0000, v15
    v_lshlrev_b32 v98, 16, v16
    v_and_b32 v99, 0xffff0000, v16
    v_lshlrev_b32 v106, 16, v17
    v_and_b32 v107, 0xffff0000, v17
    v_lshlrev_b32 v100, 16, v18
    v_and_b32 v101, 0xffff0000, v18
    v_lshlrev_b32 v108, 16, v19
    v_and_b32 v109, 0xffff0000, v19
    v_lshlrev_b32 v102, 16, v20
    v_and_b32 v103, 0xffff0000, v20
    v_lshlrev_b32 v110, 16, v21
    v_and_b32 v111, 0xffff0000, v21
L_jd_59:
    v_mul_f32 v112, v96, v176
    s_add_u32 s67, s66, 10
    s_cmp_ge_u32 s67, 14
    s_cselect_b32 s59, 14, 0
    s_sub_u32 s67, s67, s59
    s_lshl_b32 s67, s67, 15
    s_add_u32 s67, s77, s67
    v_mul_f32 v113, v97, v176
    v_fmac_f32 v112, v97, v184
    v_fma_f32 v113, -v96, v184, v113
    v_cvt_pk_bf16_f32 v80, v112, v113
    v_mul_f32 v112, v98, v177
    v_mul_f32 v113, v99, v177
    v_fmac_f32 v112, v99, v185
    v_fma_f32 v113, -v98, v185, v113
    v_cvt_pk_bf16_f32 v81, v112, v113
    v_mul_f32 v112, v100, v178
    v_mul_f32 v113, v101, v178
    v_fmac_f32 v112, v101, v186
    s_add_u32 m0, s78, 106496
    s_add_u32 s59, s67, 0
    buffer_load_dwordx4 v37, s[16:19], s59 offen lds
    v_fma_f32 v113, -v100, v186, v113
    v_cvt_pk_bf16_f32 v82, v112, v113
    v_mul_f32 v112, v102, v179
    v_mul_f32 v113, v103, v179
    v_fmac_f32 v112, v103, v187
    v_fma_f32 v113, -v102, v187, v113
    v_cvt_pk_bf16_f32 v83, v112, v113
    v_mul_f32 v112, v104, v180
    v_mul_f32 v113, v105, v180
    v_fmac_f32 v112, v105, v188
    v_fma_f32 v113, -v104, v188, v113
    v_cvt_pk_bf16_f32 v84, v112, v113
    s_add_u32 m0, s78, 107520
    s_add_u32 s59, s67, 8192
    buffer_load_dwordx4 v37, s[16:19], s59 offen lds
    v_mul_f32 v112, v106, v181
    v_mul_f32 v113, v107, v181
    v_fmac_f32 v112, v107, v189
    v_fma_f32 v113, -v106, v189, v113
    v_cvt_pk_bf16_f32 v85, v112, v113
    v_mul_f32 v112, v108, v182
    v_mul_f32 v113, v109, v182
    v_fmac_f32 v112, v109, v190
    v_fma_f32 v113, -v108, v190, v113
    v_cvt_pk_bf16_f32 v86, v112, v113
    v_mul_f32 v112, v110, v183
    v_mul_f32 v113, v111, v183
    s_add_u32 m0, s78, 108544
    s_add_u32 s59, s67, 16384
    buffer_load_dwordx4 v37, s[16:19], s59 offen lds
    v_fmac_f32 v112, v111, v191
    v_fma_f32 v113, -v110, v191, v113
    v_cvt_pk_bf16_f32 v87, v112, v113
    s_lshl_b32 s55, s44, 10
    s_add_u32 s55, s55, 81920
    v_add_u32 v8, s55, v42
    ds_write_b128 v8, v[80:83]
    ds_write_b128 v8, v[84:87] offset:4096
    s_waitcnt vmcnt(11)
    s_waitcnt lgkmcnt(0)
    s_barrier
    s_lshl_b32 s70, s45, 7
    s_lshl_b32 s71, s46, 2
    s_add_u32 m0, s78, 109568
    s_add_u32 s59, s67, 24576
    buffer_load_dwordx4 v37, s[16:19], s59 offen lds
    s_add_u32 s70, s70, s71
    s_add_u32 s70, s70, 331776
    v_mov_b32 v44, s70
    v_cmp_gt_u32 vcc, 1, v0
    v_mov_b32 v47, 2147483632
    s_nop 0
    v_cndmask_b32 v43, v47, v44, vcc
    buffer_store_dword v46, v43, s[20:23], 0 offen sc1
    s_lshl_b32 s55, s61, 12
    s_add_u32 s55, s55, 81920
    v_add_u32 v8, s55, v42
    ds_read_b128 v[96:99], v8 offset:0
    ds_read_b128 v[100:103], v8 offset:1024
    s_add_u32 s67, s66, 11
    s_cmp_ge_u32 s67, 14
    s_cselect_b32 s59, 14, 0
    s_sub_u32 s67, s67, s59
    s_lshl_b32 s67, s67, 15
    s_add_u32 s67, s77, s67
    ds_read_b128 v[104:107], v8 offset:2048
    ds_read_b128 v[108:111], v8 offset:3072
    s_waitcnt lgkmcnt(3)
    v_mfma_f32_32x32x16_bf16 v[128:143], v[160:163], v[96:99], 0
    s_waitcnt lgkmcnt(2)
    v_mfma_f32_32x32x16_bf16 v[128:143], v[164:167], v[100:103], v[128:143]
    s_waitcnt lgkmcnt(1)
    v_mfma_f32_32x32x16_bf16 v[128:143], v[168:171], v[104:107], v[128:143]
    s_waitcnt lgkmcnt(0)
    v_mfma_f32_32x32x16_bf16 v[128:143], v[172:175], v[108:111], v[128:143]
    s_nop 11
    v_mul_f32 v112, v128, v64
    v_mul_f32 v113, v128, v72
    v_fma_f32 v112, -v136, v72, v112
    v_fma_f32 v113, -v136, v64, -v113
    v_cvt_pk_bf16_f32 v80, v112, v113
    v_mul_f32 v112, v129, v65
    s_add_u32 m0, s78, 0
    s_add_u32 s59, s67, 0
    buffer_load_dwordx4 v37, s[16:19], s59 offen lds
    v_mul_f32 v113, v129, v73
    v_fma_f32 v112, -v137, v73, v112
    v_fma_f32 v113, -v137, v65, -v113
    v_cvt_pk_bf16_f32 v81, v112, v113
    v_mul_f32 v112, v130, v66
    v_mul_f32 v113, v130, v74
    v_fma_f32 v112, -v138, v74, v112
    v_fma_f32 v113, -v138, v66, -v113
    v_cvt_pk_bf16_f32 v82, v112, v113
    v_mul_f32 v112, v131, v67
    v_mul_f32 v113, v131, v75
    v_fma_f32 v112, -v139, v75, v112
    s_add_u32 m0, s78, 1024
    s_add_u32 s59, s67, 8192
    buffer_load_dwordx4 v37, s[16:19], s59 offen lds
    v_fma_f32 v113, -v139, v67, -v113
    v_cvt_pk_bf16_f32 v83, v112, v113
    v_mul_f32 v112, v132, v68
    v_mul_f32 v113, v132, v76
    v_fma_f32 v112, -v140, v76, v112
    v_fma_f32 v113, -v140, v68, -v113
    v_cvt_pk_bf16_f32 v84, v112, v113
    v_mul_f32 v112, v133, v69
    v_mul_f32 v113, v133, v77
    v_fma_f32 v112, -v141, v77, v112
    v_fma_f32 v113, -v141, v69, -v113
    v_cvt_pk_bf16_f32 v85, v112, v113
    s_add_u32 m0, s78, 2048
    s_add_u32 s59, s67, 16384
    buffer_load_dwordx4 v37, s[16:19], s59 offen lds
    v_mul_f32 v112, v134, v70
    v_mul_f32 v113, v134, v78
    v_fma_f32 v112, -v142, v78, v112
    v_fma_f32 v113, -v142, v70, -v113
    v_cvt_pk_bf16_f32 v86, v112, v113
    v_mul_f32 v112, v135, v71
    v_mul_f32 v113, v135, v79
    v_fma_f32 v112, -v143, v79, v112
    v_fma_f32 v113, -v143, v71, -v113
    v_cvt_pk_bf16_f32 v87, v112, v113
    s_lshl_b32 s55, s61, 12
    s_lshl_b32 s56, s60, 11
    s_add_u32 m0, s78, 3072
    s_add_u32 s59, s67, 24576
    buffer_load_dwordx4 v37, s[16:19], s59 offen lds
    s_add_u32 s57, s55, s56
    s_add_u32 s57, s57, 90112
    v_add_u32 v8, s57, v42
    s_xor_b32 s56, s56, 2048
    s_add_u32 s57, s55, s56
    s_add_u32 s57, s57, 90112
    v_add_u32 v9, s57, v42
    ds_write_b128 v8, v[80:83]
    ds_write_b128 v8, v[84:87] offset:1024
    s_waitcnt lgkmcnt(0)
    s_barrier
    ds_read_b128 v[88:91], v9
    s_add_u32 s67, s66, 12
    s_cmp_ge_u32 s67, 14
    s_cselect_b32 s59, 14, 0
    s_sub_u32 s67, s67, s59
    s_lshl_b32 s67, s67, 15
    s_add_u32 s67, s77, s67
    ds_read_b128 v[92:95], v9 offset:1024
    s_cmp_eq_u32 s60, 0
    s_cbranch_scc0 L_mb1_60
    v_mfma_f32_32x32x16_bf16 v[144:159], v[160:163], v[80:83], 0
    v_mfma_f32_32x32x16_bf16 v[144:159], v[164:167], v[84:87], v[144:159]
    s_waitcnt lgkmcnt(0)
    v_mfma_f32_32x32x16_bf16 v[144:159], v[168:171], v[88:91], v[144:159]
    v_mfma_f32_32x32x16_bf16 v[144:159], v[172:175], v[92:95], v[144:159]
    s_branch L_mbd_61
L_mb1_60:
    s_nop 8
    v_mfma_f32_32x32x16_bf16 v[144:159], v[168:171], v[80:83], 0
    v_mfma_f32_32x32x16_bf16 v[144:159], v[172:175], v[84:87], v[144:159]
    s_waitcnt lgkmcnt(0)
    v_mfma_f32_32x32x16_bf16 v[144:159], v[160:163], v[88:91], v[144:159]
    v_mfma_f32_32x32x16_bf16 v[144:159], v[164:167], v[92:95], v[144:159]
L_mbd_61:
    s_nop 7
    s_add_u32 m0, s78, 4096
    s_add_u32 s59, s67, 0
    buffer_load_dwordx4 v37, s[16:19], s59 offen lds
    s_nop 3
    s_lshl_b32 s55, s61, 13
    s_lshl_b32 s56, s60, 12
    s_add_u32 s55, s55, s56
    s_add_u32 s55, s55, 147456
    v_lshlrev_b32 v8, 3, v2
    v_lshl_add_u32 v8, v3, 10, v8
    v_add_u32 v8, s55, v8
    v_mul_f32 v96, v144, v48
    v_mul_f32 v97, v144, v56
    v_fmac_f32 v96, v152, v56
    v_fma_f32 v97, -v152, v48, v97
    s_add_u32 m0, s78, 5120
    s_add_u32 s59, s67, 8192
    buffer_load_dwordx4 v37, s[16:19], s59 offen lds
    ds_write_b64 v8, v[96:97] offset:0
    v_mul_f32 v98, v145, v49
    v_mul_f32 v99, v145, v57
    v_fmac_f32 v98, v153, v57
    v_fma_f32 v99, -v153, v49, v99
    ds_write_b64 v8, v[98:99] offset:256
    v_mul_f32 v100, v146, v50
    v_mul_f32 v101, v146, v58
    v_fmac_f32 v100, v154, v58
    v_fma_f32 v101, -v154, v50, v101
    ds_write_b64 v8, v[100:101] offset:512
    v_mul_f32 v102, v147, v51
    s_add_u32 m0, s78, 6144
    s_add_u32 s59, s67, 16384
    buffer_load_dwordx4 v37, s[16:19], s59 offen lds
    v_mul_f32 v103, v147, v59
    v_fmac_f32 v102, v155, v59
    v_fma_f32 v103, -v155, v51, v103
    ds_write_b64 v8, v[102:103] offset:768
    v_mul_f32 v104, v148, v52
    v_mul_f32 v105, v148, v60
    v_fmac_f32 v104, v156, v60
    v_fma_f32 v105, -v156, v52, v105
    ds_write_b64 v8, v[104:105] offset:2048
    v_mul_f32 v106, v149, v53
    v_mul_f32 v107, v149, v61
    v_fmac_f32 v106, v157, v61
    s_add_u32 m0, s78, 7168
    s_add_u32 s59, s67, 24576
    buffer_load_dwordx4 v37, s[16:19], s59 offen lds
    v_fma_f32 v107, -v157, v53, v107
    ds_write_b64 v8, v[106:107] offset:2304
    v_mul_f32 v108, v150, v54
    v_mul_f32 v109, v150, v62
    v_fmac_f32 v108, v158, v62
    v_fma_f32 v109, -v158, v54, v109
    ds_write_b64 v8, v[108:109] offset:2560
    v_mul_f32 v110, v151, v55
    v_mul_f32 v111, v151, v63
    v_fmac_f32 v110, v159, v63
    v_fma_f32 v111, -v159, v55, v111
    ds_write_b64 v8, v[110:111] offset:2816
    s_add_u32 s67, s66, 13
    s_cmp_ge_u32 s67, 14
    s_cselect_b32 s59, 14, 0
    s_sub_u32 s67, s67, s59
    s_lshl_b32 s67, s67, 15
    s_add_u32 s67, s77, s67
    s_waitcnt lgkmcnt(0)
    s_barrier
    s_lshr_b32 s70, s49, 1
    s_lshl_b32 s70, s70, 7
    s_add_u32 s70, s70, 331776
    v_lshlrev_b32 v44, 2, v0
    v_add_u32 v44, s70, v44
    v_cmp_gt_u32 vcc, 16, v0
    v_mov_b32 v47, 2147483632
    s_nop 0
    v_cndmask_b32 v126, v47, v44, vcc
    buffer_load_dword v127, v126, s[20:23], 0 offen sc1
    v_lshrrev_b32 v8, 3, v0
    s_add_u32 m0, s78, 8192
    s_add_u32 s59, s67, 0
    buffer_load_dwordx4 v37, s[16:19], s59 offen lds
    v_and_b32 v9, 7, v0
    v_lshlrev_b32 v112, 8, v8
    v_lshl_add_u32 v112, v9, 5, v112
    v_add_u32 v112, 147456, v112
    ds_read_b128 v[96:99], v112
    ds_read_b128 v[100:103], v112 offset:16
    ds_read_b128 v[104:107], v112 offset:8192
    ds_read_b128 v[108:111], v112 offset:8208
    v_lshlrev_b32 v8, 16, v8
    v_lshl_add_u32 v8, v9, 4, v8
    s_lshl_b32 s55, s47, 11
    s_lshl_b32 s56, s48, 7
    s_add_u32 m0, s78, 9216
    s_add_u32 s59, s67, 8192
    buffer_load_dwordx4 v37, s[16:19], s59 offen lds
    s_add_u32 s55, s55, s56
    s_add_u32 s55, s55, 3145728
    s_waitcnt lgkmcnt(0)
    s_cmp_eq_u32 s47, 0
    s_cbranch_scc1 L_jz2_62
    v_add_f32 v112, v96, v104
    v_add_f32 v113, v97, v105
    v_sub_f32 v114, v105, v97
    v_sub_f32 v115, v96, v104
    v_cvt_pk_bf16_f32 v80, v112, v113
    v_cvt_pk_bf16_f32 v84, v114, v115
    v_add_f32 v112, v98, v106
    v_add_f32 v113, v99, v107
    v_sub_f32 v114, v107, v99
    v_sub_f32 v115, v98, v106
    v_cvt_pk_bf16_f32 v81, v112, v113
    v_cvt_pk_bf16_f32 v85, v114, v115
    v_add_f32 v112, v100, v108
    v_add_f32 v113, v101, v109
    v_sub_f32 v114, v109, v101
    v_sub_f32 v115, v100, v108
    v_cvt_pk_bf16_f32 v82, v112, v113
    v_cvt_pk_bf16_f32 v86, v114, v115
    v_add_f32 v112, v102, v110
    v_add_f32 v113, v103, v111
    v_sub_f32 v114, v111, v103
    v_sub_f32 v115, v102, v110
    v_cvt_pk_bf16_f32 v83, v112, v113
    v_cvt_pk_bf16_f32 v87, v114, v115
    s_branch L_jd2_63
L_jz2_62:
    v_cvt_pk_bf16_f32 v80, v96, v97
    v_cvt_pk_bf16_f32 v84, v104, v105
    v_cvt_pk_bf16_f32 v81, v98, v99
    v_cvt_pk_bf16_f32 v85, v106, v107
    v_cvt_pk_bf16_f32 v82, v100, v101
    v_cvt_pk_bf16_f32 v86, v108, v109
    v_cvt_pk_bf16_f32 v83, v102, v103
    v_cvt_pk_bf16_f32 v87, v110, v111
L_jd2_63:
    buffer_store_dwordx4 v[80:83], v8, s[20:23], s55 offen sc1
    s_add_u32 m0, s78, 10240
    s_add_u32 s59, s67, 16384
    buffer_load_dwordx4 v37, s[16:19], s59 offen lds
    buffer_store_dwordx4 v[84:87], v8, s[20:23], s55 offen offset:1024 sc1
    v_lshrrev_b32 v8, 3, v0
    v_and_b32 v9, 7, v0
    v_lshlrev_b32 v33, 15, v8
    v_lshl_add_u32 v33, v9, 4, v33
    s_lshl_b32 s55, s49, 10
    s_lshl_b32 s56, s50, 7
    s_add_u32 s69, s55, s56
    s_mul_i32 s79, s49, 229376
    s_mul_i32 s55, s44, 57344
    s_add_u32 s79, s79, s55
    s_add_u32 s79, s79, 5242880
    v_lshlrev_b32 v9, 10, v5
    v_add_u32 v8, 0, v5
    v_xor_b32 v8, v8, v4
    v_lshl_add_u32 v22, v8, 4, v9
    v_add_u32 v8, 4, v5
    v_xor_b32 v8, v8, v4
    v_lshl_add_u32 v23, v8, 4, v9
    v_add_u32 v8, 8, v5
    v_xor_b32 v8, v8, v4
    v_lshl_add_u32 v24, v8, 4, v9
    v_add_u32 v8, 12, v5
    v_xor_b32 v8, v8, v4
    v_lshl_add_u32 v25, v8, 4, v9
    v_xor_b32 v8, v3, v4
    v_lshlrev_b32 v8, 4, v8
    v_lshl_add_u32 v8, v2, 8, v8
    s_add_u32 s75, s74, 81920
    s_add_u32 s55, s74, 131072
    s_cmp_lt_u32 s44, 2
    s_cselect_b32 s75, s75, s55
    v_add_u32 v26, s75, v8
    s_add_u32 s55, s74, 49152
    v_add_u32 v32, s55, v8
    s_lshl_b32 s76, s49, 16
    s_lshl_b32 s55, s44, 8
    s_add_u32 s76, s76, s55
    s_add_u32 s76, s76, 3145728
    v_cmp_gt_u32 vcc, 16, v0
    v_mov_b32 v47, 0
    s_nop 0
    v_cndmask_b32 v43, v47, v46, vcc
    s_waitcnt vmcnt(0)
    v_cmp_ne_u32 vcc, v43, v127
    s_cbranch_vccnz L_slow_64
L_back_65:
    s_barrier
    s_lshl_b32 s70, s48, 7
    s_lshl_b32 s71, s47, 2
    s_add_u32 s70, s70, s71
    s_add_u32 s70, s70, 344064
    v_lshlrev_b32 v44, 10, v0
    v_add_u32 v44, s70, v44
    v_cmp_gt_u32 vcc, 16, v0
    v_mov_b32 v47, 2147483632
    s_nop 0
    v_cndmask_b32 v43, v47, v44, vcc
    buffer_store_dword v46, v43, s[20:23], 0 offen sc1
    s_add_u32 s65, s66, 0
    s_cmp_ge_u32 s65, 14
    s_cselect_b32 s59, 14, 0
    s_sub_u32 s65, s65, s59
    s_lshl_b32 s65, s65, 12
    s_add_u32 s65, s79, s65
    s_add_u32 s59, s65, 0
    buffer_load_dwordx4 a[192:195], v42, s[20:23], s59 offen sc1
    buffer_load_dwordx4 a[196:199], v42, s[20:23], s59 offen offset:1024 sc1
    s_add_u32 s59, s65, 2048
    buffer_load_dwordx4 a[200:203], v42, s[20:23], s59 offen sc1
    buffer_load_dwordx4 a[204:207], v42, s[20:23], s59 offen offset:1024 sc1
    s_add_u32 s65, s66, 1
    s_cmp_ge_u32 s65, 14
    s_cselect_b32 s59, 14, 0
    s_sub_u32 s65, s65, s59
    s_lshl_b32 s65, s65, 12
    s_add_u32 s65, s79, s65
    s_add_u32 s59, s65, 0
    buffer_load_dwordx4 a[208:211], v42, s[20:23], s59 offen sc1
    buffer_load_dwordx4 a[212:215], v42, s[20:23], s59 offen offset:1024 sc1
    s_add_u32 s59, s65, 2048
    buffer_load_dwordx4 a[216:219], v42, s[20:23], s59 offen sc1
    buffer_load_dwordx4 a[220:223], v42, s[20:23], s59 offen offset:1024 sc1
    s_add_u32 s65, s66, 2
    s_cmp_ge_u32 s65, 14
    s_cselect_b32 s59, 14, 0
    s_sub_u32 s65, s65, s59
    s_lshl_b32 s65, s65, 12
    s_add_u32 s65, s79, s65
    s_add_u32 s59, s65, 0
    buffer_load_dwordx4 a[224:227], v42, s[20:23], s59 offen sc1
    buffer_load_dwordx4 a[228:231], v42, s[20:23], s59 offen offset:1024 sc1
    s_add_u32 s59, s65, 2048
    buffer_load_dwordx4 a[232:235], v42, s[20:23], s59 offen sc1
    buffer_load_dwordx4 a[236:239], v42, s[20:23], s59 offen offset:1024 sc1
    s_waitcnt vmcnt(10)
    v_mfma_f32_32x32x16_bf16 v[192:207], a[0:3], a[192:195], 0
    s_add_u32 s65, s66, 3
    s_cmp_ge_u32 s65, 14
    s_cselect_b32 s59, 14, 0
    s_sub_u32 s65, s65, s59
    v_cvt_f32_u32 v96, v2
    v_mul_f32 v96, 0x3c800000, v96
    v_add_f32 v97, 0.5, v96
    v_lshlrev_b32 v100, 1, v3
    v_cvt_f32_u32 v101, v100
    v_mul_f32 v98, v96, v101
    v_mul_f32 v99, v97, v101
    v_cmp_eq_u32 vcc, 0, v3
    v_mov_b32 v102, v98
    v_mov_b32 v104, v99
    v_cos_f32 v103, v102
    v_sin_f32 v102, v102
    v_cos_f32 v105, v104
    v_sin_f32 v104, v104
    v_mul_f32 v106, 0x42000000, v96
    v_cos_f32 v106, v106
    s_nop 0
    v_cndmask_b32 v102, v102, v106, vcc
    v_mul_f32 v106, 0x42000000, v97
    v_cos_f32 v106, v106
    s_nop 0
    v_cndmask_b32 v104, v104, v106, vcc
    v_cvt_pk_bf16_f32 v102, v103, v102
    v_cvt_pk_bf16_f32 v104, v105, v104
    v_accvgpr_write_b32 a160, v102
    v_accvgpr_write_b32 a176, v104
    v_fmamk_f32 v102, v96, 0x3f800000, v98
    v_fmamk_f32 v104, v97, 0x3f800000, v99
    v_mfma_f32_32x32x16_bf16 v[208:223], a[0:3], a[196:199], 0
    s_lshl_b32 s65, s65, 12
    s_add_u32 s65, s79, s65
    s_add_u32 s59, s65, 0
    buffer_load_dwordx4 a[240:243], v42, s[20:23], s59 offen sc1
    v_cos_f32 v103, v102
    v_sin_f32 v102, v102
    v_mfma_f32_32x32x16_bf16 v[224:239], a[4:7], a[192:195], 0
    buffer_load_dwordx4 a[244:247], v42, s[20:23], s59 offen offset:1024 sc1
    v_cos_f32 v105, v104
    v_sin_f32 v104, v104
    v_cvt_pk_bf16_f32 v102, v103, v102
    v_cvt_pk_bf16_f32 v104, v105, v104
    v_accvgpr_write_b32 a161, v102
    v_mfma_f32_32x32x16_bf16 v[240:255], a[4:7], a[196:199], 0
    s_add_u32 m0, s78, 11264
    s_add_u32 s59, s67, 24576
    buffer_load_dwordx4 v37, s[16:19], s59 offen lds
    v_accvgpr_write_b32 a177, v104
    v_fmamk_f32 v102, v96, 0x40800000, v98
    v_fmamk_f32 v104, v97, 0x40800000, v99
    s_waitcnt vmcnt(11)
    v_mfma_f32_32x32x16_bf16 v[192:207], a[8:11], a[200:203], v[192:207]
    s_add_u32 s59, s65, 2048
    buffer_load_dwordx4 a[248:251], v42, s[20:23], s59 offen sc1
    buffer_load_dwordx4 a[252:255], v42, s[20:23], s59 offen offset:1024 sc1
    v_cos_f32 v103, v102
    v_sin_f32 v102, v102
    v_cos_f32 v105, v104
    v_mfma_f32_32x32x16_bf16 v[208:223], a[8:11], a[204:207], v[208:223]
    v_sin_f32 v104, v104
    v_cvt_pk_bf16_f32 v102, v103, v102
    v_cvt_pk_bf16_f32 v104, v105, v104
    v_accvgpr_write_b32 a162, v102
    v_accvgpr_write_b32 a178, v104
    v_fmamk_f32 v102, v96, 0x40a00000, v98
    v_mfma_f32_32x32x16_bf16 v[224:239], a[12:15], a[200:203], v[224:239]
    v_fmamk_f32 v104, v97, 0x40a00000, v99
    v_cos_f32 v103, v102
    v_sin_f32 v102, v102
    v_cos_f32 v105, v104
    v_sin_f32 v104, v104
    v_cvt_pk_bf16_f32 v102, v103, v102
    v_mfma_f32_32x32x16_bf16 v[240:255], a[12:15], a[204:207], v[240:255]
    v_cvt_pk_bf16_f32 v104, v105, v104
    v_accvgpr_write_b32 a163, v102
    v_accvgpr_write_b32 a179, v104
    v_fmamk_f32 v102, v96, 0x41000000, v98
    v_fmamk_f32 v104, v97, 0x41000000, v99
    v_cos_f32 v103, v102
    s_waitcnt vmcnt(11)
    v_mfma_f32_32x32x16_bf16 v[192:207], a[16:19], a[208:211], v[192:207]
    s_add_u32 s65, s66, 4
    s_cmp_ge_u32 s65, 14
    s_cselect_b32 s59, 14, 0
    s_sub_u32 s65, s65, s59
    v_sin_f32 v102, v102
    v_cos_f32 v105, v104
    v_mfma_f32_32x32x16_bf16 v[208:223], a[16:19], a[212:215], v[208:223]
    s_lshl_b32 s65, s65, 12
    s_add_u32 s65, s79, s65
    s_add_u32 s59, s65, 0
    buffer_load_dwordx4 a[192:195], v42, s[20:23], s59 offen sc1
    v_sin_f32 v104, v104
    v_cvt_pk_bf16_f32 v102, v103, v102
    v_mfma_f32_32x32x16_bf16 v[224:239], a[20:23], a[208:211], v[224:239]
    buffer_load_dwordx4 a[196:199], v42, s[20:23], s59 offen offset:1024 sc1
    v_cvt_pk_bf16_f32 v104, v105, v104
    v_accvgpr_write_b32 a164, v102
    v_accvgpr_write_b32 a180, v104
    v_fmamk_f32 v102, v96, 0x41100000, v98
    v_fmamk_f32 v104, v97, 0x41100000, v99
    v_mfma_f32_32x32x16_bf16 v[240:255], a[20:23], a[212:215], v[240:255]
    v_cos_f32 v103, v102
    v_sin_f32 v102, v102
    v_cos_f32 v105, v104
    v_sin_f32 v104, v104
    v_cvt_pk_bf16_f32 v102, v103, v102
    v_cvt_pk_bf16_f32 v104, v105, v104
    s_waitcnt vmcnt(11)
    v_mfma_f32_32x32x16_bf16 v[192:207], a[24:27], a[216:219], v[192:207]
    s_add_u32 s59, s65, 2048
    buffer_load_dwordx4 a[200:203], v42, s[20:23], s59 offen sc1
    buffer_load_dwordx4 a[204:207], v42, s[20:23], s59 offen offset:1024 sc1
    v_accvgpr_write_b32 a165, v102
    v_accvgpr_write_b32 a181, v104
    v_fmamk_f32 v102, v96, 0x41400000, v98
    v_mfma_f32_32x32x16_bf16 v[208:223], a[24:27], a[220:223], v[208:223]
    v_fmamk_f32 v104, v97, 0x41400000, v99
    v_cos_f32 v103, v102
    v_sin_f32 v102, v102
    v_cos_f32 v105, v104
    v_sin_f32 v104, v104
    v_cvt_pk_bf16_f32 v102, v103, v102
    v_mfma_f32_32x32x16_bf16 v[224:239], a[28:31], a[216:219], v[224:239]
    v_cvt_pk_bf16_f32 v104, v105, v104
    v_accvgpr_write_b32 a166, v102
    v_accvgpr_write_b32 a182, v104
    v_fmamk_f32 v102, v96, 0x41500000, v98
    v_fmamk_f32 v104, v97, 0x41500000, v99
    v_cos_f32 v103, v102
    v_mfma_f32_32x32x16_bf16 v[240:255], a[28:31], a[220:223], v[240:255]
    v_sin_f32 v102, v102
    v_cos_f32 v105, v104
    v_sin_f32 v104, v104
    v_cvt_pk_bf16_f32 v102, v103, v102
    v_cvt_pk_bf16_f32 v104, v105, v104
    v_accvgpr_write_b32 a167, v102
    s_add_u32 s55, s69, 1048576
    buffer_load_dwordx4 v[14:17], v33, s[4:7], s69 offen
    buffer_load_dwordx4 v[18:21], v33, s[4:7], s55 offen
    s_waitcnt vmcnt(13)
    v_mfma_f32_32x32x16_bf16 v[192:207], a[32:35], a[224:227], v[192:207]
    s_add_u32 s65, s66, 5
    s_cmp_ge_u32 s65, 14
    s_cselect_b32 s59, 14, 0
    s_sub_u32 s65, s65, s59
    v_accvgpr_write_b32 a183, v104
    v_fmamk_f32 v102, v96, 0x41800000, v98
    v_mfma_f32_32x32x16_bf16 v[208:223], a[32:35], a[228:231], v[208:223]
    s_lshl_b32 s65, s65, 12
    s_add_u32 s65, s79, s65
    s_add_u32 s59, s65, 0
    buffer_load_dwordx4 a[208:211], v42, s[20:23], s59 offen sc1
    v_fmamk_f32 v104, v97, 0x41800000, v99
    v_cos_f32 v103, v102
    v_mfma_f32_32x32x16_bf16 v[224:239], a[36:39], a[224:227], v[224:239]
    buffer_load_dwordx4 a[212:215], v42, s[20:23], s59 offen offset:1024 sc1
    v_sin_f32 v102, v102
    v_cos_f32 v105, v104
    v_sin_f32 v104, v104
    v_cvt_pk_bf16_f32 v102, v103, v102
    v_cvt_pk_bf16_f32 v104, v105, v104
    v_mfma_f32_32x32x16_bf16 v[240:255], a[36:39], a[228:231], v[240:255]
    v_accvgpr_write_b32 a168, v102
    v_accvgpr_write_b32 a184, v104
    v_fmamk_f32 v102, v96, 0x41880000, v98
    v_fmamk_f32 v104, v97, 0x41880000, v99
    v_cos_f32 v103, v102
    v_sin_f32 v102, v102
    s_waitcnt vmcnt(13)
    v_mfma_f32_32x32x16_bf16 v[192:207], a[40:43], a[232:235], v[192:207]
    s_add_u32 s59, s65, 2048
    buffer_load_dwordx4 a[216:219], v42, s[20:23], s59 offen sc1
    buffer_load_dwordx4 a[220:223], v42, s[20:23], s59 offen offset:1024 sc1
    v_cos_f32 v105, v104
    v_sin_f32 v104, v104
    v_cvt_pk_bf16_f32 v102, v103, v102
    v_mfma_f32_32x32x16_bf16 v[208:223], a[40:43], a[236:239], v[208:223]
    v_cvt_pk_bf16_f32 v104, v105, v104
    v_accvgpr_write_b32 a169, v102
    v_accvgpr_write_b32 a185, v104
    v_fmamk_f32 v102, v96, 0x41a00000, v98
    v_fmamk_f32 v104, v97, 0x41a00000, v99
    v_cos_f32 v103, v102
    v_mfma_f32_32x32x16_bf16 v[224:239], a[44:47], a[232:235], v[224:239]
    v_sin_f32 v102, v102
    v_cos_f32 v105, v104
    v_sin_f32 v104, v104
    v_cvt_pk_bf16_f32 v102, v103, v102
    v_cvt_pk_bf16_f32 v104, v105, v104
    v_accvgpr_write_b32 a170, v102
    v_mfma_f32_32x32x16_bf16 v[240:255], a[44:47], a[236:239], v[240:255]
    v_accvgpr_write_b32 a186, v104
    v_fmamk_f32 v102, v96, 0x41a80000, v98
    v_fmamk_f32 v104, v97, 0x41a80000, v99
    v_cos_f32 v103, v102
    v_sin_f32 v102, v102
    v_cos_f32 v105, v104
    s_waitcnt vmcnt(13)
    v_mfma_f32_32x32x16_bf16 v[192:207], a[48:51], a[240:243], v[192:207]
    s_add_u32 s65, s66, 6
    s_cmp_ge_u32 s65, 14
    s_cselect_b32 s59, 14, 0
    s_sub_u32 s65, s65, s59
    v_sin_f32 v104, v104
    v_cvt_pk_bf16_f32 v102, v103, v102
    v_mfma_f32_32x32x16_bf16 v[208:223], a[48:51], a[244:247], v[208:223]
    s_lshl_b32 s65, s65, 12
    s_add_u32 s65, s79, s65
    s_add_u32 s59, s65, 0
    buffer_load_dwordx4 a[224:227], v42, s[20:23], s59 offen sc1
    v_cvt_pk_bf16_f32 v104, v105, v104
    v_accvgpr_write_b32 a171, v102
    v_mfma_f32_32x32x16_bf16 v[224:239], a[52:55], a[240:243], v[224:239]
    buffer_load_dwordx4 a[228:231], v42, s[20:23], s59 offen offset:1024 sc1
    v_accvgpr_write_b32 a187, v104
    v_fmamk_f32 v102, v96, 0x41c00000, v98
    v_fmamk_f32 v104, v97, 0x41c00000, v99
    v_cos_f32 v103, v102
    v_sin_f32 v102, v102
    v_mfma_f32_32x32x16_bf16 v[240:255], a[52:55], a[244:247], v[240:255]
    v_cos_f32 v105, v104
    v_sin_f32 v104, v104
    v_cvt_pk_bf16_f32 v102, v103, v102
    v_cvt_pk_bf16_f32 v104, v105, v104
    v_accvgpr_write_b32 a172, v102
    v_accvgpr_write_b32 a188, v104
    s_waitcnt vmcnt(12)
    v_mfma_f32_32x32x16_bf16 v[192:207], a[56:59], a[248:251], v[192:207]
    s_add_u32 s59, s65, 2048
    buffer_load_dwordx4 a[232:235], v42, s[20:23], s59 offen sc1
    buffer_load_dwordx4 a[236:239], v42, s[20:23], s59 offen offset:1024 sc1
    v_fmamk_f32 v102, v96, 0x41c80000, v98
    v_fmamk_f32 v104, v97, 0x41c80000, v99
    v_cos_f32 v103, v102
    v_mfma_f32_32x32x16_bf16 v[208:223], a[56:59], a[252:255], v[208:223]
    v_sin_f32 v102, v102
    v_cos_f32 v105, v104
    v_sin_f32 v104, v104
    v_cvt_pk_bf16_f32 v102, v103, v102
    v_cvt_pk_bf16_f32 v104, v105, v104
    v_accvgpr_write_b32 a173, v102
    v_mfma_f32_32x32x16_bf16 v[224:239], a[60:63], a[248:251], v[224:239]
    v_accvgpr_write_b32 a189, v104
    v_fmamk_f32 v102, v96, 0x41e00000, v98
    v_fmamk_f32 v104, v97, 0x41e00000, v99
    v_cos_f32 v103, v102
    v_sin_f32 v102, v102
    v_cos_f32 v105, v104
    v_mfma_f32_32x32x16_bf16 v[240:255], a[60:63], a[252:255], v[240:255]
    v_sin_f32 v104, v104
    v_cvt_pk_bf16_f32 v102, v103, v102
    v_cvt_pk_bf16_f32 v104, v105, v104
    v_accvgpr_write_b32 a174, v102
    v_accvgpr_write_b32 a190, v104
    v_fmamk_f32 v102, v96, 0x41e80000, v98
    s_waitcnt vmcnt(12)
    v_mfma_f32_32x32x16_bf16 v[192:207], a[64:67], a[192:195], v[192:207]
    s_add_u32 s65, s66, 7
    s_cmp_ge_u32 s65, 14
    s_cselect_b32 s59, 14, 0
    s_sub_u32 s65, s65, s59
    v_fmamk_f32 v104, v97, 0x41e80000, v99
    v_cos_f32 v103, v102
    v_mfma_f32_32x32x16_bf16 v[208:223], a[64:67], a[196:199], v[208:223]
    s_lshl_b32 s65, s65, 12
    s_add_u32 s65, s79, s65
    s_add_u32 s59, s65, 0
    buffer_load_dwordx4 a[240:243], v42, s[20:23], s59 offen sc1
    v_sin_f32 v102, v102
    v_cos_f32 v105, v104
    v_mfma_f32_32x32x16_bf16 v[224:239], a[68:71], a[192:195], v[224:239]
    buffer_load_dwordx4 a[244:247], v42, s[20:23], s59 offen offset:1024 sc1
    v_sin_f32 v104, v104
    v_cvt_pk_bf16_f32 v102, v103, v102
    v_cvt_pk_bf16_f32 v104, v105, v104
    v_accvgpr_write_b32 a175, v102
    v_accvgpr_write_b32 a191, v104
    v_mfma_f32_32x32x16_bf16 v[240:255], a[68:71], a[196:199], v[240:255]
    s_lshl_b32 s55, s50, 6
    v_add_u32 v96, s55, v2
    v_cvt_f32_u32 v96, v96
    s_mov_b32 s56, 0x3b000000
    v_mul_f32 v96, s56, v96
    v_add_f32 v97, 0x3d800000, v96
    s_lshl_b32 s55, s44, 6
    v_lshl_add_u32 v100, v3, 2, s55
    v_cvt_f32_u32 v101, v100
    v_mul_f32 v98, v96, v101
    v_mul_f32 v99, v97, v101
    s_waitcnt vmcnt(12)
    v_mfma_f32_32x32x16_bf16 v[192:207], a[72:75], a[200:203], v[192:207]
    s_add_u32 s59, s65, 2048
    buffer_load_dwordx4 a[248:251], v42, s[20:23], s59 offen sc1
    buffer_load_dwordx4 a[252:255], v42, s[20:23], s59 offen offset:1024 sc1
    v_fmamk_f32 v102, v96, 0x426c0000, v98
    v_fmamk_f32 v104, v97, 0x426c0000, v99
    v_cos_f32 v103, v102
    v_mfma_f32_32x32x16_bf16 v[208:223], a[72:75], a[204:207], v[208:223]
    v_sin_f32 v102, -v102
    v_cos_f32 v105, v104
    v_sin_f32 v104, -v104
    v_cvt_pk_bf16_f32 v102, v103, v102
    v_cvt_pk_bf16_f32 v104, v105, v104
    v_accvgpr_write_b32 a155, v102
    v_mfma_f32_32x32x16_bf16 v[224:239], a[76:79], a[200:203], v[224:239]
    v_accvgpr_write_b32 a159, v104
    v_fmamk_f32 v102, v96, 0x42680000, v98
    v_fmamk_f32 v104, v97, 0x42680000, v99
    v_cos_f32 v103, v102
    v_sin_f32 v102, -v102
    v_cos_f32 v105, v104
    v_mfma_f32_32x32x16_bf16 v[240:255], a[76:79], a[204:207], v[240:255]
    v_sin_f32 v104, -v104
    v_cvt_pk_bf16_f32 v102, v103, v102
    v_cvt_pk_bf16_f32 v104, v105, v104
    v_accvgpr_write_b32 a154, v102
    v_accvgpr_write_b32 a158, v104
    v_fmamk_f32 v102, v96, 0x42640000, v98
    s_lshr_b32 s70, s2, 3
    s_and_b32 s70, s70, 15
    s_lshl_b32 s70, s70, 10
    s_add_u32 s70, s70, 344064
    v_lshlrev_b32 v44, 4, v0
    v_add_u32 v44, s70, v44
    v_cmp_gt_u32 vcc, 64, v0
    v_mov_b32 v47, 2147483632
    s_nop 0
    v_cndmask_b32 v27, v47, v44, vcc
    buffer_load_dwordx4 v[28:31], v27, s[20:23], 0 offen sc1
    s_waitcnt vmcnt(11)
    v_mfma_f32_32x32x16_bf16 v[192:207], a[96:99], a[208:211], v[192:207]
    s_add_u32 s65, s66, 8
    s_cmp_ge_u32 s65, 14
    s_cselect_b32 s59, 14, 0
    s_sub_u32 s65, s65, s59
    v_fmamk_f32 v104, v97, 0x42640000, v99
    v_cos_f32 v103, v102
    v_mfma_f32_32x32x16_bf16 v[208:223], a[96:99], a[212:215], v[208:223]
    s_lshl_b32 s65, s65, 12
    s_add_u32 s65, s79, s65
    s_add_u32 s59, s65, 0
    buffer_load_dwordx4 a[192:195], v42, s[20:23], s59 offen sc1
    v_sin_f32 v102, -v102
    v_cos_f32 v105, v104
    v_mfma_f32_32x32x16_bf16 v[224:239], a[100:103], a[208:211], v[224:239]
    buffer_load_dwordx4 a[196:199], v42, s[20:23], s59 offen offset:1024 sc1
    v_sin_f32 v104, -v104
    v_cvt_pk_bf16_f32 v102, v103, v102
    v_cvt_pk_bf16_f32 v104, v105, v104
    v_accvgpr_write_b32 a153, v102
    v_accvgpr_write_b32 a157, v104
    v_mfma_f32_32x32x16_bf16 v[240:255], a[100:103], a[212:215], v[240:255]
    v_fmamk_f32 v102, v96, 0x42600000, v98
    v_fmamk_f32 v104, v97, 0x42600000, v99
    v_cos_f32 v103, v102
    v_sin_f32 v102, -v102
    v_cos_f32 v105, v104
    v_sin_f32 v104, -v104
    s_waitcnt vmcnt(11)
    v_mfma_f32_32x32x16_bf16 v[192:207], a[104:107], a[216:219], v[192:207]
    ds_read_b64_tr_b16 v[48:49], v38 offset:0
    ds_read_b64_tr_b16 v[50:51], v38 offset:1024
    v_cvt_pk_bf16_f32 v102, v103, v102
    v_cvt_pk_bf16_f32 v104, v105, v104
    v_accvgpr_write_b32 a152, v102
    v_accvgpr_write_b32 a156, v104
    v_mfma_f32_32x32x16_bf16 v[208:223], a[104:107], a[220:223], v[208:223]
    ds_read_b64_tr_b16 v[52:53], v39 offset:0
    ds_read_b64_tr_b16 v[54:55], v39 offset:1024
    v_fmamk_f32 v102, v96, 0x424c0000, v98
    v_fmamk_f32 v104, v97, 0x424c0000, v99
    v_cos_f32 v103, v102
    v_sin_f32 v102, -v102
    v_mfma_f32_32x32x16_bf16 v[224:239], a[108:111], a[216:219], v[224:239]
    s_add_u32 s59, s65, 2048
    buffer_load_dwordx4 a[200:203], v42, s[20:23], s59 offen sc1
    buffer_load_dwordx4 a[204:207], v42, s[20:23], s59 offen offset:1024 sc1
    v_cos_f32 v105, v104
    v_sin_f32 v104, -v104
    v_cvt_pk_bf16_f32 v102, v103, v102
    v_mfma_f32_32x32x16_bf16 v[240:255], a[108:111], a[220:223], v[240:255]
    v_cvt_pk_bf16_f32 v104, v105, v104
    v_accvgpr_write_b32 a147, v102
    v_accvgpr_write_b32 a151, v104
    v_fmamk_f32 v102, v96, 0x42480000, v98
    v_fmamk_f32 v104, v97, 0x42480000, v99
    v_cos_f32 v103, v102
    s_waitcnt lgkmcnt(0)
    s_waitcnt vmcnt(11)
    v_mfma_f32_32x32x16_bf16 v[192:207], v[48:51], a[224:227], v[192:207]
    ds_read_b64_tr_b16 v[56:57], v38 offset:2048
    ds_read_b64_tr_b16 v[58:59], v38 offset:3072
    v_sin_f32 v102, -v102
    v_cos_f32 v105, v104
    v_sin_f32 v104, -v104
    v_cvt_pk_bf16_f32 v102, v103, v102
    v_mfma_f32_32x32x16_bf16 v[208:223], v[48:51], a[228:231], v[208:223]
    ds_read_b64_tr_b16 v[60:61], v39 offset:2048
    ds_read_b64_tr_b16 v[62:63], v39 offset:3072
    v_cvt_pk_bf16_f32 v104, v105, v104
    v_accvgpr_write_b32 a146, v102
    v_accvgpr_write_b32 a150, v104
    v_fmamk_f32 v102, v96, 0x42440000, v98
    v_mfma_f32_32x32x16_bf16 v[224:239], v[52:55], a[224:227], v[224:239]
    s_add_u32 s65, s66, 9
    s_cmp_ge_u32 s65, 14
    s_cselect_b32 s59, 14, 0
    s_sub_u32 s65, s65, s59
    v_fmamk_f32 v104, v97, 0x42440000, v99
    v_cos_f32 v103, v102
    v_mfma_f32_32x32x16_bf16 v[240:255], v[52:55], a[228:231], v[240:255]
    s_lshl_b32 s65, s65, 12
    s_add_u32 s65, s79, s65
    s_add_u32 s59, s65, 0
    buffer_load_dwordx4 a[208:211], v42, s[20:23], s59 offen sc1
    v_sin_f32 v102, -v102
    v_cos_f32 v105, v104
    buffer_load_dwordx4 a[212:215], v42, s[20:23], s59 offen offset:1024 sc1
    s_waitcnt lgkmcnt(0)
    s_waitcnt vmcnt(11)
    v_mfma_f32_32x32x16_bf16 v[192:207], v[56:59], a[232:235], v[192:207]
    ds_read_b64_tr_b16 v[48:49], v38 offset:4096
    ds_read_b64_tr_b16 v[50:51], v38 offset:5120
    v_sin_f32 v104, -v104
    v_cvt_pk_bf16_f32 v102, v103, v102
    v_cvt_pk_bf16_f32 v104, v105, v104
    v_accvgpr_write_b32 a145, v102
    v_mfma_f32_32x32x16_bf16 v[208:223], v[56:59], a[236:239], v[208:223]
    ds_read_b64_tr_b16 v[52:53], v39 offset:4096
    ds_read_b64_tr_b16 v[54:55], v39 offset:5120
    v_accvgpr_write_b32 a149, v104
    v_fmamk_f32 v102, v96, 0x42400000, v98
    v_fmamk_f32 v104, v97, 0x42400000, v99
    v_cos_f32 v103, v102
    v_mfma_f32_32x32x16_bf16 v[224:239], v[60:63], a[232:235], v[224:239]
    s_add_u32 s59, s65, 2048
    buffer_load_dwordx4 a[216:219], v42, s[20:23], s59 offen sc1
    buffer_load_dwordx4 a[220:223], v42, s[20:23], s59 offen offset:1024 sc1
    v_sin_f32 v102, -v102
    v_cos_f32 v105, v104
    v_sin_f32 v104, -v104
    v_mfma_f32_32x32x16_bf16 v[240:255], v[60:63], a[236:239], v[240:255]
    v_cvt_pk_bf16_f32 v102, v103, v102
    v_cvt_pk_bf16_f32 v104, v105, v104
    v_accvgpr_write_b32 a144, v102
    v_accvgpr_write_b32 a148, v104
    v_fmamk_f32 v102, v96, 0x422c0000, v98
    v_fmamk_f32 v104, v97, 0x422c0000, v99
    s_waitcnt lgkmcnt(0)
    v_cmp_gt_u32 vcc, 64, v0
    v_mov_b32 v47, 0
    s_nop 0
    v_cndmask_b32 v43, v47, v46, vcc
    s_waitcnt vmcnt(8)
    v_xor_b32 v28, v43, v28
    v_xor_b32 v29, v43, v29
    v_xor_b32 v30, v43, v30
    v_xor_b32 v31, v43, v31
    v_or3_b32 v28, v28, v29, v30
    v_or_b32 v28, v28, v31
    v_cmp_ne_u32 vcc, 0, v28
    s_cbranch_vccnz L_slow_67
L_back_68:
    s_barrier
    v_mfma_f32_32x32x16_bf16 v[192:207], v[48:51], a[240:243], v[192:207]
    ds_read_b64_tr_b16 v[56:57], v38 offset:6144
    ds_read_b64_tr_b16 v[58:59], v38 offset:7168
    v_cos_f32 v103, v102
    v_sin_f32 v102, -v102
    v_cos_f32 v105, v104
    v_sin_f32 v104, -v104
    v_mfma_f32_32x32x16_bf16 v[208:223], v[48:51], a[244:247], v[208:223]
    ds_read_b64_tr_b16 v[60:61], v39 offset:6144
    ds_read_b64_tr_b16 v[62:63], v39 offset:7168
    v_cvt_pk_bf16_f32 v102, v103, v102
    v_cvt_pk_bf16_f32 v104, v105, v104
    v_accvgpr_write_b32 a139, v102
    v_accvgpr_write_b32 a143, v104
    v_mfma_f32_32x32x16_bf16 v[224:239], v[52:55], a[240:243], v[224:239]
    s_add_u32 s65, s66, 10
    s_cmp_ge_u32 s65, 14
    s_cselect_b32 s59, 14, 0
    s_sub_u32 s65, s65, s59
    v_fmamk_f32 v102, v96, 0x42280000, v98
    v_fmamk_f32 v104, v97, 0x42280000, v99
    v_mfma_f32_32x32x16_bf16 v[240:255], v[52:55], a[244:247], v[240:255]
    s_lshl_b32 s65, s65, 12
    s_add_u32 s65, s79, s65
    s_add_u32 s59, s65, 0
    buffer_load_dwordx4 a[224:227], v42, s[20:23], s59 offen sc1
    v_cos_f32 v103, v102
    v_sin_f32 v102, -v102
    buffer_load_dwordx4 a[228:231], v42, s[20:23], s59 offen offset:1024 sc1
    s_waitcnt lgkmcnt(0)
    v_mfma_f32_32x32x16_bf16 v[192:207], v[56:59], a[248:251], v[192:207]
    ds_read_b64_tr_b16 v[48:49], v10 offset:0
    ds_read_b64_tr_b16 v[50:51], v10 offset:1024
    v_cos_f32 v105, v104
    v_sin_f32 v104, -v104
    v_cvt_pk_bf16_f32 v102, v103, v102
    v_cvt_pk_bf16_f32 v104, v105, v104
    v_mfma_f32_32x32x16_bf16 v[208:223], v[56:59], a[252:255], v[208:223]
    ds_read_b64_tr_b16 v[52:53], v11 offset:0
    ds_read_b64_tr_b16 v[54:55], v11 offset:1024
    v_accvgpr_write_b32 a138, v102
    v_accvgpr_write_b32 a142, v104
    v_fmamk_f32 v102, v96, 0x42240000, v98
    v_fmamk_f32 v104, v97, 0x42240000, v99
    v_mfma_f32_32x32x16_bf16 v[224:239], v[60:63], a[248:251], v[224:239]
    s_add_u32 s59, s65, 2048
    buffer_load_dwordx4 a[232:235], v42, s[20:23], s59 offen sc1
    buffer_load_dwordx4 a[236:239], v42, s[20:23], s59 offen offset:1024 sc1
    v_cos_f32 v103, v102
    v_sin_f32 v102, -v102
    v_cos_f32 v105, v104
    v_mfma_f32_32x32x16_bf16 v[240:255], v[60:63], a[252:255], v[240:255]
    s_add_u32 m0, s75, 0
    s_add_u32 s59, s76, 0
    buffer_load_dwordx4 v22, s[20:23], s59 offen sc1 lds
    v_sin_f32 v104, -v104
    v_cvt_pk_bf16_f32 v102, v103, v102
    v_cvt_pk_bf16_f32 v104, v105, v104
    s_waitcnt lgkmcnt(0)
    s_waitcnt vmcnt(11)
    v_mfma_f32_32x32x16_bf16 v[192:207], v[48:51], a[192:195], v[192:207]
    ds_read_b64_tr_b16 v[56:57], v10 offset:2048
    ds_read_b64_tr_b16 v[58:59], v10 offset:3072
    v_accvgpr_write_b32 a137, v102
    v_accvgpr_write_b32 a141, v104
    v_fmamk_f32 v102, v96, 0x42200000, v98
    v_fmamk_f32 v104, v97, 0x42200000, v99
    v_mfma_f32_32x32x16_bf16 v[208:223], v[48:51], a[196:199], v[208:223]
    ds_read_b64_tr_b16 v[60:61], v11 offset:2048
    ds_read_b64_tr_b16 v[62:63], v11 offset:3072
    v_cos_f32 v103, v102
    v_sin_f32 v102, -v102
    v_cos_f32 v105, v104
    v_sin_f32 v104, -v104
    v_mfma_f32_32x32x16_bf16 v[224:239], v[52:55], a[192:195], v[224:239]
    s_add_u32 s65, s66, 11
    s_cmp_ge_u32 s65, 14
    s_cselect_b32 s59, 14, 0
    s_sub_u32 s65, s65, s59
    v_cvt_pk_bf16_f32 v102, v103, v102
    v_cvt_pk_bf16_f32 v104, v105, v104
    v_mfma_f32_32x32x16_bf16 v[240:255], v[52:55], a[196:199], v[240:255]
    s_lshl_b32 s65, s65, 12
    s_add_u32 s65, s79, s65
    s_add_u32 s59, s65, 0
    buffer_load_dwordx4 a[240:243], v42, s[20:23], s59 offen sc1
    v_accvgpr_write_b32 a136, v102
    v_accvgpr_write_b32 a140, v104
    buffer_load_dwordx4 a[244:247], v42, s[20:23], s59 offen offset:1024 sc1
    s_waitcnt lgkmcnt(0)
    s_waitcnt vmcnt(11)
    v_mfma_f32_32x32x16_bf16 v[192:207], v[56:59], a[200:203], v[192:207]
    ds_read_b64_tr_b16 v[48:49], v10 offset:4096
    ds_read_b64_tr_b16 v[50:51], v10 offset:5120
    v_fmamk_f32 v102, v96, 0x420c0000, v98
    v_fmamk_f32 v104, v97, 0x420c0000, v99
    v_cos_f32 v103, v102
    v_sin_f32 v102, -v102
    v_mfma_f32_32x32x16_bf16 v[208:223], v[56:59], a[204:207], v[208:223]
    ds_read_b64_tr_b16 v[52:53], v11 offset:4096
    ds_read_b64_tr_b16 v[54:55], v11 offset:5120
    v_cos_f32 v105, v104
    v_sin_f32 v104, -v104
    v_cvt_pk_bf16_f32 v102, v103, v102
    v_cvt_pk_bf16_f32 v104, v105, v104
    v_mfma_f32_32x32x16_bf16 v[224:239], v[60:63], a[200:203], v[224:239]
    s_add_u32 s59, s65, 2048
    buffer_load_dwordx4 a[248:251], v42, s[20:23], s59 offen sc1
    buffer_load_dwordx4 a[252:255], v42, s[20:23], s59 offen offset:1024 sc1
    v_accvgpr_write_b32 a131, v102
    v_accvgpr_write_b32 a135, v104
    v_fmamk_f32 v102, v96, 0x42080000, v98
    v_mfma_f32_32x32x16_bf16 v[240:255], v[60:63], a[204:207], v[240:255]
    s_add_u32 m0, s75, 1024
    s_add_u32 s59, s76, 4096
    buffer_load_dwordx4 v23, s[20:23], s59 offen sc1 lds
    v_fmamk_f32 v104, v97, 0x42080000, v99
    v_cos_f32 v103, v102
    v_sin_f32 v102, -v102
    s_waitcnt lgkmcnt(0)
    s_waitcnt vmcnt(12)
    v_mfma_f32_32x32x16_bf16 v[192:207], v[48:51], a[208:211], v[192:207]
    ds_read_b64_tr_b16 v[56:57], v10 offset:6144
    ds_read_b64_tr_b16 v[58:59], v10 offset:7168
    v_cos_f32 v105, v104
    v_sin_f32 v104, -v104
    v_cvt_pk_bf16_f32 v102, v103, v102
    v_cvt_pk_bf16_f32 v104, v105, v104
    v_mfma_f32_32x32x16_bf16 v[208:223], v[48:51], a[212:215], v[208:223]
    ds_read_b64_tr_b16 v[60:61], v11 offset:6144
    ds_read_b64_tr_b16 v[62:63], v11 offset:7168
    v_accvgpr_write_b32 a130, v102
    v_accvgpr_write_b32 a134, v104
    v_fmamk_f32 v102, v96, 0x42040000, v98
    v_fmamk_f32 v104, v97, 0x42040000, v99
    v_mfma_f32_32x32x16_bf16 v[224:239], v[52:55], a[208:211], v[224:239]
    s_add_u32 s65, s66, 12
    s_cmp_ge_u32 s65, 14
    s_cselect_b32 s59, 14, 0
    s_sub_u32 s65, s65, s59
    v_cos_f32 v103, v102
    v_sin_f32 v102, -v102
    v_mfma_f32_32x32x16_bf16 v[240:255], v[52:55], a[212:215], v[240:255]
    s_lshl_b32 s65, s65, 12
    s_add_u32 s65, s79, s65
    s_add_u32 s59, s65, 0
    buffer_load_dwordx4 a[192:195], v42, s[20:23], s59 offen sc1
    v_cos_f32 v105, v104
    v_sin_f32 v104, -v104
    buffer_load_dwordx4 a[196:199], v42, s[20:23], s59 offen offset:1024 sc1
    s_waitcnt lgkmcnt(0)
    s_waitcnt vmcnt(12)
    v_mfma_f32_32x32x16_bf16 v[192:207], v[56:59], a[216:219], v[192:207]
    ds_read_b64_tr_b16 v[48:49], v10 offset:8192
    ds_read_b64_tr_b16 v[50:51], v10 offset:9216
    v_cvt_pk_bf16_f32 v102, v103, v102
    v_cvt_pk_bf16_f32 v104, v105, v104
    v_accvgpr_write_b32 a129, v102
    v_accvgpr_write_b32 a133, v104
    v_mfma_f32_32x32x16_bf16 v[208:223], v[56:59], a[220:223], v[208:223]
    ds_read_b64_tr_b16 v[52:53], v11 offset:8192
    ds_read_b64_tr_b16 v[54:55], v11 offset:9216
    v_fmamk_f32 v102, v96, 0x42000000, v98
    v_fmamk_f32 v104, v97, 0x42000000, v99
    v_cos_f32 v103, v102
    v_sin_f32 v102, -v102
    v_mfma_f32_32x32x16_bf16 v[224:239], v[60:63], a[216:219], v[224:239]
    s_add_u32 s59, s65, 2048
    buffer_load_dwordx4 a[200:203], v42, s[20:23], s59 offen sc1
    buffer_load_dwordx4 a[204:207], v42, s[20:23], s59 offen offset:1024 sc1
    v_cos_f32 v105, v104
    v_sin_f32 v104, -v104
    v_cvt_pk_bf16_f32 v102, v103, v102
    v_mfma_f32_32x32x16_bf16 v[240:255], v[60:63], a[220:223], v[240:255]
    s_add_u32 m0, s75, 2048
    s_add_u32 s59, s76, 8192
    buffer_load_dwordx4 v24, s[20:23], s59 offen sc1 lds
    v_cvt_pk_bf16_f32 v104, v105, v104
    v_accvgpr_write_b32 a128, v102
    v_accvgpr_write_b32 a132, v104
    s_waitcnt lgkmcnt(0)
    s_waitcnt vmcnt(13)
    v_mfma_f32_32x32x16_bf16 v[192:207], v[48:51], a[224:227], v[192:207]
    ds_read_b64_tr_b16 v[56:57], v10 offset:10240
    ds_read_b64_tr_b16 v[58:59], v10 offset:11264
    v_fmamk_f32 v102, v96, 0x41d80000, v98
    v_fmamk_f32 v104, v97, 0x41d80000, v99
    v_cos_f32 v103, v102
    v_sin_f32 v102, -v102
    v_mfma_f32_32x32x16_bf16 v[208:223], v[48:51], a[228:231], v[208:223]
    ds_read_b64_tr_b16 v[60:61], v11 offset:10240
    ds_read_b64_tr_b16 v[62:63], v11 offset:11264
    v_cos_f32 v105, v104
    v_sin_f32 v104, -v104
    v_cvt_pk_bf16_f32 v102, v103, v102
    v_cvt_pk_bf16_f32 v104, v105, v104
    v_mfma_f32_32x32x16_bf16 v[224:239], v[52:55], a[224:227], v[224:239]
    s_add_u32 s65, s66, 13
    s_cmp_ge_u32 s65, 14
    s_cselect_b32 s59, 14, 0
    s_sub_u32 s65, s65, s59
    v_accvgpr_write_b32 a123, v102
    v_accvgpr_write_b32 a127, v104
    v_mfma_f32_32x32x16_bf16 v[240:255], v[52:55], a[228:231], v[240:255]
    s_lshl_b32 s65, s65, 12
    s_add_u32 s65, s79, s65
    s_add_u32 s59, s65, 0
    buffer_load_dwordx4 a[208:211], v42, s[20:23], s59 offen sc1
    v_fmamk_f32 v102, v96, 0x41d00000, v98
    v_fmamk_f32 v104, v97, 0x41d00000, v99
    buffer_load_dwordx4 a[212:215], v42, s[20:23], s59 offen offset:1024 sc1
    s_waitcnt lgkmcnt(0)
    s_waitcnt vmcnt(13)
    v_mfma_f32_32x32x16_bf16 v[192:207], v[56:59], a[232:235], v[192:207]
    ds_read_b64_tr_b16 v[48:49], v12 offset:0
    ds_read_b64_tr_b16 v[50:51], v12 offset:1024
    v_cos_f32 v103, v102
    v_sin_f32 v102, -v102
    v_cos_f32 v105, v104
    v_sin_f32 v104, -v104
    v_mfma_f32_32x32x16_bf16 v[208:223], v[56:59], a[236:239], v[208:223]
    ds_read_b64_tr_b16 v[52:53], v13 offset:0
    ds_read_b64_tr_b16 v[54:55], v13 offset:1024
    v_cvt_pk_bf16_f32 v102, v103, v102
    v_cvt_pk_bf16_f32 v104, v105, v104
    v_accvgpr_write_b32 a122, v102
    v_accvgpr_write_b32 a126, v104
    v_mfma_f32_32x32x16_bf16 v[224:239], v[60:63], a[232:235], v[224:239]
    s_add_u32 s59, s65, 2048
    buffer_load_dwordx4 a[216:219], v42, s[20:23], s59 offen sc1
    buffer_load_dwordx4 a[220:223], v42, s[20:23], s59 offen offset:1024 sc1
    v_fmamk_f32 v102, v96, 0x41c80000, v98
    v_fmamk_f32 v104, v97, 0x41c80000, v99
    v_cos_f32 v103, v102
    v_mfma_f32_32x32x16_bf16 v[240:255], v[60:63], a[236:239], v[240:255]
    s_add_u32 m0, s75, 3072
    s_add_u32 s59, s76, 12288
    buffer_load_dwordx4 v25, s[20:23], s59 offen sc1 lds
    v_sin_f32 v102, -v102
    v_cos_f32 v105, v104
    v_sin_f32 v104, -v104
    s_waitcnt lgkmcnt(0)
    s_waitcnt vmcnt(13)
    v_mfma_f32_32x32x16_bf16 v[192:207], v[48:51], a[240:243], v[192:207]
    ds_read_b64_tr_b16 v[56:57], v12 offset:2048
    ds_read_b64_tr_b16 v[58:59], v12 offset:3072
    v_cvt_pk_bf16_f32 v102, v103, v102
    v_cvt_pk_bf16_f32 v104, v105, v104
    v_accvgpr_write_b32 a121, v102
    v_accvgpr_write_b32 a125, v104
    v_mfma_f32_32x32x16_bf16 v[208:223], v[48:51], a[244:247], v[208:223]
    ds_read_b64_tr_b16 v[60:61], v13 offset:2048
    ds_read_b64_tr_b16 v[62:63], v13 offset:3072
    v_fmamk_f32 v102, v96, 0x41c00000, v98
    v_fmamk_f32 v104, v97, 0x41c00000, v99
    v_cos_f32 v103, v102
    v_sin_f32 v102, -v102
    v_mfma_f32_32x32x16_bf16 v[224:239], v[52:55], a[240:243], v[224:239]
    s_add_u32 m0, s75, 4096
    s_add_u32 s59, s76, 16384
    buffer_load_dwordx4 v22, s[20:23], s59 offen sc1 lds
    v_cos_f32 v105, v104
    v_sin_f32 v104, -v104
    v_cvt_pk_bf16_f32 v102, v103, v102
    v_mfma_f32_32x32x16_bf16 v[240:255], v[52:55], a[244:247], v[240:255]
    s_add_u32 m0, s75, 5120
    s_add_u32 s59, s76, 20480
    buffer_load_dwordx4 v23, s[20:23], s59 offen sc1 lds
    v_cvt_pk_bf16_f32 v104, v105, v104
    v_accvgpr_write_b32 a120, v102
    v_accvgpr_write_b32 a124, v104
    s_waitcnt lgkmcnt(0)
    s_waitcnt vmcnt(13)
    v_mfma_f32_32x32x16_bf16 v[192:207], v[56:59], a[248:251], v[192:207]
    ds_read_b64_tr_b16 v[48:49], v12 offset:4096
    ds_read_b64_tr_b16 v[50:51], v12 offset:5120
    v_fmamk_f32 v102, v96, 0x41980000, v98
    v_fmamk_f32 v104, v97, 0x41980000, v99
    v_cos_f32 v103, v102
    v_sin_f32 v102, -v102
    v_mfma_f32_32x32x16_bf16 v[208:223], v[56:59], a[252:255], v[208:223]
    ds_read_b64_tr_b16 v[52:53], v13 offset:4096
    ds_read_b64_tr_b16 v[54:55], v13 offset:5120
    v_cos_f32 v105, v104
    v_sin_f32 v104, -v104
    v_cvt_pk_bf16_f32 v102, v103, v102
    v_cvt_pk_bf16_f32 v104, v105, v104
    v_mfma_f32_32x32x16_bf16 v[224:239], v[60:63], a[248:251], v[224:239]
    s_add_u32 m0, s75, 6144
    s_add_u32 s59, s76, 24576
    buffer_load_dwordx4 v24, s[20:23], s59 offen sc1 lds
    v_accvgpr_write_b32 a115, v102
    v_accvgpr_write_b32 a119, v104
    v_fmamk_f32 v102, v96, 0x41900000, v98
    v_mfma_f32_32x32x16_bf16 v[240:255], v[60:63], a[252:255], v[240:255]
    s_add_u32 m0, s75, 7168
    s_add_u32 s59, s76, 28672
    buffer_load_dwordx4 v25, s[20:23], s59 offen sc1 lds
    v_fmamk_f32 v104, v97, 0x41900000, v99
    v_cos_f32 v103, v102
    v_sin_f32 v102, -v102
    s_waitcnt lgkmcnt(0)
    s_waitcnt vmcnt(12)
    v_mfma_f32_32x32x16_bf16 v[192:207], v[48:51], a[192:195], v[192:207]
    ds_read_b64_tr_b16 v[56:57], v12 offset:6144
    ds_read_b64_tr_b16 v[58:59], v12 offset:7168
    v_cos_f32 v105, v104
    v_sin_f32 v104, -v104
    v_cvt_pk_bf16_f32 v102, v103, v102
    v_cvt_pk_bf16_f32 v104, v105, v104
    v_mfma_f32_32x32x16_bf16 v[208:223], v[48:51], a[196:199], v[208:223]
    ds_read_b64_tr_b16 v[60:61], v13 offset:6144
    ds_read_b64_tr_b16 v[62:63], v13 offset:7168
    v_accvgpr_write_b32 a114, v102
    v_accvgpr_write_b32 a118, v104
    v_fmamk_f32 v102, v96, 0x41880000, v98
    v_fmamk_f32 v104, v97, 0x41880000, v99
    v_mfma_f32_32x32x16_bf16 v[224:239], v[52:55], a[192:195], v[224:239]
    s_add_u32 m0, s74, 49152
    s_add_u32 s59, s76, 32768
    buffer_load_dwordx4 v22, s[20:23], s59 offen sc1 lds
    v_cos_f32 v103, v102
    v_sin_f32 v102, -v102
    v_cos_f32 v105, v104
    v_mfma_f32_32x32x16_bf16 v[240:255], v[52:55], a[196:199], v[240:255]
    s_add_u32 m0, s74, 50176
    s_add_u32 s59, s76, 36864
    buffer_load_dwordx4 v23, s[20:23], s59 offen sc1 lds
    v_sin_f32 v104, -v104
    v_cvt_pk_bf16_f32 v102, v103, v102
    v_cvt_pk_bf16_f32 v104, v105, v104
    s_waitcnt lgkmcnt(0)
    s_waitcnt vmcnt(12)
    v_mfma_f32_32x32x16_bf16 v[192:207], v[56:59], a[200:203], v[192:207]
    ds_read_b64_tr_b16 v[48:49], v12 offset:8192
    ds_read_b64_tr_b16 v[50:51], v12 offset:9216
    v_accvgpr_write_b32 a113, v102
    v_accvgpr_write_b32 a117, v104
    v_fmamk_f32 v102, v96, 0x41800000, v98
    v_fmamk_f32 v104, v97, 0x41800000, v99
    v_mfma_f32_32x32x16_bf16 v[208:223], v[56:59], a[204:207], v[208:223]
    ds_read_b64_tr_b16 v[52:53], v13 offset:8192
    ds_read_b64_tr_b16 v[54:55], v13 offset:9216
    v_cos_f32 v103, v102
    v_sin_f32 v102, -v102
    v_cos_f32 v105, v104
    v_sin_f32 v104, -v104
    v_mfma_f32_32x32x16_bf16 v[224:239], v[60:63], a[200:203], v[224:239]
    s_add_u32 m0, s74, 51200
    s_add_u32 s59, s76, 40960
    buffer_load_dwordx4 v24, s[20:23], s59 offen sc1 lds
    v_cvt_pk_bf16_f32 v102, v103, v102
    v_cvt_pk_bf16_f32 v104, v105, v104
    v_accvgpr_write_b32 a112, v102
    v_mfma_f32_32x32x16_bf16 v[240:255], v[60:63], a[204:207], v[240:255]
    s_add_u32 m0, s74, 52224
    s_add_u32 s59, s76, 45056
    buffer_load_dwordx4 v25, s[20:23], s59 offen sc1 lds
    v_accvgpr_write_b32 a116, v104
    v_fmamk_f32 v102, v96, 0x41300000, v98
    v_fmamk_f32 v104, v97, 0x41300000, v99
    s_waitcnt lgkmcnt(0)
    s_waitcnt vmcnt(11)
    v_mfma_f32_32x32x16_bf16 v[192:207], v[48:51], a[208:211], v[192:207]
    ds_read_b64_tr_b16 v[56:57], v12 offset:10240
    ds_read_b64_tr_b16 v[58:59], v12 offset:11264
    v_cos_f32 v103, v102
    v_sin_f32 v102, -v102
    v_cos_f32 v105, v104
    v_sin_f32 v104, -v104
    v_mfma_f32_32x32x16_bf16 v[208:223], v[48:51], a[212:215], v[208:223]
    ds_read_b64_tr_b16 v[60:61], v13 offset:10240
    ds_read_b64_tr_b16 v[62:63], v13 offset:11264
    v_cvt_pk_bf16_f32 v102, v103, v102
    v_cvt_pk_bf16_f32 v104, v105, v104
    v_accvgpr_write_b32 a107, v102
    v_accvgpr_write_b32 a111, v104
    v_mfma_f32_32x32x16_bf16 v[224:239], v[52:55], a[208:211], v[224:239]
    s_add_u32 m0, s74, 53248
    s_add_u32 s59, s76, 49152
    buffer_load_dwordx4 v22, s[20:23], s59 offen sc1 lds
    v_fmamk_f32 v102, v96, 0x41200000, v98
    v_fmamk_f32 v104, v97, 0x41200000, v99
    v_cos_f32 v103, v102
    v_mfma_f32_32x32x16_bf16 v[240:255], v[52:55], a[212:215], v[240:255]
    s_add_u32 m0, s74, 54272
    s_add_u32 s59, s76, 53248
    buffer_load_dwordx4 v23, s[20:23], s59 offen sc1 lds
    v_sin_f32 v102, -v102
    v_cos_f32 v105, v104
    v_sin_f32 v104, -v104
    s_waitcnt lgkmcnt(0)
    s_waitcnt vmcnt(11)
    v_mfma_f32_32x32x16_bf16 v[192:207], v[56:59], a[216:219], v[192:207]
    s_add_u32 m0, s74, 55296
    s_add_u32 s59, s76, 57344
    buffer_load_dwordx4 v24, s[20:23], s59 offen sc1 lds
    v_cvt_pk_bf16_f32 v102, v103, v102
    v_cvt_pk_bf16_f32 v104, v105, v104
    v_accvgpr_write_b32 a106, v102
    v_mfma_f32_32x32x16_bf16 v[208:223], v[56:59], a[220:223], v[208:223]
    s_add_u32 m0, s74, 56320
    s_add_u32 s59, s76, 61440
    buffer_load_dwordx4 v25, s[20:23], s59 offen sc1 lds
    v_accvgpr_write_b32 a110, v104
    v_fmamk_f32 v102, v96, 0x41100000, v98
    v_fmamk_f32 v104, v97, 0x41100000, v99
    v_mfma_f32_32x32x16_bf16 v[224:239], v[60:63], a[216:219], v[224:239]
    v_cos_f32 v103, v102
    v_sin_f32 v102, -v102
    v_cos_f32 v105, v104
    v_sin_f32 v104, -v104
    v_cvt_pk_bf16_f32 v102, v103, v102
    v_cvt_pk_bf16_f32 v104, v105, v104
    v_mfma_f32_32x32x16_bf16 v[240:255], v[60:63], a[220:223], v[240:255]
    v_accvgpr_write_b32 a105, v102
    v_accvgpr_write_b32 a109, v104
    v_fmamk_f32 v102, v96, 0x41000000, v98
    v_fmamk_f32 v104, v97, 0x41000000, v99
    v_cos_f32 v103, v102
    v_sin_f32 v102, -v102
    v_cos_f32 v105, v104
    v_sin_f32 v104, -v104
    v_cvt_pk_bf16_f32 v102, v103, v102
    v_cvt_pk_bf16_f32 v104, v105, v104
    v_accvgpr_write_b32 a104, v102
    v_accvgpr_write_b32 a108, v104
    v_fmamk_f32 v102, v96, 0x40400000, v98
    v_fmamk_f32 v104, v97, 0x40400000, v99
    v_cos_f32 v103, v102
    v_sin_f32 v102, -v102
    v_cos_f32 v105, v104
    v_sin_f32 v104, -v104
    v_cvt_pk_bf16_f32 v102, v103, v102
    v_cvt_pk_bf16_f32 v104, v105, v104
    v_accvgpr_write_b32 a99, v102
    v_accvgpr_write_b32 a103, v104
    v_fmamk_f32 v102, v96, 0x40000000, v98
    v_fmamk_f32 v104, v97, 0x40000000, v99
    v_cos_f32 v103, v102
    v_sin_f32 v102, -v102
    v_cos_f32 v105, v104
    v_sin_f32 v104, -v104
    v_cvt_pk_bf16_f32 v102, v103, v102
    v_cvt_pk_bf16_f32 v104, v105, v104
    v_accvgpr_write_b32 a98, v102
    v_accvgpr_write_b32 a102, v104
    v_fmamk_f32 v102, v96, 0x3f800000, v98
    v_fmamk_f32 v104, v97, 0x3f800000, v99
    v_cos_f32 v103, v102
    v_sin_f32 v102, -v102
    v_cos_f32 v105, v104
    v_sin_f32 v104, -v104
    v_cvt_pk_bf16_f32 v102, v103, v102
    v_cvt_pk_bf16_f32 v104, v105, v104
    v_accvgpr_write_b32 a97, v102
    v_accvgpr_write_b32 a101, v104
    v_cmp_eq_u32 vcc, 0, v100
    v_mul_f32 v102, 0x43800000, v96
    s_nop 0
    v_cndmask_b32 v102, v98, v102, vcc
    v_mul_f32 v104, 0x43800000, v97
    v_cndmask_b32 v104, v99, v104, vcc
    v_cos_f32 v103, v102
    v_sin_f32 v102, -v102
    v_cos_f32 v105, v104
    v_sin_f32 v104, -v104
    v_mov_b32 v106, 1.0
    v_cndmask_b32_e64 v106, v106, 0.5, vcc
    v_mul_f32 v103, v103, v106
    v_mul_f32 v105, v105, v106
    v_cvt_pk_bf16_f32 v102, v103, v102
    v_cvt_pk_bf16_f32 v104, v105, v104
    v_accvgpr_write_b32 a96, v102
    v_accvgpr_write_b32 a100, v104
    s_waitcnt vmcnt(0)
    v_xor_b32 v43, 0, v26
    v_xor_b32 v47, 0, v32
    ds_read_b128 v[48:51], v43
    ds_read_b128 v[52:55], v47
    s_waitcnt lgkmcnt(0)
    v_mfma_f32_32x32x16_bf16 v[128:143], v[48:51], a[96:99], 0
    v_xor_b32 v44, 32, v26
    v_xor_b32 v45, 32, v32
    v_mfma_f32_32x32x16_bf16 v[144:159], v[48:51], a[100:103], 0
    ds_read_b128 v[56:59], v44
    ds_read_b128 v[60:63], v45
    v_mfma_f32_32x32x16_bf16 v[160:175], v[52:55], a[96:99], 0
    v_mfma_f32_32x32x16_bf16 v[176:191], v[52:55], a[100:103], 0
    s_waitcnt lgkmcnt(0)
    v_mfma_f32_32x32x16_bf16 v[128:143], v[56:59], a[104:107], v[128:143]
    v_xor_b32 v43, 64, v26
    v_xor_b32 v47, 64, v32
    v_mfma_f32_32x32x16_bf16 v[144:159], v[56:59], a[108:111], v[144:159]
    ds_read_b128 v[48:51], v43
    ds_read_b128 v[52:55], v47
    v_mfma_f32_32x32x16_bf16 v[160:175], v[60:63], a[104:107], v[160:175]
    v_mfma_f32_32x32x16_bf16 v[176:191], v[60:63], a[108:111], v[176:191]
    s_waitcnt lgkmcnt(0)
    v_mfma_f32_32x32x16_bf16 v[128:143], v[48:51], a[112:115], v[128:143]
    v_xor_b32 v44, 96, v26
    v_xor_b32 v45, 96, v32
    v_mfma_f32_32x32x16_bf16 v[144:159], v[48:51], a[116:119], v[144:159]
    ds_read_b128 v[56:59], v44
    ds_read_b128 v[60:63], v45
    v_mfma_f32_32x32x16_bf16 v[160:175], v[52:55], a[112:115], v[160:175]
    v_mfma_f32_32x32x16_bf16 v[176:191], v[52:55], a[116:119], v[176:191]
    s_waitcnt lgkmcnt(0)
    v_mfma_f32_32x32x16_bf16 v[128:143], v[56:59], a[120:123], v[128:143]
    v_xor_b32 v43, 128, v26
    v_xor_b32 v47, 128, v32
    v_mfma_f32_32x32x16_bf16 v[144:159], v[56:59], a[124:127], v[144:159]
    ds_read_b128 v[48:51], v43
    ds_read_b128 v[52:55], v47
    v_mfma_f32_32x32x16_bf16 v[160:175], v[60:63], a[120:123], v[160:175]
    v_mfma_f32_32x32x16_bf16 v[176:191], v[60:63], a[124:127], v[176:191]
    s_waitcnt lgkmcnt(0)
    v_mfma_f32_32x32x16_bf16 v[128:143], v[48:51], a[128:131], v[128:143]
    v_xor_b32 v44, 160, v26
    v_xor_b32 v45, 160, v32
    v_mfma_f32_32x32x16_bf16 v[144:159], v[48:51], a[132:135], v[144:159]
    ds_read_b128 v[56:59], v44
    ds_read_b128 v[60:63], v45
    v_mfma_f32_32x32x16_bf16 v[160:175], v[52:55], a[128:131], v[160:175]
    v_mfma_f32_32x32x16_bf16 v[176:191], v[52:55], a[132:135], v[176:191]
    s_waitcnt lgkmcnt(0)
    v_mfma_f32_32x32x16_bf16 v[128:143], v[56:59], a[136:139], v[128:143]
    v_xor_b32 v43, 192, v26
    v_xor_b32 v47, 192, v32
    v_mfma_f32_32x32x16_bf16 v[144:159], v[56:59], a[140:143], v[144:159]
    ds_read_b128 v[48:51], v43
    ds_read_b128 v[52:55], v47
    v_mfma_f32_32x32x16_bf16 v[160:175], v[60:63], a[136:139], v[160:175]
    v_mfma_f32_32x32x16_bf16 v[176:191], v[60:63], a[140:143], v[176:191]
    s_waitcnt lgkmcnt(0)
    v_mfma_f32_32x32x16_bf16 v[128:143], v[48:51], a[144:147], v[128:143]
    v_xor_b32 v44, 224, v26
    v_xor_b32 v45, 224, v32
    v_mfma_f32_32x32x16_bf16 v[144:159], v[48:51], a[148:151], v[144:159]
    ds_read_b128 v[56:59], v44
    ds_read_b128 v[60:63], v45
    v_mfma_f32_32x32x16_bf16 v[160:175], v[52:55], a[144:147], v[160:175]
    v_mfma_f32_32x32x16_bf16 v[176:191], v[52:55], a[148:151], v[176:191]
    s_waitcnt lgkmcnt(0)
    v_mfma_f32_32x32x16_bf16 v[128:143], v[56:59], a[152:155], v[128:143]
    v_mfma_f32_32x32x16_bf16 v[144:159], v[56:59], a[156:159], v[144:159]
    v_mfma_f32_32x32x16_bf16 v[160:175], v[60:63], a[152:155], v[160:175]
    v_mfma_f32_32x32x16_bf16 v[176:191], v[60:63], a[156:159], v[176:191]
    s_nop 8
    v_cvt_pk_bf16_f32 v64, v128, v129
    v_cvt_pk_bf16_f32 v65, v130, v131
    v_cvt_pk_bf16_f32 v66, v132, v133
    v_cvt_pk_bf16_f32 v67, v134, v135
    v_cvt_pk_bf16_f32 v80, v144, v145
    v_cvt_pk_bf16_f32 v81, v146, v147
    v_cvt_pk_bf16_f32 v82, v148, v149
    v_cvt_pk_bf16_f32 v83, v150, v151
    v_cvt_pk_bf16_f32 v68, v136, v137
    v_cvt_pk_bf16_f32 v69, v138, v139
    v_cvt_pk_bf16_f32 v70, v140, v141
    v_cvt_pk_bf16_f32 v71, v142, v143
    v_cvt_pk_bf16_f32 v84, v152, v153
    v_cvt_pk_bf16_f32 v85, v154, v155
    v_cvt_pk_bf16_f32 v86, v156, v157
    v_cvt_pk_bf16_f32 v87, v158, v159
    v_cvt_pk_bf16_f32 v72, v160, v161
    v_cvt_pk_bf16_f32 v73, v162, v163
    v_cvt_pk_bf16_f32 v74, v164, v165
    v_cvt_pk_bf16_f32 v75, v166, v167
    v_cvt_pk_bf16_f32 v88, v176, v177
    v_cvt_pk_bf16_f32 v89, v178, v179
    v_cvt_pk_bf16_f32 v90, v180, v181
    v_cvt_pk_bf16_f32 v91, v182, v183
    v_cvt_pk_bf16_f32 v76, v168, v169
    v_cvt_pk_bf16_f32 v77, v170, v171
    v_cvt_pk_bf16_f32 v78, v172, v173
    v_cvt_pk_bf16_f32 v79, v174, v175
    v_cvt_pk_bf16_f32 v92, v184, v185
    v_cvt_pk_bf16_f32 v93, v186, v187
    v_cvt_pk_bf16_f32 v94, v188, v189
    v_cvt_pk_bf16_f32 v95, v190, v191
    v_mfma_f32_32x32x16_bf16 v[192:207], v[64:67], a[160:163], v[192:207]
    v_mfma_f32_32x32x16_bf16 v[208:223], v[64:67], a[176:179], v[208:223]
    v_mfma_f32_32x32x16_bf16 v[224:239], v[80:83], a[160:163], v[224:239]
    v_mfma_f32_32x32x16_bf16 v[240:255], v[80:83], a[176:179], v[240:255]
    v_mfma_f32_32x32x16_bf16 v[192:207], v[68:71], a[164:167], v[192:207]
    v_mfma_f32_32x32x16_bf16 v[208:223], v[68:71], a[180:183], v[208:223]
    v_mfma_f32_32x32x16_bf16 v[224:239], v[84:87], a[164:167], v[224:239]
    v_mfma_f32_32x32x16_bf16 v[240:255], v[84:87], a[180:183], v[240:255]
    v_mfma_f32_32x32x16_bf16 v[192:207], v[72:75], a[168:171], v[192:207]
    v_mfma_f32_32x32x16_bf16 v[208:223], v[72:75], a[184:187], v[208:223]
    v_mfma_f32_32x32x16_bf16 v[224:239], v[88:91], a[168:171], v[224:239]
    v_mfma_f32_32x32x16_bf16 v[240:255], v[88:91], a[184:187], v[240:255]
    v_mfma_f32_32x32x16_bf16 v[192:207], v[76:79], a[172:175], v[192:207]
    v_mfma_f32_32x32x16_bf16 v[208:223], v[76:79], a[188:191], v[208:223]
    v_mfma_f32_32x32x16_bf16 v[224:239], v[92:95], a[172:175], v[224:239]
    v_mfma_f32_32x32x16_bf16 v[240:255], v[92:95], a[188:191], v[240:255]
    v_lshlrev_b32 v8, 7, v2
    v_lshl_add_u32 v8, v3, 3, v8
    s_add_u32 s55, s74, 49152
    v_add_u32 v8, s55, v8
    v_lshlrev_b32 v9, 4, v6
    v_xor_b32 v44, 0, v9
    v_add_u32 v22, v8, v44
    v_xor_b32 v44, 16, v9
    v_add_u32 v23, v8, v44
    v_xor_b32 v44, 32, v9
    v_add_u32 v24, v8, v44
    v_xor_b32 v44, 48, v9
    v_add_u32 v25, v8, v44
    v_xor_b32 v44, 64, v9
    v_add_u32 v26, v8, v44
    v_xor_b32 v44, 80, v9
    v_add_u32 v27, v8, v44
    v_xor_b32 v44, 96, v9
    v_add_u32 v28, v8, v44
    v_xor_b32 v44, 112, v9
    v_add_u32 v29, v8, v44
    v_cvt_pk_bf16_f32 v48, v192, v193
    v_cvt_pk_bf16_f32 v49, v194, v195
    ds_write_b64 v22, v[48:49] offset:0
    v_cvt_pk_bf16_f32 v50, v196, v197
    v_cvt_pk_bf16_f32 v51, v198, v199
    ds_write_b64 v23, v[50:51] offset:0
    v_cvt_pk_bf16_f32 v52, v200, v201
    v_cvt_pk_bf16_f32 v53, v202, v203
    ds_write_b64 v24, v[52:53] offset:0
    v_cvt_pk_bf16_f32 v54, v204, v205
    v_cvt_pk_bf16_f32 v55, v206, v207
    ds_write_b64 v25, v[54:55] offset:0
    v_cvt_pk_bf16_f32 v56, v224, v225
    v_cvt_pk_bf16_f32 v57, v226, v227
    ds_write_b64 v26, v[56:57] offset:0
    v_cvt_pk_bf16_f32 v58, v228, v229
    v_cvt_pk_bf16_f32 v59, v230, v231
    ds_write_b64 v27, v[58:59] offset:0
    v_cvt_pk_bf16_f32 v60, v232, v233
    v_cvt_pk_bf16_f32 v61, v234, v235
    ds_write_b64 v28, v[60:61] offset:0
    v_cvt_pk_bf16_f32 v62, v236, v237
    v_cvt_pk_bf16_f32 v63, v238, v239
    ds_write_b64 v29, v[62:63] offset:0
    v_cvt_pk_bf16_f32 v48, v208, v209
    v_cvt_pk_bf16_f32 v49, v210, v211
    ds_write_b64 v22, v[48:49] offset:4096
    v_cvt_pk_bf16_f32 v50, v212, v213
    v_cvt_pk_bf16_f32 v51, v214, v215
    ds_write_b64 v23, v[50:51] offset:4096
    v_cvt_pk_bf16_f32 v52, v216, v217
    v_cvt_pk_bf16_f32 v53, v218, v219
    ds_write_b64 v24, v[52:53] offset:4096
    v_cvt_pk_bf16_f32 v54, v220, v221
    v_cvt_pk_bf16_f32 v55, v222, v223
    ds_write_b64 v25, v[54:55] offset:4096
    v_cvt_pk_bf16_f32 v56, v240, v241
    v_cvt_pk_bf16_f32 v57, v242, v243
    ds_write_b64 v26, v[56:57] offset:4096
    v_cvt_pk_bf16_f32 v58, v244, v245
    v_cvt_pk_bf16_f32 v59, v246, v247
    ds_write_b64 v27, v[58:59] offset:4096
    v_cvt_pk_bf16_f32 v60, v248, v249
    v_cvt_pk_bf16_f32 v61, v250, v251
    ds_write_b64 v28, v[60:61] offset:4096
    v_cvt_pk_bf16_f32 v62, v252, v253
    v_cvt_pk_bf16_f32 v63, v254, v255
    ds_write_b64 v29, v[62:63] offset:4096
    s_waitcnt lgkmcnt(0)
    s_barrier
    v_lshrrev_b32 v8, 3, v0
    v_and_b32 v9, 7, v0
    v_and_b32 v44, 7, v8
    v_xor_b32 v9, v9, v44
    v_lshlrev_b32 v9, 4, v9
    v_lshl_add_u32 v9, v8, 7, v9
    v_add_u32 v9, 49152, v9
    ds_read_b128 v[64:67], v9 offset:0
    ds_read_b128 v[68:71], v9 offset:8192
    ds_read_b128 v[72:75], v9 offset:16384
    ds_read_b128 v[76:79], v9 offset:24576
    ds_read_b128 v[80:83], v9 offset:4096
    ds_read_b128 v[84:87], v9 offset:12288
    ds_read_b128 v[88:91], v9 offset:20480
    ds_read_b128 v[92:95], v9 offset:28672
    v_mov_b32 v98, 0x00003f80
    v_mov_b32 v99, 0x3f800000
    s_waitcnt lgkmcnt(4)
    v_dot2_f32_bf16 v96, v14, v98, 0
    v_dot2_f32_bf16 v97, v14, v99, 0
    v_dot2_f32_bf16 v96, v64, v98, v96
    v_dot2_f32_bf16 v97, v64, v99, v97
    v_dot2_f32_bf16 v96, v68, v98, v96
    v_dot2_f32_bf16 v97, v68, v99, v97
    v_dot2_f32_bf16 v96, v72, v98, v96
    v_dot2_f32_bf16 v97, v72, v99, v97
    v_dot2_f32_bf16 v96, v76, v98, v96
    v_dot2_f32_bf16 v97, v76, v99, v97
    v_dot2_f32_bf16 v108, v15, v98, 0
    v_dot2_f32_bf16 v109, v15, v99, 0
    v_dot2_f32_bf16 v108, v65, v98, v108
    v_dot2_f32_bf16 v109, v65, v99, v109
    v_dot2_f32_bf16 v108, v69, v98, v108
    v_dot2_f32_bf16 v109, v69, v99, v109
    v_dot2_f32_bf16 v108, v73, v98, v108
    v_dot2_f32_bf16 v109, v73, v99, v109
    v_dot2_f32_bf16 v108, v77, v98, v108
    v_dot2_f32_bf16 v109, v77, v99, v109
    v_cvt_pk_bf16_f32 v100, v96, v97
    v_dot2_f32_bf16 v96, v16, v98, 0
    v_dot2_f32_bf16 v97, v16, v99, 0
    v_dot2_f32_bf16 v96, v66, v98, v96
    v_dot2_f32_bf16 v97, v66, v99, v97
    v_dot2_f32_bf16 v96, v70, v98, v96
    v_dot2_f32_bf16 v97, v70, v99, v97
    v_dot2_f32_bf16 v96, v74, v98, v96
    v_dot2_f32_bf16 v97, v74, v99, v97
    v_dot2_f32_bf16 v96, v78, v98, v96
    v_dot2_f32_bf16 v97, v78, v99, v97
    v_cvt_pk_bf16_f32 v101, v108, v109
    v_dot2_f32_bf16 v108, v17, v98, 0
    v_dot2_f32_bf16 v109, v17, v99, 0
    v_dot2_f32_bf16 v108, v67, v98, v108
    v_dot2_f32_bf16 v109, v67, v99, v109
    v_dot2_f32_bf16 v108, v71, v98, v108
    v_dot2_f32_bf16 v109, v71, v99, v109
    v_dot2_f32_bf16 v108, v75, v98, v108
    v_dot2_f32_bf16 v109, v75, v99, v109
    v_dot2_f32_bf16 v108, v79, v98, v108
    v_dot2_f32_bf16 v109, v79, v99, v109
    v_cvt_pk_bf16_f32 v102, v96, v97
    s_nop 1
    v_cvt_pk_bf16_f32 v103, v108, v109
    buffer_store_dwordx4 v[100:103], v33, s[24:27], s69 offen
    s_waitcnt lgkmcnt(0)
    v_dot2_f32_bf16 v96, v18, v98, 0
    v_dot2_f32_bf16 v97, v18, v99, 0
    v_dot2_f32_bf16 v96, v80, v98, v96
    v_dot2_f32_bf16 v97, v80, v99, v97
    v_dot2_f32_bf16 v96, v84, v98, v96
    v_dot2_f32_bf16 v97, v84, v99, v97
    v_dot2_f32_bf16 v96, v88, v98, v96
    v_dot2_f32_bf16 v97, v88, v99, v97
    v_dot2_f32_bf16 v96, v92, v98, v96
    v_dot2_f32_bf16 v97, v92, v99, v97
    v_dot2_f32_bf16 v108, v19, v98, 0
    v_dot2_f32_bf16 v109, v19, v99, 0
    v_dot2_f32_bf16 v108, v81, v98, v108
    v_dot2_f32_bf16 v109, v81, v99, v109
    v_dot2_f32_bf16 v108, v85, v98, v108
    v_dot2_f32_bf16 v109, v85, v99, v109
    v_dot2_f32_bf16 v108, v89, v98, v108
    v_dot2_f32_bf16 v109, v89, v99, v109
    v_dot2_f32_bf16 v108, v93, v98, v108
    v_dot2_f32_bf16 v109, v93, v99, v109
    v_cvt_pk_bf16_f32 v104, v96, v97
    v_dot2_f32_bf16 v96, v20, v98, 0
    v_dot2_f32_bf16 v97, v20, v99, 0
    v_dot2_f32_bf16 v96, v82, v98, v96
    v_dot2_f32_bf16 v97, v82, v99, v97
    v_dot2_f32_bf16 v96, v86, v98, v96
    v_dot2_f32_bf16 v97, v86, v99, v97
    v_dot2_f32_bf16 v96, v90, v98, v96
    v_dot2_f32_bf16 v97, v90, v99, v97
    v_dot2_f32_bf16 v96, v94, v98, v96
    v_dot2_f32_bf16 v97, v94, v99, v97
    v_cvt_pk_bf16_f32 v105, v108, v109
    v_dot2_f32_bf16 v108, v21, v98, 0
    v_dot2_f32_bf16 v109, v21, v99, 0
    v_dot2_f32_bf16 v108, v83, v98, v108
    v_dot2_f32_bf16 v109, v83, v99, v109
    v_dot2_f32_bf16 v108, v87, v98, v108
    v_dot2_f32_bf16 v109, v87, v99, v109
    v_dot2_f32_bf16 v108, v91, v98, v108
    v_dot2_f32_bf16 v109, v91, v99, v109
    v_dot2_f32_bf16 v108, v95, v98, v108
    v_dot2_f32_bf16 v109, v95, v99, v109
    v_cvt_pk_bf16_f32 v106, v96, v97
    s_nop 1
    v_cvt_pk_bf16_f32 v107, v108, v109
    s_add_u32 s55, s69, 1048576
    buffer_store_dwordx4 v[104:107], v33, s[24:27], s55 offen
    s_branch L_end
L_nslow_36:
    s_mov_b32 s73, 0
L_nloop_38:
    s_sleep 1
    buffer_load_dword v46, v43, s[40:43], 0 offen sc1
    s_add_u32 s73, s73, 1
    s_waitcnt vmcnt(0)
    v_readfirstlane_b32 s51, v46
    s_cmp_lg_u32 s51, 0
    s_cbranch_scc1 L_nback_37
    s_cmp_lt_u32 s73, 100000
    s_cbranch_scc1 L_nloop_38
    s_branch L_nback_37
L_rslow_39:
    s_mov_b32 s73, 0
L_rloop_41:
    s_sleep 1
    buffer_load_dwordx4 v[120:123], v42, s[20:23], s69 offen sc1
    s_add_u32 s73, s73, 1
    s_waitcnt vmcnt(0)
    v_cmp_ne_u32 vcc, v46, v123
    s_cbranch_vccz L_rback_40
    s_cmp_lt_u32 s73, 50000
    s_cbranch_scc1 L_rloop_41
    s_branch L_rback_40
L_cslow_48:
    s_mov_b32 s73, 0
L_cloop_50:
    s_sleep 1
    buffer_load_dwordx4 v[128:131], v126, s[20:23], s79 offen offset:0 sc1
    buffer_load_dwordx4 v[132:135], v126, s[20:23], s79 offen offset:1024 sc1
    buffer_load_dwordx4 v[136:139], v126, s[20:23], s79 offen offset:2048 sc1
    buffer_load_dwordx4 v[140:143], v126, s[20:23], s79 offen offset:3072 sc1
    s_add_u32 s73, s73, 1
    s_waitcnt vmcnt(0)
    v_xor_b32 v43, v46, v129
    v_xor_b32 v44, v46, v131
    v_or_b32 v43, v43, v44
    v_xor_b32 v44, v46, v133
    v_or_b32 v43, v43, v44
    v_xor_b32 v44, v46, v135
    v_or_b32 v43, v43, v44
    v_xor_b32 v44, v46, v137
    v_or_b32 v43, v43, v44
    v_xor_b32 v44, v46, v139
    v_or_b32 v43, v43, v44
    v_xor_b32 v44, v46, v141
    v_or_b32 v43, v43, v44
    v_xor_b32 v44, v46, v143
    v_or_b32 v43, v43, v44
    v_cmp_ne_u32 vcc, 0, v43
    s_cbranch_vccz L_cback_49
    s_cmp_lt_u32 s73, 50000
    s_cbranch_scc1 L_cloop_50
    s_branch L_cback_49
L_sslow_51:
    s_mov_b32 s73, 0
    v_lshlrev_b32 v45, 4, v2
L_sloop_53:
    s_sleep 1
    buffer_load_dwordx4 v[112:115], v45, s[20:23], s75 offen sc1
    buffer_load_dwordx4 v[116:119], v45, s[20:23], s75 offen offset:512 sc1
    s_add_u32 s73, s73, 1
    s_waitcnt vmcnt(0)
    v_xor_b32 v43, v46, v115
    v_xor_b32 v44, v46, v119
    v_or_b32 v43, v43, v44
    v_cmp_ne_u32 vcc, 0, v43
    s_cbranch_vccz L_sback_52
    s_cmp_lt_u32 s73, 50000
    s_cbranch_scc1 L_sloop_53
    s_branch L_sback_52
L_slow_54:
    s_mov_b32 s73, 0
L_loop_56:
    s_sleep 1
    buffer_load_dword v127, v126, s[20:23], 0 offen sc1
    s_add_u32 s73, s73, 1
    s_waitcnt vmcnt(0)
    v_cmp_ne_u32 vcc, v43, v127
    s_cbranch_vccz L_back_55
    s_cmp_lt_u32 s73, 50000
    s_cbranch_scc1 L_loop_56
    s_branch L_back_55
L_slow_64:
    s_mov_b32 s73, 0
L_loop_66:
    s_sleep 1
    buffer_load_dword v127, v126, s[20:23], 0 offen sc1
    s_add_u32 s73, s73, 1
    s_waitcnt vmcnt(0)
    v_cmp_ne_u32 vcc, v43, v127
    s_cbranch_vccz L_back_65
    s_cmp_lt_u32 s73, 50000
    s_cbranch_scc1 L_loop_66
    s_branch L_back_65
L_slow_67:
    s_mov_b32 s73, 0
L_loop_69:
    s_sleep 1
    buffer_load_dwordx4 v[28:31], v27, s[20:23], 0 offen sc1
    s_add_u32 s73, s73, 1
    s_waitcnt vmcnt(0)
    v_xor_b32 v28, v43, v28
    v_xor_b32 v29, v43, v29
    v_xor_b32 v30, v43, v30
    v_xor_b32 v31, v43, v31
    v_or3_b32 v28, v28, v29, v30
    v_or_b32 v28, v28, v31
    v_cmp_ne_u32 vcc, 0, v28
    s_cbranch_vccz L_back_68
    s_cmp_lt_u32 s73, 50000
    s_cbranch_scc1 L_loop_69
    s_branch L_back_68
L_end:
    s_endpgm
.section .rodata,"a"
.p2align 6
.amdhsa_kernel parallel_sum__spectral_gfnet__glu_gated_swiglu__prompt_kernel
  .amdhsa_next_free_vgpr 512
  .amdhsa_next_free_sgpr 102
  .amdhsa_accum_offset 256
  .amdhsa_group_segment_fixed_size 0
  .amdhsa_kernarg_size 80
  .amdhsa_user_sgpr_count 2
  .amdhsa_user_sgpr_kernarg_segment_ptr 1
  .amdhsa_system_sgpr_workgroup_id_x 1
  .amdhsa_float_denorm_mode_32 3
.end_amdhsa_kernel
.set c0, 16256
.set c1, 16256
.set c2, 16256
.set c3, 16256
.set c4, 16256
.set c5, 16256
.set c6, 16255
.set c7, 16255
.set c8, 16255
.set c9, 16254
.set c10, 16254
.set c11, 16254
.set c12, 16253
.set c13, 16253
.set c14, 16252
.set c15, 16252
.set c16, 16251
.set c17, 16250
.set c18, 16250
.set c19, 16249
.set c20, 16248
.set c21, 16248
.set c22, 16247
.set c23, 16246
.set c24, 16245
.set c25, 16244
.set c26, 16243
.set c27, 16242
.set c28, 16241
.set c29, 16240
.set c30, 16239
.set c31, 16238
.set c32, 16237
.set c33, 16235
.set c34, 16234
.set c35, 16233
.set c36, 16231
.set c37, 16230
.set c38, 16229
.set c39, 16227
.set c40, 16226
.set c41, 16224
.set c42, 16223
.set c43, 16221
.set c44, 16220
.set c45, 16218
.set c46, 16216
.set c47, 16215
.set c48, 16213
.set c49, 16211
.set c50, 16209
.set c51, 16207
.set c52, 16206
.set c53, 16204
.set c54, 16202
.set c55, 16200
.set c56, 16198
.set c57, 16196
.set c58, 16194
.set c59, 16192
.set c60, 16190
.set c61, 16188
.set c62, 16185
.set c63, 16183
.set c64, 16181
.set c65, 16179
.set c66, 16177
.set c67, 16174
.set c68, 16172
.set c69, 16170
.set c70, 16167
.set c71, 16165
.set c72, 16162
.set c73, 16160
.set c74, 16157
.set c75, 16155
.set c76, 16152
.set c77, 16150
.set c78, 16147
.set c79, 16145
.set c80, 16142
.set c81, 16140
.set c82, 16137
.set c83, 16134
.set c84, 16132
.set c85, 16129
.set c86, 16124
.set c87, 16119
.set c88, 16113
.set c89, 16108
.set c90, 16102
.set c91, 16097
.set c92, 16091
.set c93, 16085
.set c94, 16079
.set c95, 16074
.set c96, 16068
.set c97, 16062
.set c98, 16056
.set c99, 16050
.set c100, 16044
.set c101, 16039
.set c102, 16033
.set c103, 16027
.set c104, 16021
.set c105, 16015
.set c106, 16009
.set c107, 16002
.set c108, 15993
.set c109, 15981
.set c110, 15968
.set c111, 15956
.set c112, 15944
.set c113, 15931
.set c114, 15919
.set c115, 15907
.set c116, 15894
.set c117, 15882
.set c118, 15867
.set c119, 15842
.set c120, 15817
.set c121, 15792
.set c122, 15767
.set c123, 15739
.set c124, 15689
.set c125, 15639
.set c126, 15561
.set c127, 15433
.set c128, 0
.set c129, 48201
.set c130, 48329
.set c131, 48407
.set c132, 48457
.set c133, 48507
.set c134, 48535
.set c135, 48560
.set c136, 48585
.set c137, 48610
.set c138, 48635
.set c139, 48650
.set c140, 48662
.set c141, 48675
.set c142, 48687
.set c143, 48699
.set c144, 48712
.set c145, 48724
.set c146, 48736
.set c147, 48749
.set c148, 48761
.set c149, 48770
.set c150, 48777
.set c151, 48783
.set c152, 48789
.set c153, 48795
.set c154, 48801
.set c155, 48807
.set c156, 48812
.set c157, 48818
.set c158, 48824
.set c159, 48830
.set c160, 48836
.set c161, 48842
.set c162, 48847
.set c163, 48853
.set c164, 48859
.set c165, 48865
.set c166, 48870
.set c167, 48876
.set c168, 48881
.set c169, 48887
.set c170, 48892
.set c171, 48897
.set c172, 48900
.set c173, 48902
.set c174, 48905
.set c175, 48908
.set c176, 48910
.set c177, 48913
.set c178, 48915
.set c179, 48918
.set c180, 48920
.set c181, 48923
.set c182, 48925
.set c183, 48928
.set c184, 48930
.set c185, 48933
.set c186, 48935
.set c187, 48938
.set c188, 48940
.set c189, 48942
.set c190, 48945
.set c191, 48947
.set c192, 48949
.set c193, 48951
.set c194, 48953
.set c195, 48956
.set c196, 48958
.set c197, 48960
.set c198, 48962
.set c199, 48964
.set c200, 48966
.set c201, 48968
.set c202, 48970
.set c203, 48972
.set c204, 48974
.set c205, 48975
.set c206, 48977
.set c207, 48979
.set c208, 48981
.set c209, 48983
.set c210, 48984
.set c211, 48986
.set c212, 48988
.set c213, 48989
.set c214, 48991
.set c215, 48992
.set c216, 48994
.set c217, 48995
.set c218, 48997
.set c219, 48998
.set c220, 48999
.set c221, 49001
.set c222, 49002
.set c223, 49003
.set c224, 49005
.set c225, 49006
.set c226, 49007
.set c227, 49008
.set c228, 49009
.set c229, 49010
.set c230, 49011
.set c231, 49012
.set c232, 49013
.set c233, 49014
.set c234, 49015
.set c235, 49016
.set c236, 49016
.set c237, 49017
.set c238, 49018
.set c239, 49018
.set c240, 49019
.set c241, 49020
.set c242, 49020
.set c243, 49021
.set c244, 49021
.set c245, 49022
.set c246, 49022
.set c247, 49022
.set c248, 49023
.set c249, 49023
.set c250, 49023
.set c251, 49024
.set c252, 49024
.set c253, 49024
.set c254, 49024
.set c255, 49024
.set c256, 49024
.set c257, 49024
.set c258, 49024
.set c259, 49024
.set c260, 49024
.set c261, 49024
.set c262, 49023
.set c263, 49023
.set c264, 49023
.set c265, 49022
.set c266, 49022
.set c267, 49022
.set c268, 49021
.set c269, 49021
.set c270, 49020
.set c271, 49020
.set c272, 49019
.set c273, 49018
.set c274, 49018
.set c275, 49017
.set c276, 49016
.set c277, 49016
.set c278, 49015
.set c279, 49014
.set c280, 49013
.set c281, 49012
.set c282, 49011
.set c283, 49010
.set c284, 49009
.set c285, 49008
.set c286, 49007
.set c287, 49006
.set c288, 49005
.set c289, 49003
.set c290, 49002
.set c291, 49001
.set c292, 48999
.set c293, 48998
.set c294, 48997
.set c295, 48995
.set c296, 48994
.set c297, 48992
.set c298, 48991
.set c299, 48989
.set c300, 48988
.set c301, 48986
.set c302, 48984
.set c303, 48983
.set c304, 48981
.set c305, 48979
.set c306, 48977
.set c307, 48975
.set c308, 48974
.set c309, 48972
.set c310, 48970
.set c311, 48968
.set c312, 48966
.set c313, 48964
.set c314, 48962
.set c315, 48960
.set c316, 48958
.set c317, 48956
.set c318, 48953
.set c319, 48951
.set c320, 48949
.set c321, 48947
.set c322, 48945
.set c323, 48942
.set c324, 48940
.set c325, 48938
.set c326, 48935
.set c327, 48933
.set c328, 48930
.set c329, 48928
.set c330, 48925
.set c331, 48923
.set c332, 48920
.set c333, 48918
.set c334, 48915
.set c335, 48913
.set c336, 48910
.set c337, 48908
.set c338, 48905
.set c339, 48902
.set c340, 48900
.set c341, 48897
.set c342, 48892
.set c343, 48887
.set c344, 48881
.set c345, 48876
.set c346, 48870
.set c347, 48865
.set c348, 48859
.set c349, 48853
.set c350, 48847
.set c351, 48842
.set c352, 48836
.set c353, 48830
.set c354, 48824
.set c355, 48818
.set c356, 48812
.set c357, 48807
.set c358, 48801
.set c359, 48795
.set c360, 48789
.set c361, 48783
.set c362, 48777
.set c363, 48770
.set c364, 48761
.set c365, 48749
.set c366, 48736
.set c367, 48724
.set c368, 48712
.set c369, 48699
.set c370, 48687
.set c371, 48675
.set c372, 48662
.set c373, 48650
.set c374, 48635
.set c375, 48610
.set c376, 48585
.set c377, 48560
.set c378, 48535
.set c379, 48507
.set c380, 48457
.set c381, 48407
.set c382, 48329
.set c383, 48201
.set c384, 0
.set c385, 15433
.set c386, 15561
.set c387, 15639
.set c388, 15689
.set c389, 15739
.set c390, 15767
.set c391, 15792
.set c392, 15817
.set c393, 15842
.set c394, 15867
.set c395, 15882
.set c396, 15894
.set c397, 15907
.set c398, 15919
.set c399, 15931
.set c400, 15944
.set c401, 15956
.set c402, 15968
.set c403, 15981
.set c404, 15993
.set c405, 16002
.set c406, 16009
.set c407, 16015
.set c408, 16021
.set c409, 16027
.set c410, 16033
.set c411, 16039
.set c412, 16044
.set c413, 16050
.set c414, 16056
.set c415, 16062
.set c416, 16068
.set c417, 16074
.set c418, 16079
.set c419, 16085
.set c420, 16091
.set c421, 16097
.set c422, 16102
.set c423, 16108
.set c424, 16113
.set c425, 16119
.set c426, 16124
.set c427, 16129
.set c428, 16132
.set c429, 16134
.set c430, 16137
.set c431, 16140
.set c432, 16142
.set c433, 16145
.set c434, 16147
.set c435, 16150
.set c436, 16152
.set c437, 16155
.set c438, 16157
.set c439, 16160
.set c440, 16162
.set c441, 16165
.set c442, 16167
.set c443, 16170
.set c444, 16172
.set c445, 16174
.set c446, 16177
.set c447, 16179
.set c448, 16181
.set c449, 16183
.set c450, 16185
.set c451, 16188
.set c452, 16190
.set c453, 16192
.set c454, 16194
.set c455, 16196
.set c456, 16198
.set c457, 16200
.set c458, 16202
.set c459, 16204
.set c460, 16206
.set c461, 16207
.set c462, 16209
.set c463, 16211
.set c464, 16213
.set c465, 16215
.set c466, 16216
.set c467, 16218
.set c468, 16220
.set c469, 16221
.set c470, 16223
.set c471, 16224
.set c472, 16226
.set c473, 16227
.set c474, 16229
.set c475, 16230
.set c476, 16231
.set c477, 16233
.set c478, 16234
.set c479, 16235
.set c480, 16237
.set c481, 16238
.set c482, 16239
.set c483, 16240
.set c484, 16241
.set c485, 16242
.set c486, 16243
.set c487, 16244
.set c488, 16245
.set c489, 16246
.set c490, 16247
.set c491, 16248
.set c492, 16248
.set c493, 16249
.set c494, 16250
.set c495, 16250
.set c496, 16251
.set c497, 16252
.set c498, 16252
.set c499, 16253
.set c500, 16253
.set c501, 16254
.set c502, 16254
.set c503, 16254
.set c504, 16255
.set c505, 16255
.set c506, 16255
.set c507, 16256
.set c508, 16256
.set c509, 16256
.set c510, 16256
.set c511, 16256
.altmacro
.macro TC i
.short c\i
.endm
.macro FD kb, db, ph
.set tl, 0
.rept 64
.set tu, \kb + (tl & 31)
.set tp, \ph
.set tz, 0
.if tu == 0
.set tu, 256
.if \ph
.set tz, 1
.endif
.endif
.set ti, tu*(\db + 8*(tl >> 5)) + tp
.rept 8
.if tz
.short 0
.else
TC %(ti & 511)
.endif
.set ti, ti + tu
.endr
.set tl, tl + 1
.endr
.endm
.p2align 12
.type gf_tables,@object
gf_tables:
.set tt, 0
.rept 32
.set tg, 0
.rept 8
FD %(32*tg), %(16*tt), 0
FD %(32*tg), %(16*tt), 128
.set tg, tg + 1
.endr
.set tt, tt + 1
.endr
.noaltmacro
.size gf_tables, 524288
```
